```python
import torch

def _softmax(x, axis=-1):
    return torch.softmax(x, dim=axis)

def _gelu(x):
    return torch.nn.functional.gelu(x, approximate='tanh')

def _silu(x):
    return torch.nn.functional.silu(x)

def _sigmoid(x):
    return torch.sigmoid(x)

def _layernorm(x, axis=-1, eps=1e-05):
    m = x.mean(dim=axis, keepdim=True)
    v = x.var(dim=axis, keepdim=True, unbiased=False)
    return (x - m) / torch.sqrt(v + eps)

def _scatter_add(tgt, idx, src, axis=0):
    return tgt.clone().index_add_(axis, idx, src)

def _segment_sum(src, seg, n):
    out = torch.zeros((n,) + src.shape[1:], dtype=src.dtype)
    return out.index_add_(0, seg, src)

def _pad(x, pw):
    flat = tuple((v for pair in reversed(pw) for v in pair))
    return torch.nn.functional.pad(x, flat)
kernel_name = 'sequential_preLN__memory_aug_recurrent_mem_tr__mixer_token_mlp__prompt'

def setup_inputs():

    _w = lambda a: (lambda t: t.to(torch.bfloat16) if t.is_floating_point() else t)(torch.as_tensor(a))

    def _A_setup():
        B, S, Dm = (1, 2048, 448)
        H, Dh = (16, 256)
        M, seg = (8, 32)
        seg = min(seg, S)
        S = S // seg * seg
        return {'x': _w((lambda *s: torch.randn(*s, dtype=torch.bfloat16) * 0.05)(B, S, Dm)), 'mem0': _w((lambda *s: torch.randn(*s, dtype=torch.bfloat16) * 0.2)(B, M, Dm)), 'Wq': _w((lambda *s: torch.randn(*s, dtype=torch.bfloat16) * 1.6)(Dm, H, Dh) * Dm ** (-0.5)), 'Wk': _w((lambda *s: torch.randn(*s, dtype=torch.bfloat16) * 1.6)(Dm, H, Dh) * Dm ** (-0.5)), 'Wv': _w((lambda *s: torch.randn(*s, dtype=torch.bfloat16) * 0.2)(Dm, H, Dh) * Dm ** (-0.5)), 'Wo': _w((lambda *s: torch.randn(*s, dtype=torch.bfloat16) * 0.2)(H, Dh, Dm) * (H * Dh) ** (-0.5)), 'seg_len': seg}
    _A_in = _A_setup()

    def _B_setup():
        B, S, D, F = (1, 2048, 448, 1792)
        return {'x': _w((lambda *s: torch.randn(*s, dtype=torch.bfloat16) * 0.05)(B, S, D)), 'w1': _w((lambda *s: torch.randn(*s, dtype=torch.bfloat16) * 0.4)(S, F) * S ** (-0.5)), 'b1': _w((lambda *s: torch.randn(*s, dtype=torch.bfloat16) * 3.2)(F) * 0.02), 'w2': _w((lambda *s: torch.randn(*s, dtype=torch.bfloat16) * 0.4)(F, S) * F ** (-0.5)), 'b2': _w((lambda *s: torch.randn(*s, dtype=torch.bfloat16) * 1.6)(S) * 0.02)}
    _B_in = _B_setup()
    return {'A_x': _A_in['x'], 'A_mem0': _A_in['mem0'], 'A_Wq': _A_in['Wq'], 'A_Wk': _A_in['Wk'], 'A_Wv': _A_in['Wv'], 'A_Wo': _A_in['Wo'], 'A_seg_len': _A_in['seg_len'], 'B_x': _B_in['x'], 'B_w1': _B_in['w1'], 'B_b1': _B_in['b1'], 'B_w2': _B_in['w2'], 'B_b2': _B_in['b2']}

def reference(A_x, A_mem0, A_Wq, A_Wk, A_Wv, A_Wo, A_seg_len, B_x, B_w1, B_b1, B_w2, B_b2):

    def _A_ref(x, mem0, Wq, Wk, Wv, Wo, seg_len):
        B, S, Dm = x.shape
        H, Dh = (Wq.shape[1], Wq.shape[2])
        M = mem0.shape[1]
        scale = Dh ** (-0.5)
        n_seg = S // seg_len
        L = M + seg_len
        idx = torch.arange(L)
        mask = (idx[:, None] < M) | (idx[:, None] >= idx[None, :])
        mem = mem0
        outs = []
        for s in range(n_seg):
            xs = x[:, s * seg_len:(s + 1) * seg_len, :].clone()
            h = torch.concatenate([mem, xs], axis=1)
            q = torch.einsum('btd,dhe->bhte', h, Wq)
            k = torch.einsum('btd,dhe->bhte', h, Wk)
            v = torch.einsum('btd,dhe->bhte', h, Wv)
            scores = torch.einsum('bhqe,bhke->bhqk', q, k) * scale
            scores = torch.where(mask[None, None], scores, -1000000000.0)
            p = _softmax(scores, axis=-1)
            o = torch.einsum('bhqk,bhke->bhqe', p, v)
            o = torch.einsum('bhte,hed->btd', o, Wo)
            mem = o[:, :M, :].clone()
            outs.append(o[:, M:, :])
        return torch.concatenate(outs, axis=1)

    def _B_ref(x, w1, b1, w2, b2):
        B, S, D = x.shape
        h = _layernorm(x, axis=-1)
        u = torch.einsum('bsd,sf->bdf', h, w1) + b1
        u = _gelu(u)
        y = torch.einsum('bdf,fs->bds', u, w2) + b2
        return (lambda x, *d: x.permute(*d))(y, 0, 2, 1)
    x = A_x
    h = x + _A_ref(_layernorm(x, axis=-1), A_mem0, A_Wq, A_Wk, A_Wv, A_Wo, A_seg_len)
    h2 = h + _B_ref(_layernorm(h, axis=-1), B_w1, B_b1, B_w2, B_b2)
    return h2
```

```asm
; @launch kernel=prep_kernel grid=(256,1,1) block=(256,1,1) lds=135168
; @launch kernel=main_kernel grid=(256,1,1) block=(256,1,1) lds=114688
.amdgcn_target "amdgcn-amd-amdhsa--gfx950"
.text
.p2align 8
.globl prep_kernel
.type prep_kernel,@function
prep_kernel:
  s_cmp_ge_u32 s2, 256
  s_cbranch_scc1 L_done2
  v_lshrrev_b32 v1, 6, v0
  v_and_b32 v0, 63, v0
  v_readfirstlane_b32 s3, v1
  s_load_dwordx2 s[16:17], s[0:1], 112
  s_waitcnt lgkmcnt(0)
  s_mov_b32 s8, s16
  s_mov_b32 s9, s17
  s_mov_b32 s10, 268435456
  s_mov_b32 s11, 0x00020000
  s_mov_b32 s20, s2
  s_cmp_lt_u32 s20, 112
  s_cbranch_scc1 L_at
  s_sub_u32 s20, s20, 112
  s_cmp_lt_u32 s20, 112
  s_cbranch_scc1 L_bt
  s_sub_u32 s20, s20, 112
  s_cmp_lt_u32 s20, 64
  s_cbranch_scc1 L_ln
  s_sub_u32 s20, s20, 64
  s_cmp_lt_u32 s20, 224
  s_cbranch_scc1 L_t1
  s_sub_u32 s20, s20, 224
  s_branch L_t2
L_at:
  s_load_dwordx2 s[16:17], s[0:1], 16
  s_waitcnt lgkmcnt(0)
  s_mov_b32 s12, s16
  s_mov_b32 s13, s17
  s_mov_b32 s14, 3670016
  s_mov_b32 s15, 0x00020000
  s_load_dwordx2 s[22:23], s[0:1], 24
  s_waitcnt lgkmcnt(0)
  s_mov_b32 s16, s22
  s_mov_b32 s17, s23
  s_mov_b32 s18, 3670016
  s_mov_b32 s19, 0x00020000
  s_lshr_b32 s21, s20, 3
  s_lshl_b32 s21, s21, 1
  s_bfe_u32 s22, s20, 0x10002
  s_add_u32 s21, s21, s22
  s_lshr_b32 s27, s21, 2
  s_and_b32 s21, s21, 3
  s_and_b32 s22, s20, 3
  s_lshl_b32 s22, s22, 2
  s_add_u32 s26, s21, s22
  s_add_u32 s26, s26, 0
  s_and_b32 s26, s26, 15
  s_lshl_b32 s33, s27, 1
  s_sub_u32 s34, s33, 7
  s_cmp_ge_u32 s33, 7
  s_cselect_b32 s33, s34, s33
  s_lshl_b32 s24, s26, 9
  s_lshl_b32 s21, s27, 2
  s_add_u32 s21, s21, s3
  s_mul_hi_u32 s28, s21, 613566757
  s_mul_i32 s30, s28, 7
  s_sub_u32 s30, s21, s30
  s_mul_i32 s28, s28, 112
  s_and_b32 s31, s30, 1
  s_lshl_b32 s31, s31, 2
  s_lshr_b32 s21, s30, 1
  s_lshl_b32 s21, s21, 1
  s_add_u32 s31, s31, s21
  s_sub_u32 s21, s30, 4
  s_lshl_b32 s21, s21, 2
  s_add_u32 s21, s21, 64
  s_cmp_lt_u32 s30, 4
  s_cselect_b32 s31, s31, s21
  s_cmp_lt_u32 s30, 6
  s_cselect_b32 s31, s31, 96
  s_add_u32 s28, s28, s31
  v_lshrrev_b32 v30, 5, v0
  v_and_b32 v31, 31, v0
  v_lshlrev_b32 v31, 4, v31
  s_lshl_b32 s21, s3, 4
  v_add_u32 v29, s21, v30
  v_mul_u32_u24 v29, 544, v29
  v_add_u32 v29, v29, v31
  s_cmp_lt_u32 s30, 4
  s_cselect_b32 s21, 0, 0
  s_cmp_lt_u32 s30, 6
  s_cselect_b32 s21, s21, 0
  s_add_u32 s21, s21, s28
  v_add_u32 v28, s21, v30
  v_lshlrev_b32 v28, 13, v28
  v_add_u32 v28, v28, v31
  buffer_load_dwordx4 v[108:111], v28, s[16:19], s24 offen
  s_cmp_lt_u32 s30, 4
  s_cselect_b32 s21, 8, 8
  s_cmp_lt_u32 s30, 6
  s_cselect_b32 s21, s21, 4
  s_add_u32 s21, s21, s28
  v_add_u32 v28, s21, v30
  v_lshlrev_b32 v28, 13, v28
  v_add_u32 v28, v28, v31
  buffer_load_dwordx4 v[112:115], v28, s[16:19], s24 offen
  s_cmp_lt_u32 s30, 4
  s_cselect_b32 s21, 16, 2
  s_cmp_lt_u32 s30, 6
  s_cselect_b32 s21, s21, 8
  s_add_u32 s21, s21, s28
  v_add_u32 v28, s21, v30
  v_lshlrev_b32 v28, 13, v28
  v_add_u32 v28, v28, v31
  buffer_load_dwordx4 v[116:119], v28, s[16:19], s24 offen
  s_cmp_lt_u32 s30, 4
  s_cselect_b32 s21, 24, 10
  s_cmp_lt_u32 s30, 6
  s_cselect_b32 s21, s21, 12
  s_add_u32 s21, s21, s28
  v_add_u32 v28, s21, v30
  v_lshlrev_b32 v28, 13, v28
  v_add_u32 v28, v28, v31
  buffer_load_dwordx4 v[120:123], v28, s[16:19], s24 offen
  s_cmp_lt_u32 s30, 4
  s_cselect_b32 s21, 32, 16
  s_cmp_lt_u32 s30, 6
  s_cselect_b32 s21, s21, 2
  s_add_u32 s21, s21, s28
  v_add_u32 v28, s21, v30
  v_lshlrev_b32 v28, 13, v28
  v_add_u32 v28, v28, v31
  buffer_load_dwordx4 v[124:127], v28, s[16:19], s24 offen
  s_cmp_lt_u32 s30, 4
  s_cselect_b32 s21, 40, 24
  s_cmp_lt_u32 s30, 6
  s_cselect_b32 s21, s21, 6
  s_add_u32 s21, s21, s28
  v_add_u32 v28, s21, v30
  v_lshlrev_b32 v28, 13, v28
  v_add_u32 v28, v28, v31
  buffer_load_dwordx4 v[128:131], v28, s[16:19], s24 offen
  s_cmp_lt_u32 s30, 4
  s_cselect_b32 s21, 48, 18
  s_cmp_lt_u32 s30, 6
  s_cselect_b32 s21, s21, 10
  s_add_u32 s21, s21, s28
  v_add_u32 v28, s21, v30
  v_lshlrev_b32 v28, 13, v28
  v_add_u32 v28, v28, v31
  buffer_load_dwordx4 v[132:135], v28, s[16:19], s24 offen
  s_cmp_lt_u32 s30, 4
  s_cselect_b32 s21, 56, 26
  s_cmp_lt_u32 s30, 6
  s_cselect_b32 s21, s21, 14
  s_add_u32 s21, s21, s28
  v_add_u32 v28, s21, v30
  v_lshlrev_b32 v28, 13, v28
  v_add_u32 v28, v28, v31
  buffer_load_dwordx4 v[136:139], v28, s[16:19], s24 offen
  v_lshrrev_b32 v30, 5, v0
  v_and_b32 v31, 31, v0
  s_lshl_b32 s21, s3, 4
  v_add_u32 v32, 0, v30
  v_xor_b32 v33, v31, v32
  v_add_u32 v32, s21, v32
  v_lshlrev_b32 v32, 13, v32
  v_lshl_add_u32 v40, v33, 4, v32
  v_add_u32 v32, 2, v30
  v_xor_b32 v33, v31, v32
  v_add_u32 v32, s21, v32
  v_lshlrev_b32 v32, 13, v32
  v_lshl_add_u32 v41, v33, 4, v32
  v_add_u32 v32, 4, v30
  v_xor_b32 v33, v31, v32
  v_add_u32 v32, s21, v32
  v_lshlrev_b32 v32, 13, v32
  v_lshl_add_u32 v42, v33, 4, v32
  v_add_u32 v32, 6, v30
  v_xor_b32 v33, v31, v32
  v_add_u32 v32, s21, v32
  v_lshlrev_b32 v32, 13, v32
  v_lshl_add_u32 v43, v33, 4, v32
  v_add_u32 v32, 8, v30
  v_xor_b32 v33, v31, v32
  v_add_u32 v32, s21, v32
  v_lshlrev_b32 v32, 13, v32
  v_lshl_add_u32 v44, v33, 4, v32
  v_add_u32 v32, 10, v30
  v_xor_b32 v33, v31, v32
  v_add_u32 v32, s21, v32
  v_lshlrev_b32 v32, 13, v32
  v_lshl_add_u32 v45, v33, 4, v32
  v_add_u32 v32, 12, v30
  v_xor_b32 v33, v31, v32
  v_add_u32 v32, s21, v32
  v_lshlrev_b32 v32, 13, v32
  v_lshl_add_u32 v46, v33, 4, v32
  v_add_u32 v32, 14, v30
  v_xor_b32 v33, v31, v32
  v_add_u32 v32, s21, v32
  v_lshlrev_b32 v32, 13, v32
  v_lshl_add_u32 v47, v33, 4, v32
  v_and_b32 v32, 15, v0
  v_lshrrev_b32 v33, 4, v0
  v_and_b32 v34, 3, v32
  v_xor_b32 v34, v34, v33
  v_lshlrev_b32 v34, 4, v34
  v_lshl_add_u32 v34, v32, 9, v34
  s_mul_i32 s21, s3, 24576
  s_add_u32 s21, s21, 36864
  v_add_u32 v34, s21, v34
  v_lshrrev_b32 v35, 2, v32
  v_xor_b32 v36, 0, v35
  v_lshl_add_u32 v48, v36, 6, v34
  v_xor_b32 v36, 1, v35
  v_lshl_add_u32 v49, v36, 6, v34
  v_xor_b32 v36, 2, v35
  v_lshl_add_u32 v50, v36, 6, v34
  v_xor_b32 v36, 3, v35
  v_lshl_add_u32 v51, v36, 6, v34
  v_xor_b32 v36, 4, v35
  v_lshl_add_u32 v52, v36, 6, v34
  v_xor_b32 v36, 5, v35
  v_lshl_add_u32 v53, v36, 6, v34
  v_xor_b32 v36, 6, v35
  v_lshl_add_u32 v54, v36, 6, v34
  v_xor_b32 v36, 7, v35
  v_lshl_add_u32 v55, v36, 6, v34
  s_mul_i32 s29, s3, 24576
  s_add_u32 s29, s29, 36864
  s_add_u32 s35, s33, 0
  s_sub_u32 s34, s35, 7
  s_cmp_ge_u32 s35, 7
  s_cselect_b32 s35, s34, s35
  s_lshl_b32 s22, s35, 19
  s_add_u32 s22, s22, s24
  s_add_u32 m0, s29, 0
  s_nop 0
  buffer_load_dwordx4 v40, s[12:15], s22 offen lds
  s_add_u32 m0, s29, 1024
  s_nop 0
  buffer_load_dwordx4 v41, s[12:15], s22 offen lds
  s_add_u32 m0, s29, 2048
  s_nop 0
  buffer_load_dwordx4 v42, s[12:15], s22 offen lds
  s_add_u32 m0, s29, 3072
  s_nop 0
  buffer_load_dwordx4 v43, s[12:15], s22 offen lds
  s_add_u32 m0, s29, 4096
  s_nop 0
  buffer_load_dwordx4 v44, s[12:15], s22 offen lds
  s_add_u32 m0, s29, 5120
  s_nop 0
  buffer_load_dwordx4 v45, s[12:15], s22 offen lds
  s_add_u32 m0, s29, 6144
  s_nop 0
  buffer_load_dwordx4 v46, s[12:15], s22 offen lds
  s_add_u32 m0, s29, 7168
  s_nop 0
  buffer_load_dwordx4 v47, s[12:15], s22 offen lds
  s_add_u32 s35, s33, 1
  s_sub_u32 s34, s35, 7
  s_cmp_ge_u32 s35, 7
  s_cselect_b32 s35, s34, s35
  s_lshl_b32 s22, s35, 19
  s_add_u32 s22, s22, s24
  s_add_u32 m0, s29, 8192
  s_nop 0
  buffer_load_dwordx4 v40, s[12:15], s22 offen lds
  s_add_u32 m0, s29, 9216
  s_nop 0
  buffer_load_dwordx4 v41, s[12:15], s22 offen lds
  s_add_u32 m0, s29, 10240
  s_nop 0
  buffer_load_dwordx4 v42, s[12:15], s22 offen lds
  s_add_u32 m0, s29, 11264
  s_nop 0
  buffer_load_dwordx4 v43, s[12:15], s22 offen lds
  s_add_u32 m0, s29, 12288
  s_nop 0
  buffer_load_dwordx4 v44, s[12:15], s22 offen lds
  s_add_u32 m0, s29, 13312
  s_nop 0
  buffer_load_dwordx4 v45, s[12:15], s22 offen lds
  s_add_u32 m0, s29, 14336
  s_nop 0
  buffer_load_dwordx4 v46, s[12:15], s22 offen lds
  s_add_u32 m0, s29, 15360
  s_nop 0
  buffer_load_dwordx4 v47, s[12:15], s22 offen lds
  s_waitcnt vmcnt(16)
  ds_write_b128 v29, v[108:111] offset:0
  ds_write_b128 v29, v[112:115] offset:1088
  ds_write_b128 v29, v[116:119] offset:2176
  ds_write_b128 v29, v[120:123] offset:3264
  ds_write_b128 v29, v[124:127] offset:4352
  ds_write_b128 v29, v[128:131] offset:5440
  ds_write_b128 v29, v[132:135] offset:6528
  ds_write_b128 v29, v[136:139] offset:7616
  s_waitcnt lgkmcnt(0)
  s_barrier
  v_and_b32 v2, 15, v0
  v_lshrrev_b32 v3, 4, v0
  v_mul_u32_u24 v5, 544, v2
  v_lshl_add_u32 v5, v3, 4, v5
  ds_read_b128 a[0:3], v5 offset:0
  ds_read_b128 a[4:7], v5 offset:64
  ds_read_b128 a[8:11], v5 offset:128
  ds_read_b128 a[12:15], v5 offset:192
  ds_read_b128 a[16:19], v5 offset:256
  ds_read_b128 a[20:23], v5 offset:320
  ds_read_b128 a[24:27], v5 offset:384
  ds_read_b128 a[28:31], v5 offset:448
  s_waitcnt lgkmcnt(0)
  ds_read_b128 a[32:35], v5 offset:8704
  ds_read_b128 a[36:39], v5 offset:8768
  ds_read_b128 a[40:43], v5 offset:8832
  ds_read_b128 a[44:47], v5 offset:8896
  ds_read_b128 a[48:51], v5 offset:8960
  ds_read_b128 a[52:55], v5 offset:9024
  ds_read_b128 a[56:59], v5 offset:9088
  ds_read_b128 a[60:63], v5 offset:9152
  s_waitcnt lgkmcnt(0)
  ds_read_b128 a[64:67], v5 offset:17408
  ds_read_b128 a[68:71], v5 offset:17472
  ds_read_b128 a[72:75], v5 offset:17536
  ds_read_b128 a[76:79], v5 offset:17600
  ds_read_b128 a[80:83], v5 offset:17664
  ds_read_b128 a[84:87], v5 offset:17728
  ds_read_b128 a[88:91], v5 offset:17792
  ds_read_b128 a[92:95], v5 offset:17856
  s_waitcnt lgkmcnt(0)
  ds_read_b128 a[96:99], v5 offset:26112
  ds_read_b128 a[100:103], v5 offset:26176
  ds_read_b128 a[104:107], v5 offset:26240
  ds_read_b128 a[108:111], v5 offset:26304
  ds_read_b128 a[112:115], v5 offset:26368
  ds_read_b128 a[116:119], v5 offset:26432
  ds_read_b128 a[120:123], v5 offset:26496
  ds_read_b128 a[124:127], v5 offset:26560
  s_waitcnt lgkmcnt(0)
  v_lshrrev_b32 v6, 1, v3
  v_lshlrev_b32 v6, 9, v6
  v_lshl_add_u32 v6, v2, 4, v6
  v_and_b32 v7, 1, v3
  v_lshl_add_u32 v6, v7, 3, v6
  s_mul_i32 s21, s26, 401408
  s_mul_i32 s22, s27, 57344
  s_add_u32 s21, s21, s22
  s_lshl_b32 s22, s3, 10
  s_add_u32 s21, s21, s22
  s_add_u32 s30, s21, 6553600
  s_mov_b32 s31, 0x3db8aa3b
  s_add_u32 s35, s33, 2
  s_sub_u32 s34, s35, 7
  s_cmp_ge_u32 s35, 7
  s_cselect_b32 s35, s34, s35
  s_lshl_b32 s22, s35, 19
  s_add_u32 s22, s22, s24
  s_add_u32 m0, s29, 16384
  s_nop 0
  buffer_load_dwordx4 v40, s[12:15], s22 offen lds
  s_add_u32 m0, s29, 17408
  s_nop 0
  buffer_load_dwordx4 v41, s[12:15], s22 offen lds
  s_add_u32 m0, s29, 18432
  s_nop 0
  buffer_load_dwordx4 v42, s[12:15], s22 offen lds
  s_add_u32 m0, s29, 19456
  s_nop 0
  buffer_load_dwordx4 v43, s[12:15], s22 offen lds
  s_add_u32 m0, s29, 20480
  s_nop 0
  buffer_load_dwordx4 v44, s[12:15], s22 offen lds
  s_add_u32 m0, s29, 21504
  s_nop 0
  buffer_load_dwordx4 v45, s[12:15], s22 offen lds
  s_add_u32 m0, s29, 22528
  s_nop 0
  buffer_load_dwordx4 v46, s[12:15], s22 offen lds
  s_add_u32 m0, s29, 23552
  s_nop 0
  buffer_load_dwordx4 v47, s[12:15], s22 offen lds
  s_waitcnt vmcnt(16)
  ds_read_b128 v[76:79], v48 offset:0
  ds_read_b128 v[80:83], v49 offset:0
  ds_read_b128 v[84:87], v50 offset:0
  ds_read_b128 v[88:91], v51 offset:0
  ds_read_b128 v[92:95], v52 offset:0
  ds_read_b128 v[96:99], v53 offset:0
  ds_read_b128 v[100:103], v54 offset:0
  ds_read_b128 v[104:107], v55 offset:0
  s_waitcnt lgkmcnt(7)
  v_mfma_f32_16x16x32_bf16 v[60:63], v[76:79], a[0:3], 0
  v_mfma_f32_16x16x32_bf16 v[64:67], v[76:79], a[32:35], 0
  v_mfma_f32_16x16x32_bf16 v[68:71], v[76:79], a[64:67], 0
  v_mfma_f32_16x16x32_bf16 v[72:75], v[76:79], a[96:99], 0
  s_waitcnt lgkmcnt(6)
  v_mfma_f32_16x16x32_bf16 v[60:63], v[80:83], a[4:7], v[60:63]
  v_mfma_f32_16x16x32_bf16 v[64:67], v[80:83], a[36:39], v[64:67]
  v_mfma_f32_16x16x32_bf16 v[68:71], v[80:83], a[68:71], v[68:71]
  v_mfma_f32_16x16x32_bf16 v[72:75], v[80:83], a[100:103], v[72:75]
  s_waitcnt lgkmcnt(5)
  v_mfma_f32_16x16x32_bf16 v[60:63], v[84:87], a[8:11], v[60:63]
  v_mfma_f32_16x16x32_bf16 v[64:67], v[84:87], a[40:43], v[64:67]
  v_mfma_f32_16x16x32_bf16 v[68:71], v[84:87], a[72:75], v[68:71]
  v_mfma_f32_16x16x32_bf16 v[72:75], v[84:87], a[104:107], v[72:75]
  s_waitcnt lgkmcnt(4)
  v_mfma_f32_16x16x32_bf16 v[60:63], v[88:91], a[12:15], v[60:63]
  v_mfma_f32_16x16x32_bf16 v[64:67], v[88:91], a[44:47], v[64:67]
  v_mfma_f32_16x16x32_bf16 v[68:71], v[88:91], a[76:79], v[68:71]
  v_mfma_f32_16x16x32_bf16 v[72:75], v[88:91], a[108:111], v[72:75]
  s_waitcnt lgkmcnt(3)
  v_mfma_f32_16x16x32_bf16 v[60:63], v[92:95], a[16:19], v[60:63]
  v_mfma_f32_16x16x32_bf16 v[64:67], v[92:95], a[48:51], v[64:67]
  v_mfma_f32_16x16x32_bf16 v[68:71], v[92:95], a[80:83], v[68:71]
  v_mfma_f32_16x16x32_bf16 v[72:75], v[92:95], a[112:115], v[72:75]
  s_waitcnt lgkmcnt(2)
  v_mfma_f32_16x16x32_bf16 v[60:63], v[96:99], a[20:23], v[60:63]
  v_mfma_f32_16x16x32_bf16 v[64:67], v[96:99], a[52:55], v[64:67]
  v_mfma_f32_16x16x32_bf16 v[68:71], v[96:99], a[84:87], v[68:71]
  v_mfma_f32_16x16x32_bf16 v[72:75], v[96:99], a[116:119], v[72:75]
  s_waitcnt lgkmcnt(1)
  v_mfma_f32_16x16x32_bf16 v[60:63], v[100:103], a[24:27], v[60:63]
  v_mfma_f32_16x16x32_bf16 v[64:67], v[100:103], a[56:59], v[64:67]
  v_mfma_f32_16x16x32_bf16 v[68:71], v[100:103], a[88:91], v[68:71]
  v_mfma_f32_16x16x32_bf16 v[72:75], v[100:103], a[120:123], v[72:75]
  s_waitcnt lgkmcnt(0)
  v_mfma_f32_16x16x32_bf16 v[60:63], v[104:107], a[28:31], v[60:63]
  v_mfma_f32_16x16x32_bf16 v[64:67], v[104:107], a[60:63], v[64:67]
  v_mfma_f32_16x16x32_bf16 v[68:71], v[104:107], a[92:95], v[68:71]
  v_mfma_f32_16x16x32_bf16 v[72:75], v[104:107], a[124:127], v[72:75]
  s_nop 4
  v_mul_f32 v60, s31, v60
  v_mul_f32 v61, s31, v61
  v_mul_f32 v62, s31, v62
  v_mul_f32 v63, s31, v63
  v_cvt_pk_bf16_f32 v8, v60, v61
  v_cvt_pk_bf16_f32 v9, v62, v63
  s_add_u32 s36, s33, 0
  s_sub_u32 s34, s36, 7
  s_cmp_ge_u32 s36, 7
  s_cselect_b32 s36, s34, s36
  s_lshl_b32 s36, s36, 12
  s_add_u32 s22, s30, 0
  s_add_u32 s22, s22, s36
  buffer_store_dwordx2 v[8:9], v6, s[8:11], s22 offen
  v_mul_f32 v64, s31, v64
  v_mul_f32 v65, s31, v65
  v_mul_f32 v66, s31, v66
  v_mul_f32 v67, s31, v67
  v_cvt_pk_bf16_f32 v10, v64, v65
  v_cvt_pk_bf16_f32 v11, v66, v67
  s_add_u32 s22, s30, 256
  s_add_u32 s22, s22, s36
  buffer_store_dwordx2 v[10:11], v6, s[8:11], s22 offen
  v_mul_f32 v68, s31, v68
  v_mul_f32 v69, s31, v69
  v_mul_f32 v70, s31, v70
  v_mul_f32 v71, s31, v71
  v_cvt_pk_bf16_f32 v12, v68, v69
  v_cvt_pk_bf16_f32 v13, v70, v71
  s_add_u32 s22, s30, 28672
  s_add_u32 s22, s22, s36
  buffer_store_dwordx2 v[12:13], v6, s[8:11], s22 offen
  v_mul_f32 v72, s31, v72
  v_mul_f32 v73, s31, v73
  v_mul_f32 v74, s31, v74
  v_mul_f32 v75, s31, v75
  v_cvt_pk_bf16_f32 v14, v72, v73
  v_cvt_pk_bf16_f32 v15, v74, v75
  s_add_u32 s22, s30, 28928
  s_add_u32 s22, s22, s36
  buffer_store_dwordx2 v[14:15], v6, s[8:11], s22 offen
  s_add_u32 s35, s33, 3
  s_sub_u32 s34, s35, 7
  s_cmp_ge_u32 s35, 7
  s_cselect_b32 s35, s34, s35
  s_lshl_b32 s22, s35, 19
  s_add_u32 s22, s22, s24
  s_add_u32 m0, s29, 0
  s_nop 0
  buffer_load_dwordx4 v40, s[12:15], s22 offen lds
  s_add_u32 m0, s29, 1024
  s_nop 0
  buffer_load_dwordx4 v41, s[12:15], s22 offen lds
  s_add_u32 m0, s29, 2048
  s_nop 0
  buffer_load_dwordx4 v42, s[12:15], s22 offen lds
  s_add_u32 m0, s29, 3072
  s_nop 0
  buffer_load_dwordx4 v43, s[12:15], s22 offen lds
  s_add_u32 m0, s29, 4096
  s_nop 0
  buffer_load_dwordx4 v44, s[12:15], s22 offen lds
  s_add_u32 m0, s29, 5120
  s_nop 0
  buffer_load_dwordx4 v45, s[12:15], s22 offen lds
  s_add_u32 m0, s29, 6144
  s_nop 0
  buffer_load_dwordx4 v46, s[12:15], s22 offen lds
  s_add_u32 m0, s29, 7168
  s_nop 0
  buffer_load_dwordx4 v47, s[12:15], s22 offen lds
  s_waitcnt vmcnt(20)
  ds_read_b128 v[76:79], v48 offset:8192
  ds_read_b128 v[80:83], v49 offset:8192
  ds_read_b128 v[84:87], v50 offset:8192
  ds_read_b128 v[88:91], v51 offset:8192
  ds_read_b128 v[92:95], v52 offset:8192
  ds_read_b128 v[96:99], v53 offset:8192
  ds_read_b128 v[100:103], v54 offset:8192
  ds_read_b128 v[104:107], v55 offset:8192
  s_waitcnt lgkmcnt(7)
  v_mfma_f32_16x16x32_bf16 v[60:63], v[76:79], a[0:3], 0
  v_mfma_f32_16x16x32_bf16 v[64:67], v[76:79], a[32:35], 0
  v_mfma_f32_16x16x32_bf16 v[68:71], v[76:79], a[64:67], 0
  v_mfma_f32_16x16x32_bf16 v[72:75], v[76:79], a[96:99], 0
  s_waitcnt lgkmcnt(6)
  v_mfma_f32_16x16x32_bf16 v[60:63], v[80:83], a[4:7], v[60:63]
  v_mfma_f32_16x16x32_bf16 v[64:67], v[80:83], a[36:39], v[64:67]
  v_mfma_f32_16x16x32_bf16 v[68:71], v[80:83], a[68:71], v[68:71]
  v_mfma_f32_16x16x32_bf16 v[72:75], v[80:83], a[100:103], v[72:75]
  s_waitcnt lgkmcnt(5)
  v_mfma_f32_16x16x32_bf16 v[60:63], v[84:87], a[8:11], v[60:63]
  v_mfma_f32_16x16x32_bf16 v[64:67], v[84:87], a[40:43], v[64:67]
  v_mfma_f32_16x16x32_bf16 v[68:71], v[84:87], a[72:75], v[68:71]
  v_mfma_f32_16x16x32_bf16 v[72:75], v[84:87], a[104:107], v[72:75]
  s_waitcnt lgkmcnt(4)
  v_mfma_f32_16x16x32_bf16 v[60:63], v[88:91], a[12:15], v[60:63]
  v_mfma_f32_16x16x32_bf16 v[64:67], v[88:91], a[44:47], v[64:67]
  v_mfma_f32_16x16x32_bf16 v[68:71], v[88:91], a[76:79], v[68:71]
  v_mfma_f32_16x16x32_bf16 v[72:75], v[88:91], a[108:111], v[72:75]
  s_waitcnt lgkmcnt(3)
  v_mfma_f32_16x16x32_bf16 v[60:63], v[92:95], a[16:19], v[60:63]
  v_mfma_f32_16x16x32_bf16 v[64:67], v[92:95], a[48:51], v[64:67]
  v_mfma_f32_16x16x32_bf16 v[68:71], v[92:95], a[80:83], v[68:71]
  v_mfma_f32_16x16x32_bf16 v[72:75], v[92:95], a[112:115], v[72:75]
  s_waitcnt lgkmcnt(2)
  v_mfma_f32_16x16x32_bf16 v[60:63], v[96:99], a[20:23], v[60:63]
  v_mfma_f32_16x16x32_bf16 v[64:67], v[96:99], a[52:55], v[64:67]
  v_mfma_f32_16x16x32_bf16 v[68:71], v[96:99], a[84:87], v[68:71]
  v_mfma_f32_16x16x32_bf16 v[72:75], v[96:99], a[116:119], v[72:75]
  s_waitcnt lgkmcnt(1)
  v_mfma_f32_16x16x32_bf16 v[60:63], v[100:103], a[24:27], v[60:63]
  v_mfma_f32_16x16x32_bf16 v[64:67], v[100:103], a[56:59], v[64:67]
  v_mfma_f32_16x16x32_bf16 v[68:71], v[100:103], a[88:91], v[68:71]
  v_mfma_f32_16x16x32_bf16 v[72:75], v[100:103], a[120:123], v[72:75]
  s_waitcnt lgkmcnt(0)
  v_mfma_f32_16x16x32_bf16 v[60:63], v[104:107], a[28:31], v[60:63]
  v_mfma_f32_16x16x32_bf16 v[64:67], v[104:107], a[60:63], v[64:67]
  v_mfma_f32_16x16x32_bf16 v[68:71], v[104:107], a[92:95], v[68:71]
  v_mfma_f32_16x16x32_bf16 v[72:75], v[104:107], a[124:127], v[72:75]
  s_nop 4
  v_mul_f32 v60, s31, v60
  v_mul_f32 v61, s31, v61
  v_mul_f32 v62, s31, v62
  v_mul_f32 v63, s31, v63
  v_cvt_pk_bf16_f32 v8, v60, v61
  v_cvt_pk_bf16_f32 v9, v62, v63
  s_add_u32 s36, s33, 1
  s_sub_u32 s34, s36, 7
  s_cmp_ge_u32 s36, 7
  s_cselect_b32 s36, s34, s36
  s_lshl_b32 s36, s36, 12
  s_add_u32 s22, s30, 0
  s_add_u32 s22, s22, s36
  buffer_store_dwordx2 v[8:9], v6, s[8:11], s22 offen
  v_mul_f32 v64, s31, v64
  v_mul_f32 v65, s31, v65
  v_mul_f32 v66, s31, v66
  v_mul_f32 v67, s31, v67
  v_cvt_pk_bf16_f32 v10, v64, v65
  v_cvt_pk_bf16_f32 v11, v66, v67
  s_add_u32 s22, s30, 256
  s_add_u32 s22, s22, s36
  buffer_store_dwordx2 v[10:11], v6, s[8:11], s22 offen
  v_mul_f32 v68, s31, v68
  v_mul_f32 v69, s31, v69
  v_mul_f32 v70, s31, v70
  v_mul_f32 v71, s31, v71
  v_cvt_pk_bf16_f32 v12, v68, v69
  v_cvt_pk_bf16_f32 v13, v70, v71
  s_add_u32 s22, s30, 28672
  s_add_u32 s22, s22, s36
  buffer_store_dwordx2 v[12:13], v6, s[8:11], s22 offen
  v_mul_f32 v72, s31, v72
  v_mul_f32 v73, s31, v73
  v_mul_f32 v74, s31, v74
  v_mul_f32 v75, s31, v75
  v_cvt_pk_bf16_f32 v14, v72, v73
  v_cvt_pk_bf16_f32 v15, v74, v75
  s_add_u32 s22, s30, 28928
  s_add_u32 s22, s22, s36
  buffer_store_dwordx2 v[14:15], v6, s[8:11], s22 offen
  s_add_u32 s35, s33, 4
  s_sub_u32 s34, s35, 7
  s_cmp_ge_u32 s35, 7
  s_cselect_b32 s35, s34, s35
  s_lshl_b32 s22, s35, 19
  s_add_u32 s22, s22, s24
  s_add_u32 m0, s29, 8192
  s_nop 0
  buffer_load_dwordx4 v40, s[12:15], s22 offen lds
  s_add_u32 m0, s29, 9216
  s_nop 0
  buffer_load_dwordx4 v41, s[12:15], s22 offen lds
  s_add_u32 m0, s29, 10240
  s_nop 0
  buffer_load_dwordx4 v42, s[12:15], s22 offen lds
  s_add_u32 m0, s29, 11264
  s_nop 0
  buffer_load_dwordx4 v43, s[12:15], s22 offen lds
  s_add_u32 m0, s29, 12288
  s_nop 0
  buffer_load_dwordx4 v44, s[12:15], s22 offen lds
  s_add_u32 m0, s29, 13312
  s_nop 0
  buffer_load_dwordx4 v45, s[12:15], s22 offen lds
  s_add_u32 m0, s29, 14336
  s_nop 0
  buffer_load_dwordx4 v46, s[12:15], s22 offen lds
  s_add_u32 m0, s29, 15360
  s_nop 0
  buffer_load_dwordx4 v47, s[12:15], s22 offen lds
  s_waitcnt vmcnt(20)
  ds_read_b128 v[76:79], v48 offset:16384
  ds_read_b128 v[80:83], v49 offset:16384
  ds_read_b128 v[84:87], v50 offset:16384
  ds_read_b128 v[88:91], v51 offset:16384
  ds_read_b128 v[92:95], v52 offset:16384
  ds_read_b128 v[96:99], v53 offset:16384
  ds_read_b128 v[100:103], v54 offset:16384
  ds_read_b128 v[104:107], v55 offset:16384
  s_waitcnt lgkmcnt(7)
  v_mfma_f32_16x16x32_bf16 v[60:63], v[76:79], a[0:3], 0
  v_mfma_f32_16x16x32_bf16 v[64:67], v[76:79], a[32:35], 0
  v_mfma_f32_16x16x32_bf16 v[68:71], v[76:79], a[64:67], 0
  v_mfma_f32_16x16x32_bf16 v[72:75], v[76:79], a[96:99], 0
  s_waitcnt lgkmcnt(6)
  v_mfma_f32_16x16x32_bf16 v[60:63], v[80:83], a[4:7], v[60:63]
  v_mfma_f32_16x16x32_bf16 v[64:67], v[80:83], a[36:39], v[64:67]
  v_mfma_f32_16x16x32_bf16 v[68:71], v[80:83], a[68:71], v[68:71]
  v_mfma_f32_16x16x32_bf16 v[72:75], v[80:83], a[100:103], v[72:75]
  s_waitcnt lgkmcnt(5)
  v_mfma_f32_16x16x32_bf16 v[60:63], v[84:87], a[8:11], v[60:63]
  v_mfma_f32_16x16x32_bf16 v[64:67], v[84:87], a[40:43], v[64:67]
  v_mfma_f32_16x16x32_bf16 v[68:71], v[84:87], a[72:75], v[68:71]
  v_mfma_f32_16x16x32_bf16 v[72:75], v[84:87], a[104:107], v[72:75]
  s_waitcnt lgkmcnt(4)
  v_mfma_f32_16x16x32_bf16 v[60:63], v[88:91], a[12:15], v[60:63]
  v_mfma_f32_16x16x32_bf16 v[64:67], v[88:91], a[44:47], v[64:67]
  v_mfma_f32_16x16x32_bf16 v[68:71], v[88:91], a[76:79], v[68:71]
  v_mfma_f32_16x16x32_bf16 v[72:75], v[88:91], a[108:111], v[72:75]
  s_waitcnt lgkmcnt(3)
  v_mfma_f32_16x16x32_bf16 v[60:63], v[92:95], a[16:19], v[60:63]
  v_mfma_f32_16x16x32_bf16 v[64:67], v[92:95], a[48:51], v[64:67]
  v_mfma_f32_16x16x32_bf16 v[68:71], v[92:95], a[80:83], v[68:71]
  v_mfma_f32_16x16x32_bf16 v[72:75], v[92:95], a[112:115], v[72:75]
  s_waitcnt lgkmcnt(2)
  v_mfma_f32_16x16x32_bf16 v[60:63], v[96:99], a[20:23], v[60:63]
  v_mfma_f32_16x16x32_bf16 v[64:67], v[96:99], a[52:55], v[64:67]
  v_mfma_f32_16x16x32_bf16 v[68:71], v[96:99], a[84:87], v[68:71]
  v_mfma_f32_16x16x32_bf16 v[72:75], v[96:99], a[116:119], v[72:75]
  s_waitcnt lgkmcnt(1)
  v_mfma_f32_16x16x32_bf16 v[60:63], v[100:103], a[24:27], v[60:63]
  v_mfma_f32_16x16x32_bf16 v[64:67], v[100:103], a[56:59], v[64:67]
  v_mfma_f32_16x16x32_bf16 v[68:71], v[100:103], a[88:91], v[68:71]
  v_mfma_f32_16x16x32_bf16 v[72:75], v[100:103], a[120:123], v[72:75]
  s_waitcnt lgkmcnt(0)
  v_mfma_f32_16x16x32_bf16 v[60:63], v[104:107], a[28:31], v[60:63]
  v_mfma_f32_16x16x32_bf16 v[64:67], v[104:107], a[60:63], v[64:67]
  v_mfma_f32_16x16x32_bf16 v[68:71], v[104:107], a[92:95], v[68:71]
  v_mfma_f32_16x16x32_bf16 v[72:75], v[104:107], a[124:127], v[72:75]
  s_nop 4
  v_mul_f32 v60, s31, v60
  v_mul_f32 v61, s31, v61
  v_mul_f32 v62, s31, v62
  v_mul_f32 v63, s31, v63
  v_cvt_pk_bf16_f32 v8, v60, v61
  v_cvt_pk_bf16_f32 v9, v62, v63
  s_add_u32 s36, s33, 2
  s_sub_u32 s34, s36, 7
  s_cmp_ge_u32 s36, 7
  s_cselect_b32 s36, s34, s36
  s_lshl_b32 s36, s36, 12
  s_add_u32 s22, s30, 0
  s_add_u32 s22, s22, s36
  buffer_store_dwordx2 v[8:9], v6, s[8:11], s22 offen
  v_mul_f32 v64, s31, v64
  v_mul_f32 v65, s31, v65
  v_mul_f32 v66, s31, v66
  v_mul_f32 v67, s31, v67
  v_cvt_pk_bf16_f32 v10, v64, v65
  v_cvt_pk_bf16_f32 v11, v66, v67
  s_add_u32 s22, s30, 256
  s_add_u32 s22, s22, s36
  buffer_store_dwordx2 v[10:11], v6, s[8:11], s22 offen
  v_mul_f32 v68, s31, v68
  v_mul_f32 v69, s31, v69
  v_mul_f32 v70, s31, v70
  v_mul_f32 v71, s31, v71
  v_cvt_pk_bf16_f32 v12, v68, v69
  v_cvt_pk_bf16_f32 v13, v70, v71
  s_add_u32 s22, s30, 28672
  s_add_u32 s22, s22, s36
  buffer_store_dwordx2 v[12:13], v6, s[8:11], s22 offen
  v_mul_f32 v72, s31, v72
  v_mul_f32 v73, s31, v73
  v_mul_f32 v74, s31, v74
  v_mul_f32 v75, s31, v75
  v_cvt_pk_bf16_f32 v14, v72, v73
  v_cvt_pk_bf16_f32 v15, v74, v75
  s_add_u32 s22, s30, 28928
  s_add_u32 s22, s22, s36
  buffer_store_dwordx2 v[14:15], v6, s[8:11], s22 offen
  s_add_u32 s35, s33, 5
  s_sub_u32 s34, s35, 7
  s_cmp_ge_u32 s35, 7
  s_cselect_b32 s35, s34, s35
  s_lshl_b32 s22, s35, 19
  s_add_u32 s22, s22, s24
  s_add_u32 m0, s29, 16384
  s_nop 0
  buffer_load_dwordx4 v40, s[12:15], s22 offen lds
  s_add_u32 m0, s29, 17408
  s_nop 0
  buffer_load_dwordx4 v41, s[12:15], s22 offen lds
  s_add_u32 m0, s29, 18432
  s_nop 0
  buffer_load_dwordx4 v42, s[12:15], s22 offen lds
  s_add_u32 m0, s29, 19456
  s_nop 0
  buffer_load_dwordx4 v43, s[12:15], s22 offen lds
  s_add_u32 m0, s29, 20480
  s_nop 0
  buffer_load_dwordx4 v44, s[12:15], s22 offen lds
  s_add_u32 m0, s29, 21504
  s_nop 0
  buffer_load_dwordx4 v45, s[12:15], s22 offen lds
  s_add_u32 m0, s29, 22528
  s_nop 0
  buffer_load_dwordx4 v46, s[12:15], s22 offen lds
  s_add_u32 m0, s29, 23552
  s_nop 0
  buffer_load_dwordx4 v47, s[12:15], s22 offen lds
  s_waitcnt vmcnt(20)
  ds_read_b128 v[76:79], v48 offset:0
  ds_read_b128 v[80:83], v49 offset:0
  ds_read_b128 v[84:87], v50 offset:0
  ds_read_b128 v[88:91], v51 offset:0
  ds_read_b128 v[92:95], v52 offset:0
  ds_read_b128 v[96:99], v53 offset:0
  ds_read_b128 v[100:103], v54 offset:0
  ds_read_b128 v[104:107], v55 offset:0
  s_waitcnt lgkmcnt(7)
  v_mfma_f32_16x16x32_bf16 v[60:63], v[76:79], a[0:3], 0
  v_mfma_f32_16x16x32_bf16 v[64:67], v[76:79], a[32:35], 0
  v_mfma_f32_16x16x32_bf16 v[68:71], v[76:79], a[64:67], 0
  v_mfma_f32_16x16x32_bf16 v[72:75], v[76:79], a[96:99], 0
  s_waitcnt lgkmcnt(6)
  v_mfma_f32_16x16x32_bf16 v[60:63], v[80:83], a[4:7], v[60:63]
  v_mfma_f32_16x16x32_bf16 v[64:67], v[80:83], a[36:39], v[64:67]
  v_mfma_f32_16x16x32_bf16 v[68:71], v[80:83], a[68:71], v[68:71]
  v_mfma_f32_16x16x32_bf16 v[72:75], v[80:83], a[100:103], v[72:75]
  s_waitcnt lgkmcnt(5)
  v_mfma_f32_16x16x32_bf16 v[60:63], v[84:87], a[8:11], v[60:63]
  v_mfma_f32_16x16x32_bf16 v[64:67], v[84:87], a[40:43], v[64:67]
  v_mfma_f32_16x16x32_bf16 v[68:71], v[84:87], a[72:75], v[68:71]
  v_mfma_f32_16x16x32_bf16 v[72:75], v[84:87], a[104:107], v[72:75]
  s_waitcnt lgkmcnt(4)
  v_mfma_f32_16x16x32_bf16 v[60:63], v[88:91], a[12:15], v[60:63]
  v_mfma_f32_16x16x32_bf16 v[64:67], v[88:91], a[44:47], v[64:67]
  v_mfma_f32_16x16x32_bf16 v[68:71], v[88:91], a[76:79], v[68:71]
  v_mfma_f32_16x16x32_bf16 v[72:75], v[88:91], a[108:111], v[72:75]
  s_waitcnt lgkmcnt(3)
  v_mfma_f32_16x16x32_bf16 v[60:63], v[92:95], a[16:19], v[60:63]
  v_mfma_f32_16x16x32_bf16 v[64:67], v[92:95], a[48:51], v[64:67]
  v_mfma_f32_16x16x32_bf16 v[68:71], v[92:95], a[80:83], v[68:71]
  v_mfma_f32_16x16x32_bf16 v[72:75], v[92:95], a[112:115], v[72:75]
  s_waitcnt lgkmcnt(2)
  v_mfma_f32_16x16x32_bf16 v[60:63], v[96:99], a[20:23], v[60:63]
  v_mfma_f32_16x16x32_bf16 v[64:67], v[96:99], a[52:55], v[64:67]
  v_mfma_f32_16x16x32_bf16 v[68:71], v[96:99], a[84:87], v[68:71]
  v_mfma_f32_16x16x32_bf16 v[72:75], v[96:99], a[116:119], v[72:75]
  s_waitcnt lgkmcnt(1)
  v_mfma_f32_16x16x32_bf16 v[60:63], v[100:103], a[24:27], v[60:63]
  v_mfma_f32_16x16x32_bf16 v[64:67], v[100:103], a[56:59], v[64:67]
  v_mfma_f32_16x16x32_bf16 v[68:71], v[100:103], a[88:91], v[68:71]
  v_mfma_f32_16x16x32_bf16 v[72:75], v[100:103], a[120:123], v[72:75]
  s_waitcnt lgkmcnt(0)
  v_mfma_f32_16x16x32_bf16 v[60:63], v[104:107], a[28:31], v[60:63]
  v_mfma_f32_16x16x32_bf16 v[64:67], v[104:107], a[60:63], v[64:67]
  v_mfma_f32_16x16x32_bf16 v[68:71], v[104:107], a[92:95], v[68:71]
  v_mfma_f32_16x16x32_bf16 v[72:75], v[104:107], a[124:127], v[72:75]
  s_nop 4
  v_mul_f32 v60, s31, v60
  v_mul_f32 v61, s31, v61
  v_mul_f32 v62, s31, v62
  v_mul_f32 v63, s31, v63
  v_cvt_pk_bf16_f32 v8, v60, v61
  v_cvt_pk_bf16_f32 v9, v62, v63
  s_add_u32 s36, s33, 3
  s_sub_u32 s34, s36, 7
  s_cmp_ge_u32 s36, 7
  s_cselect_b32 s36, s34, s36
  s_lshl_b32 s36, s36, 12
  s_add_u32 s22, s30, 0
  s_add_u32 s22, s22, s36
  buffer_store_dwordx2 v[8:9], v6, s[8:11], s22 offen
  v_mul_f32 v64, s31, v64
  v_mul_f32 v65, s31, v65
  v_mul_f32 v66, s31, v66
  v_mul_f32 v67, s31, v67
  v_cvt_pk_bf16_f32 v10, v64, v65
  v_cvt_pk_bf16_f32 v11, v66, v67
  s_add_u32 s22, s30, 256
  s_add_u32 s22, s22, s36
  buffer_store_dwordx2 v[10:11], v6, s[8:11], s22 offen
  v_mul_f32 v68, s31, v68
  v_mul_f32 v69, s31, v69
  v_mul_f32 v70, s31, v70
  v_mul_f32 v71, s31, v71
  v_cvt_pk_bf16_f32 v12, v68, v69
  v_cvt_pk_bf16_f32 v13, v70, v71
  s_add_u32 s22, s30, 28672
  s_add_u32 s22, s22, s36
  buffer_store_dwordx2 v[12:13], v6, s[8:11], s22 offen
  v_mul_f32 v72, s31, v72
  v_mul_f32 v73, s31, v73
  v_mul_f32 v74, s31, v74
  v_mul_f32 v75, s31, v75
  v_cvt_pk_bf16_f32 v14, v72, v73
  v_cvt_pk_bf16_f32 v15, v74, v75
  s_add_u32 s22, s30, 28928
  s_add_u32 s22, s22, s36
  buffer_store_dwordx2 v[14:15], v6, s[8:11], s22 offen
  s_add_u32 s35, s33, 6
  s_sub_u32 s34, s35, 7
  s_cmp_ge_u32 s35, 7
  s_cselect_b32 s35, s34, s35
  s_lshl_b32 s22, s35, 19
  s_add_u32 s22, s22, s24
  s_add_u32 m0, s29, 0
  s_nop 0
  buffer_load_dwordx4 v40, s[12:15], s22 offen lds
  s_add_u32 m0, s29, 1024
  s_nop 0
  buffer_load_dwordx4 v41, s[12:15], s22 offen lds
  s_add_u32 m0, s29, 2048
  s_nop 0
  buffer_load_dwordx4 v42, s[12:15], s22 offen lds
  s_add_u32 m0, s29, 3072
  s_nop 0
  buffer_load_dwordx4 v43, s[12:15], s22 offen lds
  s_add_u32 m0, s29, 4096
  s_nop 0
  buffer_load_dwordx4 v44, s[12:15], s22 offen lds
  s_add_u32 m0, s29, 5120
  s_nop 0
  buffer_load_dwordx4 v45, s[12:15], s22 offen lds
  s_add_u32 m0, s29, 6144
  s_nop 0
  buffer_load_dwordx4 v46, s[12:15], s22 offen lds
  s_add_u32 m0, s29, 7168
  s_nop 0
  buffer_load_dwordx4 v47, s[12:15], s22 offen lds
  s_waitcnt vmcnt(20)
  ds_read_b128 v[76:79], v48 offset:8192
  ds_read_b128 v[80:83], v49 offset:8192
  ds_read_b128 v[84:87], v50 offset:8192
  ds_read_b128 v[88:91], v51 offset:8192
  ds_read_b128 v[92:95], v52 offset:8192
  ds_read_b128 v[96:99], v53 offset:8192
  ds_read_b128 v[100:103], v54 offset:8192
  ds_read_b128 v[104:107], v55 offset:8192
  s_waitcnt lgkmcnt(7)
  v_mfma_f32_16x16x32_bf16 v[60:63], v[76:79], a[0:3], 0
  v_mfma_f32_16x16x32_bf16 v[64:67], v[76:79], a[32:35], 0
  v_mfma_f32_16x16x32_bf16 v[68:71], v[76:79], a[64:67], 0
  v_mfma_f32_16x16x32_bf16 v[72:75], v[76:79], a[96:99], 0
  s_waitcnt lgkmcnt(6)
  v_mfma_f32_16x16x32_bf16 v[60:63], v[80:83], a[4:7], v[60:63]
  v_mfma_f32_16x16x32_bf16 v[64:67], v[80:83], a[36:39], v[64:67]
  v_mfma_f32_16x16x32_bf16 v[68:71], v[80:83], a[68:71], v[68:71]
  v_mfma_f32_16x16x32_bf16 v[72:75], v[80:83], a[100:103], v[72:75]
  s_waitcnt lgkmcnt(5)
  v_mfma_f32_16x16x32_bf16 v[60:63], v[84:87], a[8:11], v[60:63]
  v_mfma_f32_16x16x32_bf16 v[64:67], v[84:87], a[40:43], v[64:67]
  v_mfma_f32_16x16x32_bf16 v[68:71], v[84:87], a[72:75], v[68:71]
  v_mfma_f32_16x16x32_bf16 v[72:75], v[84:87], a[104:107], v[72:75]
  s_waitcnt lgkmcnt(4)
  v_mfma_f32_16x16x32_bf16 v[60:63], v[88:91], a[12:15], v[60:63]
  v_mfma_f32_16x16x32_bf16 v[64:67], v[88:91], a[44:47], v[64:67]
  v_mfma_f32_16x16x32_bf16 v[68:71], v[88:91], a[76:79], v[68:71]
  v_mfma_f32_16x16x32_bf16 v[72:75], v[88:91], a[108:111], v[72:75]
  s_waitcnt lgkmcnt(3)
  v_mfma_f32_16x16x32_bf16 v[60:63], v[92:95], a[16:19], v[60:63]
  v_mfma_f32_16x16x32_bf16 v[64:67], v[92:95], a[48:51], v[64:67]
  v_mfma_f32_16x16x32_bf16 v[68:71], v[92:95], a[80:83], v[68:71]
  v_mfma_f32_16x16x32_bf16 v[72:75], v[92:95], a[112:115], v[72:75]
  s_waitcnt lgkmcnt(2)
  v_mfma_f32_16x16x32_bf16 v[60:63], v[96:99], a[20:23], v[60:63]
  v_mfma_f32_16x16x32_bf16 v[64:67], v[96:99], a[52:55], v[64:67]
  v_mfma_f32_16x16x32_bf16 v[68:71], v[96:99], a[84:87], v[68:71]
  v_mfma_f32_16x16x32_bf16 v[72:75], v[96:99], a[116:119], v[72:75]
  s_waitcnt lgkmcnt(1)
  v_mfma_f32_16x16x32_bf16 v[60:63], v[100:103], a[24:27], v[60:63]
  v_mfma_f32_16x16x32_bf16 v[64:67], v[100:103], a[56:59], v[64:67]
  v_mfma_f32_16x16x32_bf16 v[68:71], v[100:103], a[88:91], v[68:71]
  v_mfma_f32_16x16x32_bf16 v[72:75], v[100:103], a[120:123], v[72:75]
  s_waitcnt lgkmcnt(0)
  v_mfma_f32_16x16x32_bf16 v[60:63], v[104:107], a[28:31], v[60:63]
  v_mfma_f32_16x16x32_bf16 v[64:67], v[104:107], a[60:63], v[64:67]
  v_mfma_f32_16x16x32_bf16 v[68:71], v[104:107], a[92:95], v[68:71]
  v_mfma_f32_16x16x32_bf16 v[72:75], v[104:107], a[124:127], v[72:75]
  s_nop 4
  v_mul_f32 v60, s31, v60
  v_mul_f32 v61, s31, v61
  v_mul_f32 v62, s31, v62
  v_mul_f32 v63, s31, v63
  v_cvt_pk_bf16_f32 v8, v60, v61
  v_cvt_pk_bf16_f32 v9, v62, v63
  s_add_u32 s36, s33, 4
  s_sub_u32 s34, s36, 7
  s_cmp_ge_u32 s36, 7
  s_cselect_b32 s36, s34, s36
  s_lshl_b32 s36, s36, 12
  s_add_u32 s22, s30, 0
  s_add_u32 s22, s22, s36
  buffer_store_dwordx2 v[8:9], v6, s[8:11], s22 offen
  v_mul_f32 v64, s31, v64
  v_mul_f32 v65, s31, v65
  v_mul_f32 v66, s31, v66
  v_mul_f32 v67, s31, v67
  v_cvt_pk_bf16_f32 v10, v64, v65
  v_cvt_pk_bf16_f32 v11, v66, v67
  s_add_u32 s22, s30, 256
  s_add_u32 s22, s22, s36
  buffer_store_dwordx2 v[10:11], v6, s[8:11], s22 offen
  v_mul_f32 v68, s31, v68
  v_mul_f32 v69, s31, v69
  v_mul_f32 v70, s31, v70
  v_mul_f32 v71, s31, v71
  v_cvt_pk_bf16_f32 v12, v68, v69
  v_cvt_pk_bf16_f32 v13, v70, v71
  s_add_u32 s22, s30, 28672
  s_add_u32 s22, s22, s36
  buffer_store_dwordx2 v[12:13], v6, s[8:11], s22 offen
  v_mul_f32 v72, s31, v72
  v_mul_f32 v73, s31, v73
  v_mul_f32 v74, s31, v74
  v_mul_f32 v75, s31, v75
  v_cvt_pk_bf16_f32 v14, v72, v73
  v_cvt_pk_bf16_f32 v15, v74, v75
  s_add_u32 s22, s30, 28928
  s_add_u32 s22, s22, s36
  buffer_store_dwordx2 v[14:15], v6, s[8:11], s22 offen
  s_waitcnt vmcnt(12)
  ds_read_b128 v[76:79], v48 offset:16384
  ds_read_b128 v[80:83], v49 offset:16384
  ds_read_b128 v[84:87], v50 offset:16384
  ds_read_b128 v[88:91], v51 offset:16384
  ds_read_b128 v[92:95], v52 offset:16384
  ds_read_b128 v[96:99], v53 offset:16384
  ds_read_b128 v[100:103], v54 offset:16384
  ds_read_b128 v[104:107], v55 offset:16384
  s_waitcnt lgkmcnt(7)
  v_mfma_f32_16x16x32_bf16 v[60:63], v[76:79], a[0:3], 0
  v_mfma_f32_16x16x32_bf16 v[64:67], v[76:79], a[32:35], 0
  v_mfma_f32_16x16x32_bf16 v[68:71], v[76:79], a[64:67], 0
  v_mfma_f32_16x16x32_bf16 v[72:75], v[76:79], a[96:99], 0
  s_waitcnt lgkmcnt(6)
  v_mfma_f32_16x16x32_bf16 v[60:63], v[80:83], a[4:7], v[60:63]
  v_mfma_f32_16x16x32_bf16 v[64:67], v[80:83], a[36:39], v[64:67]
  v_mfma_f32_16x16x32_bf16 v[68:71], v[80:83], a[68:71], v[68:71]
  v_mfma_f32_16x16x32_bf16 v[72:75], v[80:83], a[100:103], v[72:75]
  s_waitcnt lgkmcnt(5)
  v_mfma_f32_16x16x32_bf16 v[60:63], v[84:87], a[8:11], v[60:63]
  v_mfma_f32_16x16x32_bf16 v[64:67], v[84:87], a[40:43], v[64:67]
  v_mfma_f32_16x16x32_bf16 v[68:71], v[84:87], a[72:75], v[68:71]
  v_mfma_f32_16x16x32_bf16 v[72:75], v[84:87], a[104:107], v[72:75]
  s_waitcnt lgkmcnt(4)
  v_mfma_f32_16x16x32_bf16 v[60:63], v[88:91], a[12:15], v[60:63]
  v_mfma_f32_16x16x32_bf16 v[64:67], v[88:91], a[44:47], v[64:67]
  v_mfma_f32_16x16x32_bf16 v[68:71], v[88:91], a[76:79], v[68:71]
  v_mfma_f32_16x16x32_bf16 v[72:75], v[88:91], a[108:111], v[72:75]
  s_waitcnt lgkmcnt(3)
  v_mfma_f32_16x16x32_bf16 v[60:63], v[92:95], a[16:19], v[60:63]
  v_mfma_f32_16x16x32_bf16 v[64:67], v[92:95], a[48:51], v[64:67]
  v_mfma_f32_16x16x32_bf16 v[68:71], v[92:95], a[80:83], v[68:71]
  v_mfma_f32_16x16x32_bf16 v[72:75], v[92:95], a[112:115], v[72:75]
  s_waitcnt lgkmcnt(2)
  v_mfma_f32_16x16x32_bf16 v[60:63], v[96:99], a[20:23], v[60:63]
  v_mfma_f32_16x16x32_bf16 v[64:67], v[96:99], a[52:55], v[64:67]
  v_mfma_f32_16x16x32_bf16 v[68:71], v[96:99], a[84:87], v[68:71]
  v_mfma_f32_16x16x32_bf16 v[72:75], v[96:99], a[116:119], v[72:75]
  s_waitcnt lgkmcnt(1)
  v_mfma_f32_16x16x32_bf16 v[60:63], v[100:103], a[24:27], v[60:63]
  v_mfma_f32_16x16x32_bf16 v[64:67], v[100:103], a[56:59], v[64:67]
  v_mfma_f32_16x16x32_bf16 v[68:71], v[100:103], a[88:91], v[68:71]
  v_mfma_f32_16x16x32_bf16 v[72:75], v[100:103], a[120:123], v[72:75]
  s_waitcnt lgkmcnt(0)
  v_mfma_f32_16x16x32_bf16 v[60:63], v[104:107], a[28:31], v[60:63]
  v_mfma_f32_16x16x32_bf16 v[64:67], v[104:107], a[60:63], v[64:67]
  v_mfma_f32_16x16x32_bf16 v[68:71], v[104:107], a[92:95], v[68:71]
  v_mfma_f32_16x16x32_bf16 v[72:75], v[104:107], a[124:127], v[72:75]
  s_nop 4
  v_mul_f32 v60, s31, v60
  v_mul_f32 v61, s31, v61
  v_mul_f32 v62, s31, v62
  v_mul_f32 v63, s31, v63
  v_cvt_pk_bf16_f32 v8, v60, v61
  v_cvt_pk_bf16_f32 v9, v62, v63
  s_add_u32 s36, s33, 5
  s_sub_u32 s34, s36, 7
  s_cmp_ge_u32 s36, 7
  s_cselect_b32 s36, s34, s36
  s_lshl_b32 s36, s36, 12
  s_add_u32 s22, s30, 0
  s_add_u32 s22, s22, s36
  buffer_store_dwordx2 v[8:9], v6, s[8:11], s22 offen
  v_mul_f32 v64, s31, v64
  v_mul_f32 v65, s31, v65
  v_mul_f32 v66, s31, v66
  v_mul_f32 v67, s31, v67
  v_cvt_pk_bf16_f32 v10, v64, v65
  v_cvt_pk_bf16_f32 v11, v66, v67
  s_add_u32 s22, s30, 256
  s_add_u32 s22, s22, s36
  buffer_store_dwordx2 v[10:11], v6, s[8:11], s22 offen
  v_mul_f32 v68, s31, v68
  v_mul_f32 v69, s31, v69
  v_mul_f32 v70, s31, v70
  v_mul_f32 v71, s31, v71
  v_cvt_pk_bf16_f32 v12, v68, v69
  v_cvt_pk_bf16_f32 v13, v70, v71
  s_add_u32 s22, s30, 28672
  s_add_u32 s22, s22, s36
  buffer_store_dwordx2 v[12:13], v6, s[8:11], s22 offen
  v_mul_f32 v72, s31, v72
  v_mul_f32 v73, s31, v73
  v_mul_f32 v74, s31, v74
  v_mul_f32 v75, s31, v75
  v_cvt_pk_bf16_f32 v14, v72, v73
  v_cvt_pk_bf16_f32 v15, v74, v75
  s_add_u32 s22, s30, 28928
  s_add_u32 s22, s22, s36
  buffer_store_dwordx2 v[14:15], v6, s[8:11], s22 offen
  s_waitcnt vmcnt(4)
  ds_read_b128 v[76:79], v48 offset:0
  ds_read_b128 v[80:83], v49 offset:0
  ds_read_b128 v[84:87], v50 offset:0
  ds_read_b128 v[88:91], v51 offset:0
  ds_read_b128 v[92:95], v52 offset:0
  ds_read_b128 v[96:99], v53 offset:0
  ds_read_b128 v[100:103], v54 offset:0
  ds_read_b128 v[104:107], v55 offset:0
  s_waitcnt lgkmcnt(7)
  v_mfma_f32_16x16x32_bf16 v[60:63], v[76:79], a[0:3], 0
  v_mfma_f32_16x16x32_bf16 v[64:67], v[76:79], a[32:35], 0
  v_mfma_f32_16x16x32_bf16 v[68:71], v[76:79], a[64:67], 0
  v_mfma_f32_16x16x32_bf16 v[72:75], v[76:79], a[96:99], 0
  s_waitcnt lgkmcnt(6)
  v_mfma_f32_16x16x32_bf16 v[60:63], v[80:83], a[4:7], v[60:63]
  v_mfma_f32_16x16x32_bf16 v[64:67], v[80:83], a[36:39], v[64:67]
  v_mfma_f32_16x16x32_bf16 v[68:71], v[80:83], a[68:71], v[68:71]
  v_mfma_f32_16x16x32_bf16 v[72:75], v[80:83], a[100:103], v[72:75]
  s_waitcnt lgkmcnt(5)
  v_mfma_f32_16x16x32_bf16 v[60:63], v[84:87], a[8:11], v[60:63]
  v_mfma_f32_16x16x32_bf16 v[64:67], v[84:87], a[40:43], v[64:67]
  v_mfma_f32_16x16x32_bf16 v[68:71], v[84:87], a[72:75], v[68:71]
  v_mfma_f32_16x16x32_bf16 v[72:75], v[84:87], a[104:107], v[72:75]
  s_waitcnt lgkmcnt(4)
  v_mfma_f32_16x16x32_bf16 v[60:63], v[88:91], a[12:15], v[60:63]
  v_mfma_f32_16x16x32_bf16 v[64:67], v[88:91], a[44:47], v[64:67]
  v_mfma_f32_16x16x32_bf16 v[68:71], v[88:91], a[76:79], v[68:71]
  v_mfma_f32_16x16x32_bf16 v[72:75], v[88:91], a[108:111], v[72:75]
  s_waitcnt lgkmcnt(3)
  v_mfma_f32_16x16x32_bf16 v[60:63], v[92:95], a[16:19], v[60:63]
  v_mfma_f32_16x16x32_bf16 v[64:67], v[92:95], a[48:51], v[64:67]
  v_mfma_f32_16x16x32_bf16 v[68:71], v[92:95], a[80:83], v[68:71]
  v_mfma_f32_16x16x32_bf16 v[72:75], v[92:95], a[112:115], v[72:75]
  s_waitcnt lgkmcnt(2)
  v_mfma_f32_16x16x32_bf16 v[60:63], v[96:99], a[20:23], v[60:63]
  v_mfma_f32_16x16x32_bf16 v[64:67], v[96:99], a[52:55], v[64:67]
  v_mfma_f32_16x16x32_bf16 v[68:71], v[96:99], a[84:87], v[68:71]
  v_mfma_f32_16x16x32_bf16 v[72:75], v[96:99], a[116:119], v[72:75]
  s_waitcnt lgkmcnt(1)
  v_mfma_f32_16x16x32_bf16 v[60:63], v[100:103], a[24:27], v[60:63]
  v_mfma_f32_16x16x32_bf16 v[64:67], v[100:103], a[56:59], v[64:67]
  v_mfma_f32_16x16x32_bf16 v[68:71], v[100:103], a[88:91], v[68:71]
  v_mfma_f32_16x16x32_bf16 v[72:75], v[100:103], a[120:123], v[72:75]
  s_waitcnt lgkmcnt(0)
  v_mfma_f32_16x16x32_bf16 v[60:63], v[104:107], a[28:31], v[60:63]
  v_mfma_f32_16x16x32_bf16 v[64:67], v[104:107], a[60:63], v[64:67]
  v_mfma_f32_16x16x32_bf16 v[68:71], v[104:107], a[92:95], v[68:71]
  v_mfma_f32_16x16x32_bf16 v[72:75], v[104:107], a[124:127], v[72:75]
  s_nop 4
  v_mul_f32 v60, s31, v60
  v_mul_f32 v61, s31, v61
  v_mul_f32 v62, s31, v62
  v_mul_f32 v63, s31, v63
  v_cvt_pk_bf16_f32 v8, v60, v61
  v_cvt_pk_bf16_f32 v9, v62, v63
  s_add_u32 s36, s33, 6
  s_sub_u32 s34, s36, 7
  s_cmp_ge_u32 s36, 7
  s_cselect_b32 s36, s34, s36
  s_lshl_b32 s36, s36, 12
  s_add_u32 s22, s30, 0
  s_add_u32 s22, s22, s36
  buffer_store_dwordx2 v[8:9], v6, s[8:11], s22 offen
  v_mul_f32 v64, s31, v64
  v_mul_f32 v65, s31, v65
  v_mul_f32 v66, s31, v66
  v_mul_f32 v67, s31, v67
  v_cvt_pk_bf16_f32 v10, v64, v65
  v_cvt_pk_bf16_f32 v11, v66, v67
  s_add_u32 s22, s30, 256
  s_add_u32 s22, s22, s36
  buffer_store_dwordx2 v[10:11], v6, s[8:11], s22 offen
  v_mul_f32 v68, s31, v68
  v_mul_f32 v69, s31, v69
  v_mul_f32 v70, s31, v70
  v_mul_f32 v71, s31, v71
  v_cvt_pk_bf16_f32 v12, v68, v69
  v_cvt_pk_bf16_f32 v13, v70, v71
  s_add_u32 s22, s30, 28672
  s_add_u32 s22, s22, s36
  buffer_store_dwordx2 v[12:13], v6, s[8:11], s22 offen
  v_mul_f32 v72, s31, v72
  v_mul_f32 v73, s31, v73
  v_mul_f32 v74, s31, v74
  v_mul_f32 v75, s31, v75
  v_cvt_pk_bf16_f32 v14, v72, v73
  v_cvt_pk_bf16_f32 v15, v74, v75
  s_add_u32 s22, s30, 28928
  s_add_u32 s22, s22, s36
  buffer_store_dwordx2 v[14:15], v6, s[8:11], s22 offen
  s_branch L_done
L_bt:
  s_load_dwordx2 s[16:17], s[0:1], 32
  s_waitcnt lgkmcnt(0)
  s_mov_b32 s12, s16
  s_mov_b32 s13, s17
  s_mov_b32 s14, 3670016
  s_mov_b32 s15, 0x00020000
  s_load_dwordx2 s[22:23], s[0:1], 40
  s_waitcnt lgkmcnt(0)
  s_mov_b32 s16, s22
  s_mov_b32 s17, s23
  s_mov_b32 s18, 3670016
  s_mov_b32 s19, 0x00020000
  s_lshr_b32 s21, s20, 3
  s_lshl_b32 s21, s21, 1
  s_bfe_u32 s22, s20, 0x10002
  s_add_u32 s21, s21, s22
  s_lshr_b32 s27, s21, 2
  s_and_b32 s21, s21, 3
  s_and_b32 s22, s20, 3
  s_lshl_b32 s22, s22, 2
  s_add_u32 s26, s21, s22
  s_add_u32 s26, s26, 4
  s_and_b32 s26, s26, 15
  s_lshl_b32 s33, s27, 1
  s_sub_u32 s34, s33, 7
  s_cmp_ge_u32 s33, 7
  s_cselect_b32 s33, s34, s33
  s_lshl_b32 s24, s26, 9
  v_lshrrev_b32 v1, 3, v0
  v_and_b32 v11, 7, v0
  s_lshl_b32 s21, s3, 6
  v_add_u32 v1, s21, v1
  v_mul_u32_u24 v10, 896, v1
  v_lshl_add_u32 v10, v11, 4, v10
  s_mul_i32 s31, s26, 229376
  s_lshl_b32 s21, s27, 7
  s_add_u32 s31, s31, s21
  s_add_u32 s22, s31, 0
  buffer_load_dwordx4 v[108:111], v10, s[16:19], s22 offen
  s_add_u32 s22, s31, 7168
  buffer_load_dwordx4 v[112:115], v10, s[16:19], s22 offen
  s_add_u32 s22, s31, 14336
  buffer_load_dwordx4 v[116:119], v10, s[16:19], s22 offen
  s_add_u32 s22, s31, 21504
  buffer_load_dwordx4 v[120:123], v10, s[16:19], s22 offen
  s_add_u32 s22, s31, 28672
  buffer_load_dwordx4 v[124:127], v10, s[16:19], s22 offen
  s_add_u32 s22, s31, 35840
  buffer_load_dwordx4 v[128:131], v10, s[16:19], s22 offen
  s_add_u32 s22, s31, 43008
  buffer_load_dwordx4 v[132:135], v10, s[16:19], s22 offen
  s_add_u32 s22, s31, 50176
  buffer_load_dwordx4 v[136:139], v10, s[16:19], s22 offen
  v_mul_u32_u24 v1, 144, v1
  v_lshl_add_u32 v1, v11, 4, v1
  v_and_b32 v2, 15, v0
  v_lshrrev_b32 v3, 4, v0
  v_lshrrev_b32 v6, 2, v2
  v_lshl_add_u32 v6, v3, 3, v6
  v_mul_u32_u24 v5, 144, v6
  v_and_b32 v6, 3, v2
  v_lshl_add_u32 v5, v6, 3, v5
  v_lshrrev_b32 v30, 5, v0
  v_and_b32 v31, 31, v0
  s_lshl_b32 s21, s3, 4
  v_add_u32 v32, 0, v30
  v_xor_b32 v33, v31, v32
  v_add_u32 v32, s21, v32
  v_lshlrev_b32 v32, 13, v32
  v_lshl_add_u32 v40, v33, 4, v32
  v_add_u32 v32, 2, v30
  v_xor_b32 v33, v31, v32
  v_add_u32 v32, s21, v32
  v_lshlrev_b32 v32, 13, v32
  v_lshl_add_u32 v41, v33, 4, v32
  v_add_u32 v32, 4, v30
  v_xor_b32 v33, v31, v32
  v_add_u32 v32, s21, v32
  v_lshlrev_b32 v32, 13, v32
  v_lshl_add_u32 v42, v33, 4, v32
  v_add_u32 v32, 6, v30
  v_xor_b32 v33, v31, v32
  v_add_u32 v32, s21, v32
  v_lshlrev_b32 v32, 13, v32
  v_lshl_add_u32 v43, v33, 4, v32
  v_add_u32 v32, 8, v30
  v_xor_b32 v33, v31, v32
  v_add_u32 v32, s21, v32
  v_lshlrev_b32 v32, 13, v32
  v_lshl_add_u32 v44, v33, 4, v32
  v_add_u32 v32, 10, v30
  v_xor_b32 v33, v31, v32
  v_add_u32 v32, s21, v32
  v_lshlrev_b32 v32, 13, v32
  v_lshl_add_u32 v45, v33, 4, v32
  v_add_u32 v32, 12, v30
  v_xor_b32 v33, v31, v32
  v_add_u32 v32, s21, v32
  v_lshlrev_b32 v32, 13, v32
  v_lshl_add_u32 v46, v33, 4, v32
  v_add_u32 v32, 14, v30
  v_xor_b32 v33, v31, v32
  v_add_u32 v32, s21, v32
  v_lshlrev_b32 v32, 13, v32
  v_lshl_add_u32 v47, v33, 4, v32
  v_and_b32 v32, 15, v0
  v_lshrrev_b32 v33, 4, v0
  v_and_b32 v34, 3, v32
  v_xor_b32 v34, v34, v33
  v_lshlrev_b32 v34, 4, v34
  v_lshl_add_u32 v34, v32, 9, v34
  s_mul_i32 s21, s3, 24576
  s_add_u32 s21, s21, 36864
  v_add_u32 v34, s21, v34
  v_lshrrev_b32 v35, 2, v32
  v_xor_b32 v36, 0, v35
  v_lshl_add_u32 v48, v36, 6, v34
  v_xor_b32 v36, 1, v35
  v_lshl_add_u32 v49, v36, 6, v34
  v_xor_b32 v36, 2, v35
  v_lshl_add_u32 v50, v36, 6, v34
  v_xor_b32 v36, 3, v35
  v_lshl_add_u32 v51, v36, 6, v34
  v_xor_b32 v36, 4, v35
  v_lshl_add_u32 v52, v36, 6, v34
  v_xor_b32 v36, 5, v35
  v_lshl_add_u32 v53, v36, 6, v34
  v_xor_b32 v36, 6, v35
  v_lshl_add_u32 v54, v36, 6, v34
  v_xor_b32 v36, 7, v35
  v_lshl_add_u32 v55, v36, 6, v34
  s_mul_i32 s29, s3, 24576
  s_add_u32 s29, s29, 36864
  s_add_u32 s35, s33, 0
  s_sub_u32 s34, s35, 7
  s_cmp_ge_u32 s35, 7
  s_cselect_b32 s35, s34, s35
  s_lshl_b32 s22, s35, 19
  s_add_u32 s22, s22, s24
  s_add_u32 m0, s29, 0
  s_nop 0
  buffer_load_dwordx4 v40, s[12:15], s22 offen lds
  s_add_u32 m0, s29, 1024
  s_nop 0
  buffer_load_dwordx4 v41, s[12:15], s22 offen lds
  s_add_u32 m0, s29, 2048
  s_nop 0
  buffer_load_dwordx4 v42, s[12:15], s22 offen lds
  s_add_u32 m0, s29, 3072
  s_nop 0
  buffer_load_dwordx4 v43, s[12:15], s22 offen lds
  s_add_u32 m0, s29, 4096
  s_nop 0
  buffer_load_dwordx4 v44, s[12:15], s22 offen lds
  s_add_u32 m0, s29, 5120
  s_nop 0
  buffer_load_dwordx4 v45, s[12:15], s22 offen lds
  s_add_u32 m0, s29, 6144
  s_nop 0
  buffer_load_dwordx4 v46, s[12:15], s22 offen lds
  s_add_u32 m0, s29, 7168
  s_nop 0
  buffer_load_dwordx4 v47, s[12:15], s22 offen lds
  s_add_u32 s35, s33, 1
  s_sub_u32 s34, s35, 7
  s_cmp_ge_u32 s35, 7
  s_cselect_b32 s35, s34, s35
  s_lshl_b32 s22, s35, 19
  s_add_u32 s22, s22, s24
  s_add_u32 m0, s29, 8192
  s_nop 0
  buffer_load_dwordx4 v40, s[12:15], s22 offen lds
  s_add_u32 m0, s29, 9216
  s_nop 0
  buffer_load_dwordx4 v41, s[12:15], s22 offen lds
  s_add_u32 m0, s29, 10240
  s_nop 0
  buffer_load_dwordx4 v42, s[12:15], s22 offen lds
  s_add_u32 m0, s29, 11264
  s_nop 0
  buffer_load_dwordx4 v43, s[12:15], s22 offen lds
  s_add_u32 m0, s29, 12288
  s_nop 0
  buffer_load_dwordx4 v44, s[12:15], s22 offen lds
  s_add_u32 m0, s29, 13312
  s_nop 0
  buffer_load_dwordx4 v45, s[12:15], s22 offen lds
  s_add_u32 m0, s29, 14336
  s_nop 0
  buffer_load_dwordx4 v46, s[12:15], s22 offen lds
  s_add_u32 m0, s29, 15360
  s_nop 0
  buffer_load_dwordx4 v47, s[12:15], s22 offen lds
  s_waitcnt vmcnt(16)
  ds_write_b128 v1, v[108:111] offset:0
  ds_write_b128 v1, v[112:115] offset:1152
  ds_write_b128 v1, v[116:119] offset:2304
  ds_write_b128 v1, v[120:123] offset:3456
  ds_write_b128 v1, v[124:127] offset:4608
  ds_write_b128 v1, v[128:131] offset:5760
  ds_write_b128 v1, v[132:135] offset:6912
  ds_write_b128 v1, v[136:139] offset:8064
  s_waitcnt lgkmcnt(0)
  s_barrier
  ds_read_b64_tr_b16 v[108:109], v5 offset:0
  ds_read_b64_tr_b16 v[110:111], v5 offset:576
  ds_read_b64_tr_b16 v[112:113], v5 offset:4608
  ds_read_b64_tr_b16 v[114:115], v5 offset:5184
  ds_read_b64_tr_b16 v[116:117], v5 offset:9216
  ds_read_b64_tr_b16 v[118:119], v5 offset:9792
  ds_read_b64_tr_b16 v[120:121], v5 offset:13824
  ds_read_b64_tr_b16 v[122:123], v5 offset:14400
  s_waitcnt lgkmcnt(0)
  ds_read_b64_tr_b16 v[124:125], v5 offset:18432
  ds_read_b64_tr_b16 v[126:127], v5 offset:19008
  ds_read_b64_tr_b16 v[128:129], v5 offset:23040
  ds_read_b64_tr_b16 v[130:131], v5 offset:23616
  ds_read_b64_tr_b16 v[132:133], v5 offset:27648
  ds_read_b64_tr_b16 v[134:135], v5 offset:28224
  ds_read_b64_tr_b16 v[136:137], v5 offset:32256
  ds_read_b64_tr_b16 v[138:139], v5 offset:32832
  s_waitcnt lgkmcnt(0)
  ds_read_b64_tr_b16 v[140:141], v5 offset:32
  ds_read_b64_tr_b16 v[142:143], v5 offset:608
  ds_read_b64_tr_b16 v[144:145], v5 offset:4640
  ds_read_b64_tr_b16 v[146:147], v5 offset:5216
  ds_read_b64_tr_b16 v[148:149], v5 offset:9248
  ds_read_b64_tr_b16 v[150:151], v5 offset:9824
  ds_read_b64_tr_b16 v[152:153], v5 offset:13856
  ds_read_b64_tr_b16 v[154:155], v5 offset:14432
  s_waitcnt lgkmcnt(0)
  ds_read_b64_tr_b16 v[156:157], v5 offset:18464
  ds_read_b64_tr_b16 v[158:159], v5 offset:19040
  ds_read_b64_tr_b16 v[160:161], v5 offset:23072
  ds_read_b64_tr_b16 v[162:163], v5 offset:23648
  ds_read_b64_tr_b16 v[164:165], v5 offset:27680
  ds_read_b64_tr_b16 v[166:167], v5 offset:28256
  ds_read_b64_tr_b16 v[168:169], v5 offset:32288
  ds_read_b64_tr_b16 v[170:171], v5 offset:32864
  s_waitcnt lgkmcnt(0)
  ds_read_b64_tr_b16 v[172:173], v5 offset:64
  ds_read_b64_tr_b16 v[174:175], v5 offset:640
  ds_read_b64_tr_b16 v[176:177], v5 offset:4672
  ds_read_b64_tr_b16 v[178:179], v5 offset:5248
  ds_read_b64_tr_b16 v[180:181], v5 offset:9280
  ds_read_b64_tr_b16 v[182:183], v5 offset:9856
  ds_read_b64_tr_b16 v[184:185], v5 offset:13888
  ds_read_b64_tr_b16 v[186:187], v5 offset:14464
  s_waitcnt lgkmcnt(0)
  ds_read_b64_tr_b16 v[188:189], v5 offset:18496
  ds_read_b64_tr_b16 v[190:191], v5 offset:19072
  ds_read_b64_tr_b16 v[192:193], v5 offset:23104
  ds_read_b64_tr_b16 v[194:195], v5 offset:23680
  ds_read_b64_tr_b16 v[196:197], v5 offset:27712
  ds_read_b64_tr_b16 v[198:199], v5 offset:28288
  ds_read_b64_tr_b16 v[200:201], v5 offset:32320
  ds_read_b64_tr_b16 v[202:203], v5 offset:32896
  s_waitcnt lgkmcnt(0)
  ds_read_b64_tr_b16 v[204:205], v5 offset:96
  ds_read_b64_tr_b16 v[206:207], v5 offset:672
  ds_read_b64_tr_b16 v[208:209], v5 offset:4704
  ds_read_b64_tr_b16 v[210:211], v5 offset:5280
  ds_read_b64_tr_b16 v[212:213], v5 offset:9312
  ds_read_b64_tr_b16 v[214:215], v5 offset:9888
  ds_read_b64_tr_b16 v[216:217], v5 offset:13920
  ds_read_b64_tr_b16 v[218:219], v5 offset:14496
  s_waitcnt lgkmcnt(0)
  ds_read_b64_tr_b16 v[220:221], v5 offset:18528
  ds_read_b64_tr_b16 v[222:223], v5 offset:19104
  ds_read_b64_tr_b16 v[224:225], v5 offset:23136
  ds_read_b64_tr_b16 v[226:227], v5 offset:23712
  ds_read_b64_tr_b16 v[228:229], v5 offset:27744
  ds_read_b64_tr_b16 v[230:231], v5 offset:28320
  ds_read_b64_tr_b16 v[232:233], v5 offset:32352
  ds_read_b64_tr_b16 v[234:235], v5 offset:32928
  s_waitcnt lgkmcnt(0)
  v_bfe_u32 v6, v2, 1, 1
  v_lshlrev_b32 v6, 3, v6
  v_lshrrev_b32 v7, 2, v2
  v_lshl_add_u32 v6, v7, 1, v6
  v_and_b32 v7, 1, v2
  v_add_u32 v6, v6, v7
  s_lshl_b32 s21, s27, 6
  v_add_u32 v6, s21, v6
  s_mul_i32 s23, s26, 28
  s_mov_b32 s25, 153391690
  v_lshrrev_b32 v7, 1, v3
  v_lshlrev_b32 v7, 9, v7
  v_and_b32 v8, 1, v3
  v_lshl_add_u32 v7, v8, 3, v7
  v_add_u32 v8, 0, v6
  v_mul_hi_u32 v9, v8, s25
  v_mul_u32_u24 v10, 28, v9
  v_sub_u32 v8, v8, v10
  v_mul_u32_u24 v9, 448, v9
  v_add_u32 v8, v8, v9
  v_add_u32 v8, s23, v8
  v_lshrrev_b32 v9, 5, v8
  v_mul_u32_u24 v9, 28672, v9
  v_and_b32 v8, 31, v8
  v_lshl_add_u32 v8, v8, 4, v9
  v_add_u32 v16, v8, v7
  v_add_u32 v8, 16, v6
  v_mul_hi_u32 v9, v8, s25
  v_mul_u32_u24 v10, 28, v9
  v_sub_u32 v8, v8, v10
  v_mul_u32_u24 v9, 448, v9
  v_add_u32 v8, v8, v9
  v_add_u32 v8, s23, v8
  v_lshrrev_b32 v9, 5, v8
  v_mul_u32_u24 v9, 28672, v9
  v_and_b32 v8, 31, v8
  v_lshl_add_u32 v8, v8, 4, v9
  v_add_u32 v17, v8, v7
  v_add_u32 v8, 32, v6
  v_mul_hi_u32 v9, v8, s25
  v_mul_u32_u24 v10, 28, v9
  v_sub_u32 v8, v8, v10
  v_mul_u32_u24 v9, 448, v9
  v_add_u32 v8, v8, v9
  v_add_u32 v8, s23, v8
  v_lshrrev_b32 v9, 5, v8
  v_mul_u32_u24 v9, 28672, v9
  v_and_b32 v8, 31, v8
  v_lshl_add_u32 v8, v8, 4, v9
  v_add_u32 v18, v8, v7
  v_add_u32 v8, 48, v6
  v_mul_hi_u32 v9, v8, s25
  v_mul_u32_u24 v10, 28, v9
  v_sub_u32 v8, v8, v10
  v_mul_u32_u24 v9, 448, v9
  v_add_u32 v8, v8, v9
  v_add_u32 v8, s23, v8
  v_lshrrev_b32 v9, 5, v8
  v_mul_u32_u24 v9, 28672, v9
  v_and_b32 v8, 31, v8
  v_lshl_add_u32 v8, v8, 4, v9
  v_add_u32 v19, v8, v7
  s_lshl_b32 s30, s3, 10
  s_add_u32 s30, s30, 12976128
  s_add_u32 s35, s33, 2
  s_sub_u32 s34, s35, 7
  s_cmp_ge_u32 s35, 7
  s_cselect_b32 s35, s34, s35
  s_lshl_b32 s22, s35, 19
  s_add_u32 s22, s22, s24
  s_add_u32 m0, s29, 16384
  s_nop 0
  buffer_load_dwordx4 v40, s[12:15], s22 offen lds
  s_add_u32 m0, s29, 17408
  s_nop 0
  buffer_load_dwordx4 v41, s[12:15], s22 offen lds
  s_add_u32 m0, s29, 18432
  s_nop 0
  buffer_load_dwordx4 v42, s[12:15], s22 offen lds
  s_add_u32 m0, s29, 19456
  s_nop 0
  buffer_load_dwordx4 v43, s[12:15], s22 offen lds
  s_add_u32 m0, s29, 20480
  s_nop 0
  buffer_load_dwordx4 v44, s[12:15], s22 offen lds
  s_add_u32 m0, s29, 21504
  s_nop 0
  buffer_load_dwordx4 v45, s[12:15], s22 offen lds
  s_add_u32 m0, s29, 22528
  s_nop 0
  buffer_load_dwordx4 v46, s[12:15], s22 offen lds
  s_add_u32 m0, s29, 23552
  s_nop 0
  buffer_load_dwordx4 v47, s[12:15], s22 offen lds
  s_waitcnt vmcnt(16)
  ds_read_b128 v[76:79], v48 offset:0
  ds_read_b128 v[80:83], v49 offset:0
  ds_read_b128 v[84:87], v50 offset:0
  ds_read_b128 v[88:91], v51 offset:0
  ds_read_b128 v[92:95], v52 offset:0
  ds_read_b128 v[96:99], v53 offset:0
  ds_read_b128 v[100:103], v54 offset:0
  ds_read_b128 v[104:107], v55 offset:0
  s_waitcnt lgkmcnt(7)
  v_mfma_f32_16x16x32_bf16 v[60:63], v[76:79], v[108:111], 0
  v_mfma_f32_16x16x32_bf16 v[64:67], v[76:79], v[140:143], 0
  v_mfma_f32_16x16x32_bf16 v[68:71], v[76:79], v[172:175], 0
  v_mfma_f32_16x16x32_bf16 v[72:75], v[76:79], v[204:207], 0
  s_waitcnt lgkmcnt(6)
  v_mfma_f32_16x16x32_bf16 v[60:63], v[80:83], v[112:115], v[60:63]
  v_mfma_f32_16x16x32_bf16 v[64:67], v[80:83], v[144:147], v[64:67]
  v_mfma_f32_16x16x32_bf16 v[68:71], v[80:83], v[176:179], v[68:71]
  v_mfma_f32_16x16x32_bf16 v[72:75], v[80:83], v[208:211], v[72:75]
  s_waitcnt lgkmcnt(5)
  v_mfma_f32_16x16x32_bf16 v[60:63], v[84:87], v[116:119], v[60:63]
  v_mfma_f32_16x16x32_bf16 v[64:67], v[84:87], v[148:151], v[64:67]
  v_mfma_f32_16x16x32_bf16 v[68:71], v[84:87], v[180:183], v[68:71]
  v_mfma_f32_16x16x32_bf16 v[72:75], v[84:87], v[212:215], v[72:75]
  s_waitcnt lgkmcnt(4)
  v_mfma_f32_16x16x32_bf16 v[60:63], v[88:91], v[120:123], v[60:63]
  v_mfma_f32_16x16x32_bf16 v[64:67], v[88:91], v[152:155], v[64:67]
  v_mfma_f32_16x16x32_bf16 v[68:71], v[88:91], v[184:187], v[68:71]
  v_mfma_f32_16x16x32_bf16 v[72:75], v[88:91], v[216:219], v[72:75]
  s_waitcnt lgkmcnt(3)
  v_mfma_f32_16x16x32_bf16 v[60:63], v[92:95], v[124:127], v[60:63]
  v_mfma_f32_16x16x32_bf16 v[64:67], v[92:95], v[156:159], v[64:67]
  v_mfma_f32_16x16x32_bf16 v[68:71], v[92:95], v[188:191], v[68:71]
  v_mfma_f32_16x16x32_bf16 v[72:75], v[92:95], v[220:223], v[72:75]
  s_waitcnt lgkmcnt(2)
  v_mfma_f32_16x16x32_bf16 v[60:63], v[96:99], v[128:131], v[60:63]
  v_mfma_f32_16x16x32_bf16 v[64:67], v[96:99], v[160:163], v[64:67]
  v_mfma_f32_16x16x32_bf16 v[68:71], v[96:99], v[192:195], v[68:71]
  v_mfma_f32_16x16x32_bf16 v[72:75], v[96:99], v[224:227], v[72:75]
  s_waitcnt lgkmcnt(1)
  v_mfma_f32_16x16x32_bf16 v[60:63], v[100:103], v[132:135], v[60:63]
  v_mfma_f32_16x16x32_bf16 v[64:67], v[100:103], v[164:167], v[64:67]
  v_mfma_f32_16x16x32_bf16 v[68:71], v[100:103], v[196:199], v[68:71]
  v_mfma_f32_16x16x32_bf16 v[72:75], v[100:103], v[228:231], v[72:75]
  s_waitcnt lgkmcnt(0)
  v_mfma_f32_16x16x32_bf16 v[60:63], v[104:107], v[136:139], v[60:63]
  v_mfma_f32_16x16x32_bf16 v[64:67], v[104:107], v[168:171], v[64:67]
  v_mfma_f32_16x16x32_bf16 v[68:71], v[104:107], v[200:203], v[68:71]
  v_mfma_f32_16x16x32_bf16 v[72:75], v[104:107], v[232:235], v[72:75]
  s_add_u32 s36, s33, 0
  s_sub_u32 s34, s36, 7
  s_cmp_ge_u32 s36, 7
  s_cselect_b32 s36, s34, s36
  s_lshl_b32 s36, s36, 12
  s_add_u32 s22, s30, s36
  v_cvt_pk_bf16_f32 v8, v60, v61
  v_cvt_pk_bf16_f32 v9, v62, v63
  buffer_store_dwordx2 v[8:9], v16, s[8:11], s22 offen
  v_cvt_pk_bf16_f32 v10, v64, v65
  v_cvt_pk_bf16_f32 v11, v66, v67
  buffer_store_dwordx2 v[10:11], v17, s[8:11], s22 offen
  v_cvt_pk_bf16_f32 v12, v68, v69
  v_cvt_pk_bf16_f32 v13, v70, v71
  buffer_store_dwordx2 v[12:13], v18, s[8:11], s22 offen
  v_cvt_pk_bf16_f32 v14, v72, v73
  v_cvt_pk_bf16_f32 v15, v74, v75
  buffer_store_dwordx2 v[14:15], v19, s[8:11], s22 offen
  s_add_u32 s35, s33, 3
  s_sub_u32 s34, s35, 7
  s_cmp_ge_u32 s35, 7
  s_cselect_b32 s35, s34, s35
  s_lshl_b32 s22, s35, 19
  s_add_u32 s22, s22, s24
  s_add_u32 m0, s29, 0
  s_nop 0
  buffer_load_dwordx4 v40, s[12:15], s22 offen lds
  s_add_u32 m0, s29, 1024
  s_nop 0
  buffer_load_dwordx4 v41, s[12:15], s22 offen lds
  s_add_u32 m0, s29, 2048
  s_nop 0
  buffer_load_dwordx4 v42, s[12:15], s22 offen lds
  s_add_u32 m0, s29, 3072
  s_nop 0
  buffer_load_dwordx4 v43, s[12:15], s22 offen lds
  s_add_u32 m0, s29, 4096
  s_nop 0
  buffer_load_dwordx4 v44, s[12:15], s22 offen lds
  s_add_u32 m0, s29, 5120
  s_nop 0
  buffer_load_dwordx4 v45, s[12:15], s22 offen lds
  s_add_u32 m0, s29, 6144
  s_nop 0
  buffer_load_dwordx4 v46, s[12:15], s22 offen lds
  s_add_u32 m0, s29, 7168
  s_nop 0
  buffer_load_dwordx4 v47, s[12:15], s22 offen lds
  s_waitcnt vmcnt(20)
  ds_read_b128 v[76:79], v48 offset:8192
  ds_read_b128 v[80:83], v49 offset:8192
  ds_read_b128 v[84:87], v50 offset:8192
  ds_read_b128 v[88:91], v51 offset:8192
  ds_read_b128 v[92:95], v52 offset:8192
  ds_read_b128 v[96:99], v53 offset:8192
  ds_read_b128 v[100:103], v54 offset:8192
  ds_read_b128 v[104:107], v55 offset:8192
  s_waitcnt lgkmcnt(7)
  v_mfma_f32_16x16x32_bf16 v[60:63], v[76:79], v[108:111], 0
  v_mfma_f32_16x16x32_bf16 v[64:67], v[76:79], v[140:143], 0
  v_mfma_f32_16x16x32_bf16 v[68:71], v[76:79], v[172:175], 0
  v_mfma_f32_16x16x32_bf16 v[72:75], v[76:79], v[204:207], 0
  s_waitcnt lgkmcnt(6)
  v_mfma_f32_16x16x32_bf16 v[60:63], v[80:83], v[112:115], v[60:63]
  v_mfma_f32_16x16x32_bf16 v[64:67], v[80:83], v[144:147], v[64:67]
  v_mfma_f32_16x16x32_bf16 v[68:71], v[80:83], v[176:179], v[68:71]
  v_mfma_f32_16x16x32_bf16 v[72:75], v[80:83], v[208:211], v[72:75]
  s_waitcnt lgkmcnt(5)
  v_mfma_f32_16x16x32_bf16 v[60:63], v[84:87], v[116:119], v[60:63]
  v_mfma_f32_16x16x32_bf16 v[64:67], v[84:87], v[148:151], v[64:67]
  v_mfma_f32_16x16x32_bf16 v[68:71], v[84:87], v[180:183], v[68:71]
  v_mfma_f32_16x16x32_bf16 v[72:75], v[84:87], v[212:215], v[72:75]
  s_waitcnt lgkmcnt(4)
  v_mfma_f32_16x16x32_bf16 v[60:63], v[88:91], v[120:123], v[60:63]
  v_mfma_f32_16x16x32_bf16 v[64:67], v[88:91], v[152:155], v[64:67]
  v_mfma_f32_16x16x32_bf16 v[68:71], v[88:91], v[184:187], v[68:71]
  v_mfma_f32_16x16x32_bf16 v[72:75], v[88:91], v[216:219], v[72:75]
  s_waitcnt lgkmcnt(3)
  v_mfma_f32_16x16x32_bf16 v[60:63], v[92:95], v[124:127], v[60:63]
  v_mfma_f32_16x16x32_bf16 v[64:67], v[92:95], v[156:159], v[64:67]
  v_mfma_f32_16x16x32_bf16 v[68:71], v[92:95], v[188:191], v[68:71]
  v_mfma_f32_16x16x32_bf16 v[72:75], v[92:95], v[220:223], v[72:75]
  s_waitcnt lgkmcnt(2)
  v_mfma_f32_16x16x32_bf16 v[60:63], v[96:99], v[128:131], v[60:63]
  v_mfma_f32_16x16x32_bf16 v[64:67], v[96:99], v[160:163], v[64:67]
  v_mfma_f32_16x16x32_bf16 v[68:71], v[96:99], v[192:195], v[68:71]
  v_mfma_f32_16x16x32_bf16 v[72:75], v[96:99], v[224:227], v[72:75]
  s_waitcnt lgkmcnt(1)
  v_mfma_f32_16x16x32_bf16 v[60:63], v[100:103], v[132:135], v[60:63]
  v_mfma_f32_16x16x32_bf16 v[64:67], v[100:103], v[164:167], v[64:67]
  v_mfma_f32_16x16x32_bf16 v[68:71], v[100:103], v[196:199], v[68:71]
  v_mfma_f32_16x16x32_bf16 v[72:75], v[100:103], v[228:231], v[72:75]
  s_waitcnt lgkmcnt(0)
  v_mfma_f32_16x16x32_bf16 v[60:63], v[104:107], v[136:139], v[60:63]
  v_mfma_f32_16x16x32_bf16 v[64:67], v[104:107], v[168:171], v[64:67]
  v_mfma_f32_16x16x32_bf16 v[68:71], v[104:107], v[200:203], v[68:71]
  v_mfma_f32_16x16x32_bf16 v[72:75], v[104:107], v[232:235], v[72:75]
  s_add_u32 s36, s33, 1
  s_sub_u32 s34, s36, 7
  s_cmp_ge_u32 s36, 7
  s_cselect_b32 s36, s34, s36
  s_lshl_b32 s36, s36, 12
  s_add_u32 s22, s30, s36
  v_cvt_pk_bf16_f32 v8, v60, v61
  v_cvt_pk_bf16_f32 v9, v62, v63
  buffer_store_dwordx2 v[8:9], v16, s[8:11], s22 offen
  v_cvt_pk_bf16_f32 v10, v64, v65
  v_cvt_pk_bf16_f32 v11, v66, v67
  buffer_store_dwordx2 v[10:11], v17, s[8:11], s22 offen
  v_cvt_pk_bf16_f32 v12, v68, v69
  v_cvt_pk_bf16_f32 v13, v70, v71
  buffer_store_dwordx2 v[12:13], v18, s[8:11], s22 offen
  v_cvt_pk_bf16_f32 v14, v72, v73
  v_cvt_pk_bf16_f32 v15, v74, v75
  buffer_store_dwordx2 v[14:15], v19, s[8:11], s22 offen
  s_add_u32 s35, s33, 4
  s_sub_u32 s34, s35, 7
  s_cmp_ge_u32 s35, 7
  s_cselect_b32 s35, s34, s35
  s_lshl_b32 s22, s35, 19
  s_add_u32 s22, s22, s24
  s_add_u32 m0, s29, 8192
  s_nop 0
  buffer_load_dwordx4 v40, s[12:15], s22 offen lds
  s_add_u32 m0, s29, 9216
  s_nop 0
  buffer_load_dwordx4 v41, s[12:15], s22 offen lds
  s_add_u32 m0, s29, 10240
  s_nop 0
  buffer_load_dwordx4 v42, s[12:15], s22 offen lds
  s_add_u32 m0, s29, 11264
  s_nop 0
  buffer_load_dwordx4 v43, s[12:15], s22 offen lds
  s_add_u32 m0, s29, 12288
  s_nop 0
  buffer_load_dwordx4 v44, s[12:15], s22 offen lds
  s_add_u32 m0, s29, 13312
  s_nop 0
  buffer_load_dwordx4 v45, s[12:15], s22 offen lds
  s_add_u32 m0, s29, 14336
  s_nop 0
  buffer_load_dwordx4 v46, s[12:15], s22 offen lds
  s_add_u32 m0, s29, 15360
  s_nop 0
  buffer_load_dwordx4 v47, s[12:15], s22 offen lds
  s_waitcnt vmcnt(20)
  ds_read_b128 v[76:79], v48 offset:16384
  ds_read_b128 v[80:83], v49 offset:16384
  ds_read_b128 v[84:87], v50 offset:16384
  ds_read_b128 v[88:91], v51 offset:16384
  ds_read_b128 v[92:95], v52 offset:16384
  ds_read_b128 v[96:99], v53 offset:16384
  ds_read_b128 v[100:103], v54 offset:16384
  ds_read_b128 v[104:107], v55 offset:16384
  s_waitcnt lgkmcnt(7)
  v_mfma_f32_16x16x32_bf16 v[60:63], v[76:79], v[108:111], 0
  v_mfma_f32_16x16x32_bf16 v[64:67], v[76:79], v[140:143], 0
  v_mfma_f32_16x16x32_bf16 v[68:71], v[76:79], v[172:175], 0
  v_mfma_f32_16x16x32_bf16 v[72:75], v[76:79], v[204:207], 0
  s_waitcnt lgkmcnt(6)
  v_mfma_f32_16x16x32_bf16 v[60:63], v[80:83], v[112:115], v[60:63]
  v_mfma_f32_16x16x32_bf16 v[64:67], v[80:83], v[144:147], v[64:67]
  v_mfma_f32_16x16x32_bf16 v[68:71], v[80:83], v[176:179], v[68:71]
  v_mfma_f32_16x16x32_bf16 v[72:75], v[80:83], v[208:211], v[72:75]
  s_waitcnt lgkmcnt(5)
  v_mfma_f32_16x16x32_bf16 v[60:63], v[84:87], v[116:119], v[60:63]
  v_mfma_f32_16x16x32_bf16 v[64:67], v[84:87], v[148:151], v[64:67]
  v_mfma_f32_16x16x32_bf16 v[68:71], v[84:87], v[180:183], v[68:71]
  v_mfma_f32_16x16x32_bf16 v[72:75], v[84:87], v[212:215], v[72:75]
  s_waitcnt lgkmcnt(4)
  v_mfma_f32_16x16x32_bf16 v[60:63], v[88:91], v[120:123], v[60:63]
  v_mfma_f32_16x16x32_bf16 v[64:67], v[88:91], v[152:155], v[64:67]
  v_mfma_f32_16x16x32_bf16 v[68:71], v[88:91], v[184:187], v[68:71]
  v_mfma_f32_16x16x32_bf16 v[72:75], v[88:91], v[216:219], v[72:75]
  s_waitcnt lgkmcnt(3)
  v_mfma_f32_16x16x32_bf16 v[60:63], v[92:95], v[124:127], v[60:63]
  v_mfma_f32_16x16x32_bf16 v[64:67], v[92:95], v[156:159], v[64:67]
  v_mfma_f32_16x16x32_bf16 v[68:71], v[92:95], v[188:191], v[68:71]
  v_mfma_f32_16x16x32_bf16 v[72:75], v[92:95], v[220:223], v[72:75]
  s_waitcnt lgkmcnt(2)
  v_mfma_f32_16x16x32_bf16 v[60:63], v[96:99], v[128:131], v[60:63]
  v_mfma_f32_16x16x32_bf16 v[64:67], v[96:99], v[160:163], v[64:67]
  v_mfma_f32_16x16x32_bf16 v[68:71], v[96:99], v[192:195], v[68:71]
  v_mfma_f32_16x16x32_bf16 v[72:75], v[96:99], v[224:227], v[72:75]
  s_waitcnt lgkmcnt(1)
  v_mfma_f32_16x16x32_bf16 v[60:63], v[100:103], v[132:135], v[60:63]
  v_mfma_f32_16x16x32_bf16 v[64:67], v[100:103], v[164:167], v[64:67]
  v_mfma_f32_16x16x32_bf16 v[68:71], v[100:103], v[196:199], v[68:71]
  v_mfma_f32_16x16x32_bf16 v[72:75], v[100:103], v[228:231], v[72:75]
  s_waitcnt lgkmcnt(0)
  v_mfma_f32_16x16x32_bf16 v[60:63], v[104:107], v[136:139], v[60:63]
  v_mfma_f32_16x16x32_bf16 v[64:67], v[104:107], v[168:171], v[64:67]
  v_mfma_f32_16x16x32_bf16 v[68:71], v[104:107], v[200:203], v[68:71]
  v_mfma_f32_16x16x32_bf16 v[72:75], v[104:107], v[232:235], v[72:75]
  s_add_u32 s36, s33, 2
  s_sub_u32 s34, s36, 7
  s_cmp_ge_u32 s36, 7
  s_cselect_b32 s36, s34, s36
  s_lshl_b32 s36, s36, 12
  s_add_u32 s22, s30, s36
  v_cvt_pk_bf16_f32 v8, v60, v61
  v_cvt_pk_bf16_f32 v9, v62, v63
  buffer_store_dwordx2 v[8:9], v16, s[8:11], s22 offen
  v_cvt_pk_bf16_f32 v10, v64, v65
  v_cvt_pk_bf16_f32 v11, v66, v67
  buffer_store_dwordx2 v[10:11], v17, s[8:11], s22 offen
  v_cvt_pk_bf16_f32 v12, v68, v69
  v_cvt_pk_bf16_f32 v13, v70, v71
  buffer_store_dwordx2 v[12:13], v18, s[8:11], s22 offen
  v_cvt_pk_bf16_f32 v14, v72, v73
  v_cvt_pk_bf16_f32 v15, v74, v75
  buffer_store_dwordx2 v[14:15], v19, s[8:11], s22 offen
  s_add_u32 s35, s33, 5
  s_sub_u32 s34, s35, 7
  s_cmp_ge_u32 s35, 7
  s_cselect_b32 s35, s34, s35
  s_lshl_b32 s22, s35, 19
  s_add_u32 s22, s22, s24
  s_add_u32 m0, s29, 16384
  s_nop 0
  buffer_load_dwordx4 v40, s[12:15], s22 offen lds
  s_add_u32 m0, s29, 17408
  s_nop 0
  buffer_load_dwordx4 v41, s[12:15], s22 offen lds
  s_add_u32 m0, s29, 18432
  s_nop 0
  buffer_load_dwordx4 v42, s[12:15], s22 offen lds
  s_add_u32 m0, s29, 19456
  s_nop 0
  buffer_load_dwordx4 v43, s[12:15], s22 offen lds
  s_add_u32 m0, s29, 20480
  s_nop 0
  buffer_load_dwordx4 v44, s[12:15], s22 offen lds
  s_add_u32 m0, s29, 21504
  s_nop 0
  buffer_load_dwordx4 v45, s[12:15], s22 offen lds
  s_add_u32 m0, s29, 22528
  s_nop 0
  buffer_load_dwordx4 v46, s[12:15], s22 offen lds
  s_add_u32 m0, s29, 23552
  s_nop 0
  buffer_load_dwordx4 v47, s[12:15], s22 offen lds
  s_waitcnt vmcnt(20)
  ds_read_b128 v[76:79], v48 offset:0
  ds_read_b128 v[80:83], v49 offset:0
  ds_read_b128 v[84:87], v50 offset:0
  ds_read_b128 v[88:91], v51 offset:0
  ds_read_b128 v[92:95], v52 offset:0
  ds_read_b128 v[96:99], v53 offset:0
  ds_read_b128 v[100:103], v54 offset:0
  ds_read_b128 v[104:107], v55 offset:0
  s_waitcnt lgkmcnt(7)
  v_mfma_f32_16x16x32_bf16 v[60:63], v[76:79], v[108:111], 0
  v_mfma_f32_16x16x32_bf16 v[64:67], v[76:79], v[140:143], 0
  v_mfma_f32_16x16x32_bf16 v[68:71], v[76:79], v[172:175], 0
  v_mfma_f32_16x16x32_bf16 v[72:75], v[76:79], v[204:207], 0
  s_waitcnt lgkmcnt(6)
  v_mfma_f32_16x16x32_bf16 v[60:63], v[80:83], v[112:115], v[60:63]
  v_mfma_f32_16x16x32_bf16 v[64:67], v[80:83], v[144:147], v[64:67]
  v_mfma_f32_16x16x32_bf16 v[68:71], v[80:83], v[176:179], v[68:71]
  v_mfma_f32_16x16x32_bf16 v[72:75], v[80:83], v[208:211], v[72:75]
  s_waitcnt lgkmcnt(5)
  v_mfma_f32_16x16x32_bf16 v[60:63], v[84:87], v[116:119], v[60:63]
  v_mfma_f32_16x16x32_bf16 v[64:67], v[84:87], v[148:151], v[64:67]
  v_mfma_f32_16x16x32_bf16 v[68:71], v[84:87], v[180:183], v[68:71]
  v_mfma_f32_16x16x32_bf16 v[72:75], v[84:87], v[212:215], v[72:75]
  s_waitcnt lgkmcnt(4)
  v_mfma_f32_16x16x32_bf16 v[60:63], v[88:91], v[120:123], v[60:63]
  v_mfma_f32_16x16x32_bf16 v[64:67], v[88:91], v[152:155], v[64:67]
  v_mfma_f32_16x16x32_bf16 v[68:71], v[88:91], v[184:187], v[68:71]
  v_mfma_f32_16x16x32_bf16 v[72:75], v[88:91], v[216:219], v[72:75]
  s_waitcnt lgkmcnt(3)
  v_mfma_f32_16x16x32_bf16 v[60:63], v[92:95], v[124:127], v[60:63]
  v_mfma_f32_16x16x32_bf16 v[64:67], v[92:95], v[156:159], v[64:67]
  v_mfma_f32_16x16x32_bf16 v[68:71], v[92:95], v[188:191], v[68:71]
  v_mfma_f32_16x16x32_bf16 v[72:75], v[92:95], v[220:223], v[72:75]
  s_waitcnt lgkmcnt(2)
  v_mfma_f32_16x16x32_bf16 v[60:63], v[96:99], v[128:131], v[60:63]
  v_mfma_f32_16x16x32_bf16 v[64:67], v[96:99], v[160:163], v[64:67]
  v_mfma_f32_16x16x32_bf16 v[68:71], v[96:99], v[192:195], v[68:71]
  v_mfma_f32_16x16x32_bf16 v[72:75], v[96:99], v[224:227], v[72:75]
  s_waitcnt lgkmcnt(1)
  v_mfma_f32_16x16x32_bf16 v[60:63], v[100:103], v[132:135], v[60:63]
  v_mfma_f32_16x16x32_bf16 v[64:67], v[100:103], v[164:167], v[64:67]
  v_mfma_f32_16x16x32_bf16 v[68:71], v[100:103], v[196:199], v[68:71]
  v_mfma_f32_16x16x32_bf16 v[72:75], v[100:103], v[228:231], v[72:75]
  s_waitcnt lgkmcnt(0)
  v_mfma_f32_16x16x32_bf16 v[60:63], v[104:107], v[136:139], v[60:63]
  v_mfma_f32_16x16x32_bf16 v[64:67], v[104:107], v[168:171], v[64:67]
  v_mfma_f32_16x16x32_bf16 v[68:71], v[104:107], v[200:203], v[68:71]
  v_mfma_f32_16x16x32_bf16 v[72:75], v[104:107], v[232:235], v[72:75]
  s_add_u32 s36, s33, 3
  s_sub_u32 s34, s36, 7
  s_cmp_ge_u32 s36, 7
  s_cselect_b32 s36, s34, s36
  s_lshl_b32 s36, s36, 12
  s_add_u32 s22, s30, s36
  v_cvt_pk_bf16_f32 v8, v60, v61
  v_cvt_pk_bf16_f32 v9, v62, v63
  buffer_store_dwordx2 v[8:9], v16, s[8:11], s22 offen
  v_cvt_pk_bf16_f32 v10, v64, v65
  v_cvt_pk_bf16_f32 v11, v66, v67
  buffer_store_dwordx2 v[10:11], v17, s[8:11], s22 offen
  v_cvt_pk_bf16_f32 v12, v68, v69
  v_cvt_pk_bf16_f32 v13, v70, v71
  buffer_store_dwordx2 v[12:13], v18, s[8:11], s22 offen
  v_cvt_pk_bf16_f32 v14, v72, v73
  v_cvt_pk_bf16_f32 v15, v74, v75
  buffer_store_dwordx2 v[14:15], v19, s[8:11], s22 offen
  s_add_u32 s35, s33, 6
  s_sub_u32 s34, s35, 7
  s_cmp_ge_u32 s35, 7
  s_cselect_b32 s35, s34, s35
  s_lshl_b32 s22, s35, 19
  s_add_u32 s22, s22, s24
  s_add_u32 m0, s29, 0
  s_nop 0
  buffer_load_dwordx4 v40, s[12:15], s22 offen lds
  s_add_u32 m0, s29, 1024
  s_nop 0
  buffer_load_dwordx4 v41, s[12:15], s22 offen lds
  s_add_u32 m0, s29, 2048
  s_nop 0
  buffer_load_dwordx4 v42, s[12:15], s22 offen lds
  s_add_u32 m0, s29, 3072
  s_nop 0
  buffer_load_dwordx4 v43, s[12:15], s22 offen lds
  s_add_u32 m0, s29, 4096
  s_nop 0
  buffer_load_dwordx4 v44, s[12:15], s22 offen lds
  s_add_u32 m0, s29, 5120
  s_nop 0
  buffer_load_dwordx4 v45, s[12:15], s22 offen lds
  s_add_u32 m0, s29, 6144
  s_nop 0
  buffer_load_dwordx4 v46, s[12:15], s22 offen lds
  s_add_u32 m0, s29, 7168
  s_nop 0
  buffer_load_dwordx4 v47, s[12:15], s22 offen lds
  s_waitcnt vmcnt(20)
  ds_read_b128 v[76:79], v48 offset:8192
  ds_read_b128 v[80:83], v49 offset:8192
  ds_read_b128 v[84:87], v50 offset:8192
  ds_read_b128 v[88:91], v51 offset:8192
  ds_read_b128 v[92:95], v52 offset:8192
  ds_read_b128 v[96:99], v53 offset:8192
  ds_read_b128 v[100:103], v54 offset:8192
  ds_read_b128 v[104:107], v55 offset:8192
  s_waitcnt lgkmcnt(7)
  v_mfma_f32_16x16x32_bf16 v[60:63], v[76:79], v[108:111], 0
  v_mfma_f32_16x16x32_bf16 v[64:67], v[76:79], v[140:143], 0
  v_mfma_f32_16x16x32_bf16 v[68:71], v[76:79], v[172:175], 0
  v_mfma_f32_16x16x32_bf16 v[72:75], v[76:79], v[204:207], 0
  s_waitcnt lgkmcnt(6)
  v_mfma_f32_16x16x32_bf16 v[60:63], v[80:83], v[112:115], v[60:63]
  v_mfma_f32_16x16x32_bf16 v[64:67], v[80:83], v[144:147], v[64:67]
  v_mfma_f32_16x16x32_bf16 v[68:71], v[80:83], v[176:179], v[68:71]
  v_mfma_f32_16x16x32_bf16 v[72:75], v[80:83], v[208:211], v[72:75]
  s_waitcnt lgkmcnt(5)
  v_mfma_f32_16x16x32_bf16 v[60:63], v[84:87], v[116:119], v[60:63]
  v_mfma_f32_16x16x32_bf16 v[64:67], v[84:87], v[148:151], v[64:67]
  v_mfma_f32_16x16x32_bf16 v[68:71], v[84:87], v[180:183], v[68:71]
  v_mfma_f32_16x16x32_bf16 v[72:75], v[84:87], v[212:215], v[72:75]
  s_waitcnt lgkmcnt(4)
  v_mfma_f32_16x16x32_bf16 v[60:63], v[88:91], v[120:123], v[60:63]
  v_mfma_f32_16x16x32_bf16 v[64:67], v[88:91], v[152:155], v[64:67]
  v_mfma_f32_16x16x32_bf16 v[68:71], v[88:91], v[184:187], v[68:71]
  v_mfma_f32_16x16x32_bf16 v[72:75], v[88:91], v[216:219], v[72:75]
  s_waitcnt lgkmcnt(3)
  v_mfma_f32_16x16x32_bf16 v[60:63], v[92:95], v[124:127], v[60:63]
  v_mfma_f32_16x16x32_bf16 v[64:67], v[92:95], v[156:159], v[64:67]
  v_mfma_f32_16x16x32_bf16 v[68:71], v[92:95], v[188:191], v[68:71]
  v_mfma_f32_16x16x32_bf16 v[72:75], v[92:95], v[220:223], v[72:75]
  s_waitcnt lgkmcnt(2)
  v_mfma_f32_16x16x32_bf16 v[60:63], v[96:99], v[128:131], v[60:63]
  v_mfma_f32_16x16x32_bf16 v[64:67], v[96:99], v[160:163], v[64:67]
  v_mfma_f32_16x16x32_bf16 v[68:71], v[96:99], v[192:195], v[68:71]
  v_mfma_f32_16x16x32_bf16 v[72:75], v[96:99], v[224:227], v[72:75]
  s_waitcnt lgkmcnt(1)
  v_mfma_f32_16x16x32_bf16 v[60:63], v[100:103], v[132:135], v[60:63]
  v_mfma_f32_16x16x32_bf16 v[64:67], v[100:103], v[164:167], v[64:67]
  v_mfma_f32_16x16x32_bf16 v[68:71], v[100:103], v[196:199], v[68:71]
  v_mfma_f32_16x16x32_bf16 v[72:75], v[100:103], v[228:231], v[72:75]
  s_waitcnt lgkmcnt(0)
  v_mfma_f32_16x16x32_bf16 v[60:63], v[104:107], v[136:139], v[60:63]
  v_mfma_f32_16x16x32_bf16 v[64:67], v[104:107], v[168:171], v[64:67]
  v_mfma_f32_16x16x32_bf16 v[68:71], v[104:107], v[200:203], v[68:71]
  v_mfma_f32_16x16x32_bf16 v[72:75], v[104:107], v[232:235], v[72:75]
  s_add_u32 s36, s33, 4
  s_sub_u32 s34, s36, 7
  s_cmp_ge_u32 s36, 7
  s_cselect_b32 s36, s34, s36
  s_lshl_b32 s36, s36, 12
  s_add_u32 s22, s30, s36
  v_cvt_pk_bf16_f32 v8, v60, v61
  v_cvt_pk_bf16_f32 v9, v62, v63
  buffer_store_dwordx2 v[8:9], v16, s[8:11], s22 offen
  v_cvt_pk_bf16_f32 v10, v64, v65
  v_cvt_pk_bf16_f32 v11, v66, v67
  buffer_store_dwordx2 v[10:11], v17, s[8:11], s22 offen
  v_cvt_pk_bf16_f32 v12, v68, v69
  v_cvt_pk_bf16_f32 v13, v70, v71
  buffer_store_dwordx2 v[12:13], v18, s[8:11], s22 offen
  v_cvt_pk_bf16_f32 v14, v72, v73
  v_cvt_pk_bf16_f32 v15, v74, v75
  buffer_store_dwordx2 v[14:15], v19, s[8:11], s22 offen
  s_waitcnt vmcnt(12)
  ds_read_b128 v[76:79], v48 offset:16384
  ds_read_b128 v[80:83], v49 offset:16384
  ds_read_b128 v[84:87], v50 offset:16384
  ds_read_b128 v[88:91], v51 offset:16384
  ds_read_b128 v[92:95], v52 offset:16384
  ds_read_b128 v[96:99], v53 offset:16384
  ds_read_b128 v[100:103], v54 offset:16384
  ds_read_b128 v[104:107], v55 offset:16384
  s_waitcnt lgkmcnt(7)
  v_mfma_f32_16x16x32_bf16 v[60:63], v[76:79], v[108:111], 0
  v_mfma_f32_16x16x32_bf16 v[64:67], v[76:79], v[140:143], 0
  v_mfma_f32_16x16x32_bf16 v[68:71], v[76:79], v[172:175], 0
  v_mfma_f32_16x16x32_bf16 v[72:75], v[76:79], v[204:207], 0
  s_waitcnt lgkmcnt(6)
  v_mfma_f32_16x16x32_bf16 v[60:63], v[80:83], v[112:115], v[60:63]
  v_mfma_f32_16x16x32_bf16 v[64:67], v[80:83], v[144:147], v[64:67]
  v_mfma_f32_16x16x32_bf16 v[68:71], v[80:83], v[176:179], v[68:71]
  v_mfma_f32_16x16x32_bf16 v[72:75], v[80:83], v[208:211], v[72:75]
  s_waitcnt lgkmcnt(5)
  v_mfma_f32_16x16x32_bf16 v[60:63], v[84:87], v[116:119], v[60:63]
  v_mfma_f32_16x16x32_bf16 v[64:67], v[84:87], v[148:151], v[64:67]
  v_mfma_f32_16x16x32_bf16 v[68:71], v[84:87], v[180:183], v[68:71]
  v_mfma_f32_16x16x32_bf16 v[72:75], v[84:87], v[212:215], v[72:75]
  s_waitcnt lgkmcnt(4)
  v_mfma_f32_16x16x32_bf16 v[60:63], v[88:91], v[120:123], v[60:63]
  v_mfma_f32_16x16x32_bf16 v[64:67], v[88:91], v[152:155], v[64:67]
  v_mfma_f32_16x16x32_bf16 v[68:71], v[88:91], v[184:187], v[68:71]
  v_mfma_f32_16x16x32_bf16 v[72:75], v[88:91], v[216:219], v[72:75]
  s_waitcnt lgkmcnt(3)
  v_mfma_f32_16x16x32_bf16 v[60:63], v[92:95], v[124:127], v[60:63]
  v_mfma_f32_16x16x32_bf16 v[64:67], v[92:95], v[156:159], v[64:67]
  v_mfma_f32_16x16x32_bf16 v[68:71], v[92:95], v[188:191], v[68:71]
  v_mfma_f32_16x16x32_bf16 v[72:75], v[92:95], v[220:223], v[72:75]
  s_waitcnt lgkmcnt(2)
  v_mfma_f32_16x16x32_bf16 v[60:63], v[96:99], v[128:131], v[60:63]
  v_mfma_f32_16x16x32_bf16 v[64:67], v[96:99], v[160:163], v[64:67]
  v_mfma_f32_16x16x32_bf16 v[68:71], v[96:99], v[192:195], v[68:71]
  v_mfma_f32_16x16x32_bf16 v[72:75], v[96:99], v[224:227], v[72:75]
  s_waitcnt lgkmcnt(1)
  v_mfma_f32_16x16x32_bf16 v[60:63], v[100:103], v[132:135], v[60:63]
  v_mfma_f32_16x16x32_bf16 v[64:67], v[100:103], v[164:167], v[64:67]
  v_mfma_f32_16x16x32_bf16 v[68:71], v[100:103], v[196:199], v[68:71]
  v_mfma_f32_16x16x32_bf16 v[72:75], v[100:103], v[228:231], v[72:75]
  s_waitcnt lgkmcnt(0)
  v_mfma_f32_16x16x32_bf16 v[60:63], v[104:107], v[136:139], v[60:63]
  v_mfma_f32_16x16x32_bf16 v[64:67], v[104:107], v[168:171], v[64:67]
  v_mfma_f32_16x16x32_bf16 v[68:71], v[104:107], v[200:203], v[68:71]
  v_mfma_f32_16x16x32_bf16 v[72:75], v[104:107], v[232:235], v[72:75]
  s_add_u32 s36, s33, 5
  s_sub_u32 s34, s36, 7
  s_cmp_ge_u32 s36, 7
  s_cselect_b32 s36, s34, s36
  s_lshl_b32 s36, s36, 12
  s_add_u32 s22, s30, s36
  v_cvt_pk_bf16_f32 v8, v60, v61
  v_cvt_pk_bf16_f32 v9, v62, v63
  buffer_store_dwordx2 v[8:9], v16, s[8:11], s22 offen
  v_cvt_pk_bf16_f32 v10, v64, v65
  v_cvt_pk_bf16_f32 v11, v66, v67
  buffer_store_dwordx2 v[10:11], v17, s[8:11], s22 offen
  v_cvt_pk_bf16_f32 v12, v68, v69
  v_cvt_pk_bf16_f32 v13, v70, v71
  buffer_store_dwordx2 v[12:13], v18, s[8:11], s22 offen
  v_cvt_pk_bf16_f32 v14, v72, v73
  v_cvt_pk_bf16_f32 v15, v74, v75
  buffer_store_dwordx2 v[14:15], v19, s[8:11], s22 offen
  s_waitcnt vmcnt(4)
  ds_read_b128 v[76:79], v48 offset:0
  ds_read_b128 v[80:83], v49 offset:0
  ds_read_b128 v[84:87], v50 offset:0
  ds_read_b128 v[88:91], v51 offset:0
  ds_read_b128 v[92:95], v52 offset:0
  ds_read_b128 v[96:99], v53 offset:0
  ds_read_b128 v[100:103], v54 offset:0
  ds_read_b128 v[104:107], v55 offset:0
  s_waitcnt lgkmcnt(7)
  v_mfma_f32_16x16x32_bf16 v[60:63], v[76:79], v[108:111], 0
  v_mfma_f32_16x16x32_bf16 v[64:67], v[76:79], v[140:143], 0
  v_mfma_f32_16x16x32_bf16 v[68:71], v[76:79], v[172:175], 0
  v_mfma_f32_16x16x32_bf16 v[72:75], v[76:79], v[204:207], 0
  s_waitcnt lgkmcnt(6)
  v_mfma_f32_16x16x32_bf16 v[60:63], v[80:83], v[112:115], v[60:63]
  v_mfma_f32_16x16x32_bf16 v[64:67], v[80:83], v[144:147], v[64:67]
  v_mfma_f32_16x16x32_bf16 v[68:71], v[80:83], v[176:179], v[68:71]
  v_mfma_f32_16x16x32_bf16 v[72:75], v[80:83], v[208:211], v[72:75]
  s_waitcnt lgkmcnt(5)
  v_mfma_f32_16x16x32_bf16 v[60:63], v[84:87], v[116:119], v[60:63]
  v_mfma_f32_16x16x32_bf16 v[64:67], v[84:87], v[148:151], v[64:67]
  v_mfma_f32_16x16x32_bf16 v[68:71], v[84:87], v[180:183], v[68:71]
  v_mfma_f32_16x16x32_bf16 v[72:75], v[84:87], v[212:215], v[72:75]
  s_waitcnt lgkmcnt(4)
  v_mfma_f32_16x16x32_bf16 v[60:63], v[88:91], v[120:123], v[60:63]
  v_mfma_f32_16x16x32_bf16 v[64:67], v[88:91], v[152:155], v[64:67]
  v_mfma_f32_16x16x32_bf16 v[68:71], v[88:91], v[184:187], v[68:71]
  v_mfma_f32_16x16x32_bf16 v[72:75], v[88:91], v[216:219], v[72:75]
  s_waitcnt lgkmcnt(3)
  v_mfma_f32_16x16x32_bf16 v[60:63], v[92:95], v[124:127], v[60:63]
  v_mfma_f32_16x16x32_bf16 v[64:67], v[92:95], v[156:159], v[64:67]
  v_mfma_f32_16x16x32_bf16 v[68:71], v[92:95], v[188:191], v[68:71]
  v_mfma_f32_16x16x32_bf16 v[72:75], v[92:95], v[220:223], v[72:75]
  s_waitcnt lgkmcnt(2)
  v_mfma_f32_16x16x32_bf16 v[60:63], v[96:99], v[128:131], v[60:63]
  v_mfma_f32_16x16x32_bf16 v[64:67], v[96:99], v[160:163], v[64:67]
  v_mfma_f32_16x16x32_bf16 v[68:71], v[96:99], v[192:195], v[68:71]
  v_mfma_f32_16x16x32_bf16 v[72:75], v[96:99], v[224:227], v[72:75]
  s_waitcnt lgkmcnt(1)
  v_mfma_f32_16x16x32_bf16 v[60:63], v[100:103], v[132:135], v[60:63]
  v_mfma_f32_16x16x32_bf16 v[64:67], v[100:103], v[164:167], v[64:67]
  v_mfma_f32_16x16x32_bf16 v[68:71], v[100:103], v[196:199], v[68:71]
  v_mfma_f32_16x16x32_bf16 v[72:75], v[100:103], v[228:231], v[72:75]
  s_waitcnt lgkmcnt(0)
  v_mfma_f32_16x16x32_bf16 v[60:63], v[104:107], v[136:139], v[60:63]
  v_mfma_f32_16x16x32_bf16 v[64:67], v[104:107], v[168:171], v[64:67]
  v_mfma_f32_16x16x32_bf16 v[68:71], v[104:107], v[200:203], v[68:71]
  v_mfma_f32_16x16x32_bf16 v[72:75], v[104:107], v[232:235], v[72:75]
  s_add_u32 s36, s33, 6
  s_sub_u32 s34, s36, 7
  s_cmp_ge_u32 s36, 7
  s_cselect_b32 s36, s34, s36
  s_lshl_b32 s36, s36, 12
  s_add_u32 s22, s30, s36
  v_cvt_pk_bf16_f32 v8, v60, v61
  v_cvt_pk_bf16_f32 v9, v62, v63
  buffer_store_dwordx2 v[8:9], v16, s[8:11], s22 offen
  v_cvt_pk_bf16_f32 v10, v64, v65
  v_cvt_pk_bf16_f32 v11, v66, v67
  buffer_store_dwordx2 v[10:11], v17, s[8:11], s22 offen
  v_cvt_pk_bf16_f32 v12, v68, v69
  v_cvt_pk_bf16_f32 v13, v70, v71
  buffer_store_dwordx2 v[12:13], v18, s[8:11], s22 offen
  v_cvt_pk_bf16_f32 v14, v72, v73
  v_cvt_pk_bf16_f32 v15, v74, v75
  buffer_store_dwordx2 v[14:15], v19, s[8:11], s22 offen
  s_branch L_done
L_ln:
  s_lshl_b32 s20, s20, 1
L_ln_again:
  s_load_dwordx2 s[16:17], s[0:1], 0
  s_waitcnt lgkmcnt(0)
  s_mov_b32 s12, s16
  s_mov_b32 s13, s17
  s_mov_b32 s14, 1835008
  s_mov_b32 s15, 0x00020000
  v_lshrrev_b32 v1, 3, v0
  v_and_b32 v2, 7, v0
  s_lshl_b32 s21, s3, 3
  v_add_u32 v3, s21, v1
  s_lshl_b32 s22, s20, 5
  v_add_u32 v4, s22, v3
  v_mul_u32_u24 v4, 896, v4
  v_mul_u32_u24 v5, 112, v2
  v_add_u32 v4, v4, v5
  s_cmp_lg_u32 s20, 62
  s_cbranch_scc1 L_ln_nom0
  s_load_dwordx2 s[44:45], s[0:1], 8
  s_waitcnt lgkmcnt(0)
  s_mov_b32 s40, s44
  s_mov_b32 s41, s45
  s_mov_b32 s42, 7168
  s_mov_b32 s43, 0x00020000
  s_lshl_b32 s21, s3, 6
  v_add_u32 v6, s21, v0
  v_lshlrev_b32 v7, 4, v6
  buffer_load_dwordx4 v[136:139], v7, s[40:43], 0 offen
  v_add_u32 v7, 4096, v7
  buffer_load_dwordx4 v[140:143], v7, s[40:43], 0 offen
L_ln_nom0:
  s_and_b32 s21, s20, 1
  s_cmp_eq_u32 s21, 0
  s_cbranch_scc0 L_ln_have2
  buffer_load_dwordx4 v[8:11], v4, s[12:15], 0 offen offset:0
  buffer_load_dwordx4 v[12:15], v4, s[12:15], 0 offen offset:16
  buffer_load_dwordx4 v[16:19], v4, s[12:15], 0 offen offset:32
  buffer_load_dwordx4 v[20:23], v4, s[12:15], 0 offen offset:48
  buffer_load_dwordx4 v[24:27], v4, s[12:15], 0 offen offset:64
  buffer_load_dwordx4 v[28:31], v4, s[12:15], 0 offen offset:80
  buffer_load_dwordx4 v[32:35], v4, s[12:15], 0 offen offset:96
  v_add_u32 v4, 28672, v4
  buffer_load_dwordx4 v[108:111], v4, s[12:15], 0 offen offset:0
  buffer_load_dwordx4 v[112:115], v4, s[12:15], 0 offen offset:16
  buffer_load_dwordx4 v[116:119], v4, s[12:15], 0 offen offset:32
  buffer_load_dwordx4 v[120:123], v4, s[12:15], 0 offen offset:48
  buffer_load_dwordx4 v[124:127], v4, s[12:15], 0 offen offset:64
  buffer_load_dwordx4 v[128:131], v4, s[12:15], 0 offen offset:80
  buffer_load_dwordx4 v[132:135], v4, s[12:15], 0 offen offset:96
  s_waitcnt vmcnt(7)
  s_nop 0
  s_branch L_ln_xok
L_ln_have2:
  s_waitcnt vmcnt(0)
  v_mov_b32 v8, v108
  v_mov_b32 v9, v109
  v_mov_b32 v10, v110
  v_mov_b32 v11, v111
  v_mov_b32 v12, v112
  v_mov_b32 v13, v113
  v_mov_b32 v14, v114
  v_mov_b32 v15, v115
  v_mov_b32 v16, v116
  v_mov_b32 v17, v117
  v_mov_b32 v18, v118
  v_mov_b32 v19, v119
  v_mov_b32 v20, v120
  v_mov_b32 v21, v121
  v_mov_b32 v22, v122
  v_mov_b32 v23, v123
  v_mov_b32 v24, v124
  v_mov_b32 v25, v125
  v_mov_b32 v26, v126
  v_mov_b32 v27, v127
  v_mov_b32 v28, v128
  v_mov_b32 v29, v129
  v_mov_b32 v30, v130
  v_mov_b32 v31, v131
  v_mov_b32 v32, v132
  v_mov_b32 v33, v133
  v_mov_b32 v34, v134
  v_mov_b32 v35, v135
L_ln_xok:
  v_mov_b32 v100, -1
  v_mov_b32 v101, -1
  v_mov_b32 v102, -1
  v_mov_b32 v103, -1
  s_cmp_ge_u32 s20, 63
  s_cbranch_scc1 L_ln_nosent
  s_lshl_b32 s21, s3, 6
  v_add_u32 v6, s21, v0
  v_lshlrev_b32 v6, 4, v6
  s_mul_i32 s21, s20, 7168
  s_add_u32 s21, s21, 48770048
  buffer_store_dwordx4 v[100:103], v6, s[8:11], s21 offen
  v_add_u32 v7, 4096, v6
  v_cmp_gt_u32 vcc, 7168, v7
  s_nop 0
  s_and_saveexec_b64 s[24:25], vcc
  buffer_store_dwordx4 v[100:103], v7, s[8:11], s21 offen
  s_mov_b64 exec, s[24:25]
  s_mul_i32 s21, s20, 10240
  s_add_u32 s21, s21, 49221632
  buffer_store_dwordx4 v[100:103], v6, s[8:11], s21 offen
  buffer_store_dwordx4 v[100:103], v7, s[8:11], s21 offen
  v_add_u32 v7, 8192, v6
  v_cmp_gt_u32 vcc, 10240, v7
  s_nop 0
  s_and_saveexec_b64 s[24:25], vcc
  buffer_store_dwordx4 v[100:103], v7, s[8:11], s21 offen
  s_mov_b64 exec, s[24:25]
L_ln_nosent:
  s_cmp_lg_u32 s20, 0
  s_cbranch_scc1 L_ln_nohint
  v_mov_b32 v104, 0
  s_lshl_b32 s21, s3, 6
  v_add_u32 v6, s21, v0
  v_lshlrev_b32 v6, 2, v6
  s_mov_b32 s21, 49876992
  buffer_store_dword v104, v6, s[8:11], s21 offen
L_ln_nohint:
  s_cmp_lg_u32 s20, 1
  s_cbranch_scc1 L_ln_noflg
  v_mov_b32 v104, 0
  v_mov_b32 v105, 0
  v_mov_b32 v106, 0
  v_mov_b32 v107, 0
  s_lshl_b32 s21, s3, 6
  v_add_u32 v6, s21, v0
  v_lshlrev_b32 v6, 4, v6
  s_mov_b32 s21, 49881088
  s_add_u32 s22, s21, 0
  buffer_store_dwordx4 v[104:107], v6, s[8:11], s22 offen
  s_add_u32 s22, s21, 4096
  buffer_store_dwordx4 v[104:107], v6, s[8:11], s22 offen
  s_add_u32 s22, s21, 8192
  buffer_store_dwordx4 v[104:107], v6, s[8:11], s22 offen
  s_add_u32 s22, s21, 12288
  buffer_store_dwordx4 v[104:107], v6, s[8:11], s22 offen
  s_add_u32 s22, s21, 16384
  buffer_store_dwordx4 v[104:107], v6, s[8:11], s22 offen
  s_add_u32 s22, s21, 20480
  buffer_store_dwordx4 v[104:107], v6, s[8:11], s22 offen
  s_add_u32 s22, s21, 24576
  buffer_store_dwordx4 v[104:107], v6, s[8:11], s22 offen
  s_add_u32 s22, s21, 28672
  buffer_store_dwordx4 v[104:107], v6, s[8:11], s22 offen
  s_add_u32 s22, s21, 32768
  buffer_store_dwordx4 v[104:107], v6, s[8:11], s22 offen
  s_add_u32 s22, s21, 36864
  buffer_store_dwordx4 v[104:107], v6, s[8:11], s22 offen
  s_add_u32 s22, s21, 40960
  buffer_store_dwordx4 v[104:107], v6, s[8:11], s22 offen
  s_add_u32 s22, s21, 45056
  buffer_store_dwordx4 v[104:107], v6, s[8:11], s22 offen
  s_add_u32 s22, s21, 49152
  buffer_store_dwordx4 v[104:107], v6, s[8:11], s22 offen
  s_add_u32 s22, s21, 53248
  buffer_store_dwordx4 v[104:107], v6, s[8:11], s22 offen
  s_add_u32 s22, s21, 57344
  buffer_store_dwordx4 v[104:107], v6, s[8:11], s22 offen
  s_add_u32 s22, s21, 61440
  buffer_store_dwordx4 v[104:107], v6, s[8:11], s22 offen
  s_add_u32 s22, s21, 65536
  buffer_store_dwordx4 v[104:107], v6, s[8:11], s22 offen
  s_add_u32 s22, s21, 69632
  buffer_store_dwordx4 v[104:107], v6, s[8:11], s22 offen
L_ln_noflg:
  v_lshlrev_b32 v40, 16, v8
  v_and_b32 v41, 0xffff0000, v8
  v_lshlrev_b32 v42, 16, v9
  v_and_b32 v43, 0xffff0000, v9
  v_lshlrev_b32 v44, 16, v10
  v_and_b32 v45, 0xffff0000, v10
  v_lshlrev_b32 v46, 16, v11
  v_and_b32 v47, 0xffff0000, v11
  v_lshlrev_b32 v48, 16, v12
  v_and_b32 v49, 0xffff0000, v12
  v_lshlrev_b32 v50, 16, v13
  v_and_b32 v51, 0xffff0000, v13
  v_lshlrev_b32 v52, 16, v14
  v_and_b32 v53, 0xffff0000, v14
  v_lshlrev_b32 v54, 16, v15
  v_and_b32 v55, 0xffff0000, v15
  v_lshlrev_b32 v56, 16, v16
  v_and_b32 v57, 0xffff0000, v16
  v_lshlrev_b32 v58, 16, v17
  v_and_b32 v59, 0xffff0000, v17
  v_lshlrev_b32 v60, 16, v18
  v_and_b32 v61, 0xffff0000, v18
  v_lshlrev_b32 v62, 16, v19
  v_and_b32 v63, 0xffff0000, v19
  v_lshlrev_b32 v64, 16, v20
  v_and_b32 v65, 0xffff0000, v20
  v_lshlrev_b32 v66, 16, v21
  v_and_b32 v67, 0xffff0000, v21
  v_lshlrev_b32 v68, 16, v22
  v_and_b32 v69, 0xffff0000, v22
  v_lshlrev_b32 v70, 16, v23
  v_and_b32 v71, 0xffff0000, v23
  v_lshlrev_b32 v72, 16, v24
  v_and_b32 v73, 0xffff0000, v24
  v_lshlrev_b32 v74, 16, v25
  v_and_b32 v75, 0xffff0000, v25
  v_lshlrev_b32 v76, 16, v26
  v_and_b32 v77, 0xffff0000, v26
  v_lshlrev_b32 v78, 16, v27
  v_and_b32 v79, 0xffff0000, v27
  v_lshlrev_b32 v80, 16, v28
  v_and_b32 v81, 0xffff0000, v28
  v_lshlrev_b32 v82, 16, v29
  v_and_b32 v83, 0xffff0000, v29
  v_lshlrev_b32 v84, 16, v30
  v_and_b32 v85, 0xffff0000, v30
  v_lshlrev_b32 v86, 16, v31
  v_and_b32 v87, 0xffff0000, v31
  v_lshlrev_b32 v88, 16, v32
  v_and_b32 v89, 0xffff0000, v32
  v_lshlrev_b32 v90, 16, v33
  v_and_b32 v91, 0xffff0000, v33
  v_lshlrev_b32 v92, 16, v34
  v_and_b32 v93, 0xffff0000, v34
  v_lshlrev_b32 v94, 16, v35
  v_and_b32 v95, 0xffff0000, v35
  v_add_f32 v96, v40, v44
  v_add_f32 v97, v41, v45
  v_add_f32 v98, v42, v46
  v_add_f32 v99, v43, v47
  v_add_f32 v96, v96, v48
  v_add_f32 v97, v97, v49
  v_add_f32 v98, v98, v50
  v_add_f32 v99, v99, v51
  v_add_f32 v96, v96, v52
  v_add_f32 v97, v97, v53
  v_add_f32 v98, v98, v54
  v_add_f32 v99, v99, v55
  v_add_f32 v96, v96, v56
  v_add_f32 v97, v97, v57
  v_add_f32 v98, v98, v58
  v_add_f32 v99, v99, v59
  v_add_f32 v96, v96, v60
  v_add_f32 v97, v97, v61
  v_add_f32 v98, v98, v62
  v_add_f32 v99, v99, v63
  v_add_f32 v96, v96, v64
  v_add_f32 v97, v97, v65
  v_add_f32 v98, v98, v66
  v_add_f32 v99, v99, v67
  v_add_f32 v96, v96, v68
  v_add_f32 v97, v97, v69
  v_add_f32 v98, v98, v70
  v_add_f32 v99, v99, v71
  v_add_f32 v96, v96, v72
  v_add_f32 v97, v97, v73
  v_add_f32 v98, v98, v74
  v_add_f32 v99, v99, v75
  v_add_f32 v96, v96, v76
  v_add_f32 v97, v97, v77
  v_add_f32 v98, v98, v78
  v_add_f32 v99, v99, v79
  v_add_f32 v96, v96, v80
  v_add_f32 v97, v97, v81
  v_add_f32 v98, v98, v82
  v_add_f32 v99, v99, v83
  v_add_f32 v96, v96, v84
  v_add_f32 v97, v97, v85
  v_add_f32 v98, v98, v86
  v_add_f32 v99, v99, v87
  v_add_f32 v96, v96, v88
  v_add_f32 v97, v97, v89
  v_add_f32 v98, v98, v90
  v_add_f32 v99, v99, v91
  v_add_f32 v96, v96, v92
  v_add_f32 v97, v97, v93
  v_add_f32 v98, v98, v94
  v_add_f32 v99, v99, v95
  v_add_f32 v96, v96, v97
  v_add_f32 v98, v98, v99
  v_add_f32 v96, v96, v98
  s_nop 1
  v_add_f32_dpp v96, v96, v96 quad_perm:[1,0,3,2] row_mask:0xf bank_mask:0xf
  s_nop 1
  v_add_f32_dpp v96, v96, v96 quad_perm:[2,3,0,1] row_mask:0xf bank_mask:0xf
  s_nop 1
  v_add_f32_dpp v96, v96, v96 row_half_mirror row_mask:0xf bank_mask:0xf
  v_mul_f32 v96, 0x3b124925, v96
  v_sub_f32 v40, v40, v96
  v_sub_f32 v41, v41, v96
  v_sub_f32 v42, v42, v96
  v_sub_f32 v43, v43, v96
  v_sub_f32 v44, v44, v96
  v_sub_f32 v45, v45, v96
  v_sub_f32 v46, v46, v96
  v_sub_f32 v47, v47, v96
  v_sub_f32 v48, v48, v96
  v_sub_f32 v49, v49, v96
  v_sub_f32 v50, v50, v96
  v_sub_f32 v51, v51, v96
  v_sub_f32 v52, v52, v96
  v_sub_f32 v53, v53, v96
  v_sub_f32 v54, v54, v96
  v_sub_f32 v55, v55, v96
  v_sub_f32 v56, v56, v96
  v_sub_f32 v57, v57, v96
  v_sub_f32 v58, v58, v96
  v_sub_f32 v59, v59, v96
  v_sub_f32 v60, v60, v96
  v_sub_f32 v61, v61, v96
  v_sub_f32 v62, v62, v96
  v_sub_f32 v63, v63, v96
  v_sub_f32 v64, v64, v96
  v_sub_f32 v65, v65, v96
  v_sub_f32 v66, v66, v96
  v_sub_f32 v67, v67, v96
  v_sub_f32 v68, v68, v96
  v_sub_f32 v69, v69, v96
  v_sub_f32 v70, v70, v96
  v_sub_f32 v71, v71, v96
  v_sub_f32 v72, v72, v96
  v_sub_f32 v73, v73, v96
  v_sub_f32 v74, v74, v96
  v_sub_f32 v75, v75, v96
  v_sub_f32 v76, v76, v96
  v_sub_f32 v77, v77, v96
  v_sub_f32 v78, v78, v96
  v_sub_f32 v79, v79, v96
  v_sub_f32 v80, v80, v96
  v_sub_f32 v81, v81, v96
  v_sub_f32 v82, v82, v96
  v_sub_f32 v83, v83, v96
  v_sub_f32 v84, v84, v96
  v_sub_f32 v85, v85, v96
  v_sub_f32 v86, v86, v96
  v_sub_f32 v87, v87, v96
  v_sub_f32 v88, v88, v96
  v_sub_f32 v89, v89, v96
  v_sub_f32 v90, v90, v96
  v_sub_f32 v91, v91, v96
  v_sub_f32 v92, v92, v96
  v_sub_f32 v93, v93, v96
  v_sub_f32 v94, v94, v96
  v_sub_f32 v95, v95, v96
  v_mul_f32 v96, v40, v40
  v_mul_f32 v97, v41, v41
  v_mul_f32 v98, v42, v42
  v_mul_f32 v99, v43, v43
  v_fmac_f32 v96, v44, v44
  v_fmac_f32 v97, v45, v45
  v_fmac_f32 v98, v46, v46
  v_fmac_f32 v99, v47, v47
  v_fmac_f32 v96, v48, v48
  v_fmac_f32 v97, v49, v49
  v_fmac_f32 v98, v50, v50
  v_fmac_f32 v99, v51, v51
  v_fmac_f32 v96, v52, v52
  v_fmac_f32 v97, v53, v53
  v_fmac_f32 v98, v54, v54
  v_fmac_f32 v99, v55, v55
  v_fmac_f32 v96, v56, v56
  v_fmac_f32 v97, v57, v57
  v_fmac_f32 v98, v58, v58
  v_fmac_f32 v99, v59, v59
  v_fmac_f32 v96, v60, v60
  v_fmac_f32 v97, v61, v61
  v_fmac_f32 v98, v62, v62
  v_fmac_f32 v99, v63, v63
  v_fmac_f32 v96, v64, v64
  v_fmac_f32 v97, v65, v65
  v_fmac_f32 v98, v66, v66
  v_fmac_f32 v99, v67, v67
  v_fmac_f32 v96, v68, v68
  v_fmac_f32 v97, v69, v69
  v_fmac_f32 v98, v70, v70
  v_fmac_f32 v99, v71, v71
  v_fmac_f32 v96, v72, v72
  v_fmac_f32 v97, v73, v73
  v_fmac_f32 v98, v74, v74
  v_fmac_f32 v99, v75, v75
  v_fmac_f32 v96, v76, v76
  v_fmac_f32 v97, v77, v77
  v_fmac_f32 v98, v78, v78
  v_fmac_f32 v99, v79, v79
  v_fmac_f32 v96, v80, v80
  v_fmac_f32 v97, v81, v81
  v_fmac_f32 v98, v82, v82
  v_fmac_f32 v99, v83, v83
  v_fmac_f32 v96, v84, v84
  v_fmac_f32 v97, v85, v85
  v_fmac_f32 v98, v86, v86
  v_fmac_f32 v99, v87, v87
  v_fmac_f32 v96, v88, v88
  v_fmac_f32 v97, v89, v89
  v_fmac_f32 v98, v90, v90
  v_fmac_f32 v99, v91, v91
  v_fmac_f32 v96, v92, v92
  v_fmac_f32 v97, v93, v93
  v_fmac_f32 v98, v94, v94
  v_fmac_f32 v99, v95, v95
  v_add_f32 v96, v96, v97
  v_add_f32 v98, v98, v99
  v_add_f32 v96, v96, v98
  s_nop 1
  v_add_f32_dpp v96, v96, v96 quad_perm:[1,0,3,2] row_mask:0xf bank_mask:0xf
  s_nop 1
  v_add_f32_dpp v96, v96, v96 quad_perm:[2,3,0,1] row_mask:0xf bank_mask:0xf
  s_nop 1
  v_add_f32_dpp v96, v96, v96 row_half_mirror row_mask:0xf bank_mask:0xf
  v_mov_b32 v97, 0x3727c5ac
  v_fmac_f32 v97, 0x3b124925, v96
  v_rsq_f32 v97, v97
  s_nop 0
  v_mul_f32 v40, v40, v97
  v_mul_f32 v41, v41, v97
  v_mul_f32 v42, v42, v97
  v_mul_f32 v43, v43, v97
  v_mul_f32 v44, v44, v97
  v_mul_f32 v45, v45, v97
  v_mul_f32 v46, v46, v97
  v_mul_f32 v47, v47, v97
  v_mul_f32 v48, v48, v97
  v_mul_f32 v49, v49, v97
  v_mul_f32 v50, v50, v97
  v_mul_f32 v51, v51, v97
  v_mul_f32 v52, v52, v97
  v_mul_f32 v53, v53, v97
  v_mul_f32 v54, v54, v97
  v_mul_f32 v55, v55, v97
  v_mul_f32 v56, v56, v97
  v_mul_f32 v57, v57, v97
  v_mul_f32 v58, v58, v97
  v_mul_f32 v59, v59, v97
  v_mul_f32 v60, v60, v97
  v_mul_f32 v61, v61, v97
  v_mul_f32 v62, v62, v97
  v_mul_f32 v63, v63, v97
  v_mul_f32 v64, v64, v97
  v_mul_f32 v65, v65, v97
  v_mul_f32 v66, v66, v97
  v_mul_f32 v67, v67, v97
  v_mul_f32 v68, v68, v97
  v_mul_f32 v69, v69, v97
  v_mul_f32 v70, v70, v97
  v_mul_f32 v71, v71, v97
  v_mul_f32 v72, v72, v97
  v_mul_f32 v73, v73, v97
  v_mul_f32 v74, v74, v97
  v_mul_f32 v75, v75, v97
  v_mul_f32 v76, v76, v97
  v_mul_f32 v77, v77, v97
  v_mul_f32 v78, v78, v97
  v_mul_f32 v79, v79, v97
  v_mul_f32 v80, v80, v97
  v_mul_f32 v81, v81, v97
  v_mul_f32 v82, v82, v97
  v_mul_f32 v83, v83, v97
  v_mul_f32 v84, v84, v97
  v_mul_f32 v85, v85, v97
  v_mul_f32 v86, v86, v97
  v_mul_f32 v87, v87, v97
  v_mul_f32 v88, v88, v97
  v_mul_f32 v89, v89, v97
  v_mul_f32 v90, v90, v97
  v_mul_f32 v91, v91, v97
  v_mul_f32 v92, v92, v97
  v_mul_f32 v93, v93, v97
  v_mul_f32 v94, v94, v97
  v_mul_f32 v95, v95, v97
  v_cvt_pk_bf16_f32 v8, v40, v41
  v_cvt_pk_bf16_f32 v9, v42, v43
  v_cvt_pk_bf16_f32 v10, v44, v45
  v_cvt_pk_bf16_f32 v11, v46, v47
  v_cvt_pk_bf16_f32 v12, v48, v49
  v_cvt_pk_bf16_f32 v13, v50, v51
  v_cvt_pk_bf16_f32 v14, v52, v53
  v_cvt_pk_bf16_f32 v15, v54, v55
  v_cvt_pk_bf16_f32 v16, v56, v57
  v_cvt_pk_bf16_f32 v17, v58, v59
  v_cvt_pk_bf16_f32 v18, v60, v61
  v_cvt_pk_bf16_f32 v19, v62, v63
  v_cvt_pk_bf16_f32 v20, v64, v65
  v_cvt_pk_bf16_f32 v21, v66, v67
  v_cvt_pk_bf16_f32 v22, v68, v69
  v_cvt_pk_bf16_f32 v23, v70, v71
  v_cvt_pk_bf16_f32 v24, v72, v73
  v_cvt_pk_bf16_f32 v25, v74, v75
  v_cvt_pk_bf16_f32 v26, v76, v77
  v_cvt_pk_bf16_f32 v27, v78, v79
  v_cvt_pk_bf16_f32 v28, v80, v81
  v_cvt_pk_bf16_f32 v29, v82, v83
  v_cvt_pk_bf16_f32 v30, v84, v85
  v_cvt_pk_bf16_f32 v31, v86, v87
  v_cvt_pk_bf16_f32 v32, v88, v89
  v_cvt_pk_bf16_f32 v33, v90, v91
  v_cvt_pk_bf16_f32 v34, v92, v93
  v_cvt_pk_bf16_f32 v35, v94, v95
  v_mul_u32_u24 v5, 3584, v2
  v_lshl_add_u32 v5, v3, 4, v5
  s_mul_i32 s21, s20, 28672
  s_add_u32 s22, s21, 0
  buffer_store_dwordx4 v[8:11], v5, s[8:11], s22 offen offset:0
  buffer_store_dwordx4 v[12:15], v5, s[8:11], s22 offen offset:512
  buffer_store_dwordx4 v[16:19], v5, s[8:11], s22 offen offset:1024
  buffer_store_dwordx4 v[20:23], v5, s[8:11], s22 offen offset:1536
  buffer_store_dwordx4 v[24:27], v5, s[8:11], s22 offen offset:2048
  buffer_store_dwordx4 v[28:31], v5, s[8:11], s22 offen offset:2560
  buffer_store_dwordx4 v[32:35], v5, s[8:11], s22 offen offset:3072
  v_mul_u32_u24 v5, 904, v3
  v_mul_u32_u24 v6, 112, v2
  v_add_u32 v5, v5, v6
  ds_write_b64 v5, v[8:9] offset:0
  ds_write_b64 v5, v[10:11] offset:8
  ds_write_b64 v5, v[12:13] offset:16
  ds_write_b64 v5, v[14:15] offset:24
  ds_write_b64 v5, v[16:17] offset:32
  ds_write_b64 v5, v[18:19] offset:40
  ds_write_b64 v5, v[20:21] offset:48
  ds_write_b64 v5, v[22:23] offset:56
  ds_write_b64 v5, v[24:25] offset:64
  ds_write_b64 v5, v[26:27] offset:72
  ds_write_b64 v5, v[28:29] offset:80
  ds_write_b64 v5, v[30:31] offset:88
  ds_write_b64 v5, v[32:33] offset:96
  ds_write_b64 v5, v[34:35] offset:104
  s_waitcnt lgkmcnt(0)
  s_barrier
  v_and_b32 v1, 15, v0
  v_lshrrev_b32 v2, 4, v0
  v_mul_u32_u24 v3, 904, v1
  s_mul_i32 s21, s3, 224
  v_add_u32 v3, s21, v3
  v_lshrrev_b32 v4, 1, v2
  v_and_b32 v5, 1, v2
  v_lshl_add_u32 v6, v4, 5, v3
  v_lshl_add_u32 v6, v5, 2, v6
  v_lshl_add_u32 v7, v5, 4, v3
  v_lshl_add_u32 v7, v4, 2, v7
  v_lshlrev_b32 v4, 4, v0
  v_lshlrev_b32 v5, 3, v0
  s_mul_i32 s21, s20, 28672
  s_mul_i32 s22, s3, 7168
  s_add_u32 s21, s21, s22
  s_add_u32 s21, s21, 1835008
  ds_read_b32 v8, v6 offset:0
  ds_read_b32 v9, v6 offset:8
  ds_read_b32 v10, v6 offset:16
  ds_read_b32 v11, v6 offset:24
  ds_read_b32 v12, v6 offset:64
  ds_read_b32 v13, v6 offset:72
  ds_read_b32 v14, v6 offset:80
  ds_read_b32 v15, v6 offset:88
  ds_read_b32 v16, v6 offset:128
  ds_read_b32 v17, v6 offset:136
  ds_read_b32 v18, v6 offset:144
  ds_read_b32 v19, v6 offset:152
  ds_read_b32 v20, v7 offset:192
  ds_read_b32 v21, v7 offset:200
  s_waitcnt lgkmcnt(0)
  s_add_u32 s22, s21, 0
  buffer_store_dwordx4 v[8:11], v4, s[8:11], s22 offen
  s_add_u32 s22, s21, 1024
  buffer_store_dwordx4 v[12:15], v4, s[8:11], s22 offen
  s_add_u32 s22, s21, 2048
  buffer_store_dwordx4 v[16:19], v4, s[8:11], s22 offen
  s_add_u32 s22, s21, 3072
  buffer_store_dwordx2 v[20:21], v5, s[8:11], s22 offen
  ds_read_b32 v22, v6 offset:14464
  ds_read_b32 v23, v6 offset:14472
  ds_read_b32 v24, v6 offset:14480
  ds_read_b32 v25, v6 offset:14488
  ds_read_b32 v26, v6 offset:14528
  ds_read_b32 v27, v6 offset:14536
  ds_read_b32 v28, v6 offset:14544
  ds_read_b32 v29, v6 offset:14552
  ds_read_b32 v30, v6 offset:14592
  ds_read_b32 v31, v6 offset:14600
  ds_read_b32 v32, v6 offset:14608
  ds_read_b32 v33, v6 offset:14616
  ds_read_b32 v34, v7 offset:14656
  ds_read_b32 v35, v7 offset:14664
  s_waitcnt lgkmcnt(0)
  s_add_u32 s22, s21, 3584
  buffer_store_dwordx4 v[22:25], v4, s[8:11], s22 offen
  s_add_u32 s22, s21, 4608
  buffer_store_dwordx4 v[26:29], v4, s[8:11], s22 offen
  s_add_u32 s22, s21, 5632
  buffer_store_dwordx4 v[30:33], v4, s[8:11], s22 offen
  s_add_u32 s22, s21, 6656
  buffer_store_dwordx2 v[34:35], v5, s[8:11], s22 offen
  v_and_b32 v1, 31, v0
  v_lshrrev_b32 v2, 5, v0
  v_mul_u32_u24 v3, 904, v1
  s_mul_i32 s21, s3, 224
  v_add_u32 v3, s21, v3
  v_lshl_add_u32 v60, v2, 5, v3
  v_lshl_add_u32 v61, v2, 2, v3
  v_lshl_add_u32 v62, v2, 4, v3
  v_lshlrev_b32 v4, 4, v0
  s_mul_i32 s21, s20, 28672
  s_mul_i32 s22, s3, 7168
  s_add_u32 s21, s21, s22
  s_add_u32 s21, s21, 3670016
  ds_read_b32 v64, v60 offset:0
  ds_read_b32 v65, v60 offset:16
  ds_read_b32 v66, v60 offset:64
  ds_read_b32 v67, v60 offset:80
  ds_read_b32 v68, v60 offset:8
  ds_read_b32 v69, v60 offset:24
  ds_read_b32 v70, v60 offset:72
  ds_read_b32 v71, v60 offset:88
  ds_read_b32 v72, v60 offset:4
  ds_read_b32 v73, v60 offset:20
  ds_read_b32 v74, v60 offset:68
  ds_read_b32 v75, v60 offset:84
  s_waitcnt lgkmcnt(0)
  s_add_u32 s22, s21, 0
  buffer_store_dwordx4 v[64:67], v4, s[8:11], s22 offen
  s_add_u32 s22, s21, 1024
  buffer_store_dwordx4 v[68:71], v4, s[8:11], s22 offen
  s_add_u32 s22, s21, 2048
  buffer_store_dwordx4 v[72:75], v4, s[8:11], s22 offen
  ds_read_b32 v76, v60 offset:12
  ds_read_b32 v77, v60 offset:28
  ds_read_b32 v78, v60 offset:76
  ds_read_b32 v79, v60 offset:92
  ds_read_b32 v80, v61 offset:128
  ds_read_b32 v81, v61 offset:144
  ds_read_b32 v82, v61 offset:160
  ds_read_b32 v83, v61 offset:176
  ds_read_b32 v84, v61 offset:136
  ds_read_b32 v85, v61 offset:152
  ds_read_b32 v86, v61 offset:168
  ds_read_b32 v87, v61 offset:184
  s_waitcnt lgkmcnt(0)
  s_add_u32 s22, s21, 3072
  buffer_store_dwordx4 v[76:79], v4, s[8:11], s22 offen
  s_add_u32 s22, s21, 4096
  buffer_store_dwordx4 v[80:83], v4, s[8:11], s22 offen
  s_add_u32 s22, s21, 5120
  buffer_store_dwordx4 v[84:87], v4, s[8:11], s22 offen
  ds_read_b32 v88, v62 offset:192
  ds_read_b32 v89, v62 offset:200
  ds_read_b32 v90, v62 offset:196
  ds_read_b32 v91, v62 offset:204
  s_waitcnt lgkmcnt(0)
  s_add_u32 s22, s21, 6144
  buffer_store_dwordx4 v[88:91], v4, s[8:11], s22 offen
  s_and_b32 s21, s20, 1
  s_cmp_eq_u32 s21, 0
  s_cbranch_scc0 L_ln_second
  s_add_u32 s20, s20, 1
  s_waitcnt lgkmcnt(0)
  s_barrier
  s_branch L_ln_again
L_ln_second:
  s_cmp_lg_u32 s20, 63
  s_cbranch_scc1 L_done
  s_waitcnt lgkmcnt(0)
  s_barrier
  s_lshl_b32 s21, s3, 6
  v_add_u32 v6, s21, v0
  s_mov_b32 s21, 0x4924925
  v_mul_hi_u32 v16, v6, s21
  v_mul_u32_u24 v17, 56, v16
  v_sub_u32 v17, v6, v17
  v_mul_u32_u24 v16, 904, v16
  v_lshl_add_u32 v16, v17, 4, v16
  v_add_u32 v6, 256, v6
  v_mul_hi_u32 v18, v6, s21
  v_mul_u32_u24 v19, 56, v18
  v_sub_u32 v19, v6, v19
  v_mul_u32_u24 v18, 904, v18
  v_lshl_add_u32 v18, v19, 4, v18
  ds_write_b64 v16, v[136:137]
  ds_write_b64 v16, v[138:139] offset:8
  v_cmp_gt_u32 vcc, 448, v6
  s_nop 0
  s_and_saveexec_b64 s[24:25], vcc
  ds_write_b64 v18, v[140:141]
  ds_write_b64 v18, v[142:143] offset:8
  s_mov_b64 exec, s[24:25]
  s_waitcnt lgkmcnt(0)
  s_barrier
  v_and_b32 v1, 7, v0
  v_lshrrev_b32 v2, 3, v0
  v_mul_u32_u24 v3, 904, v1
  v_lshrrev_b32 v4, 1, v2
  v_and_b32 v5, 1, v2
  v_lshl_add_u32 v6, v4, 5, v3
  v_lshl_add_u32 v6, v5, 2, v6
  s_lshl_b32 s21, s3, 7
  v_add_u32 v6, s21, v6
  v_lshlrev_b32 v4, 7, v2
  v_lshl_add_u32 v4, v1, 4, v4
  s_lshl_b32 s21, s3, 10
  s_add_u32 s21, s21, 48762880
  ds_read_b32 v8, v6 offset:0
  ds_read_b32 v9, v6 offset:8
  ds_read_b32 v10, v6 offset:16
  ds_read_b32 v11, v6 offset:24
  s_waitcnt lgkmcnt(0)
  buffer_store_dwordx4 v[8:11], v4, s[8:11], s21 offen
  s_cmp_eq_u32 s3, 3
  s_cbranch_scc1 L_mem_skip
  ds_read_b32 v12, v6 offset:512
  ds_read_b32 v13, v6 offset:520
  ds_read_b32 v14, v6 offset:528
  ds_read_b32 v15, v6 offset:536
  s_waitcnt lgkmcnt(0)
  s_add_u32 s22, s21, 4096
  buffer_store_dwordx4 v[12:15], v4, s[8:11], s22 offen
L_mem_skip:
  v_and_b32 v1, 31, v0
  v_lshrrev_b32 v2, 5, v0
  v_mul_u32_u24 v3, 904, v1
  s_mul_i32 s21, s3, 224
  v_add_u32 v3, s21, v3
  v_lshl_add_u32 v60, v2, 5, v3
  v_lshl_add_u32 v61, v2, 2, v3
  v_lshl_add_u32 v62, v2, 4, v3
  v_lshlrev_b32 v4, 7, v2
  v_lshl_add_u32 v4, v1, 4, v4
  s_mul_i32 s21, s3, 1792
  s_add_u32 s21, s21, 5505024
  s_mov_b32 exec_lo, 0xff
  s_mov_b32 exec_hi, 0xff
  ds_read_b32 v64, v60 offset:0
  ds_read_b32 v65, v60 offset:16
  ds_read_b32 v66, v60 offset:64
  ds_read_b32 v67, v60 offset:80
  ds_read_b32 v68, v60 offset:8
  ds_read_b32 v69, v60 offset:24
  ds_read_b32 v70, v60 offset:72
  ds_read_b32 v71, v60 offset:88
  ds_read_b32 v72, v60 offset:4
  ds_read_b32 v73, v60 offset:20
  ds_read_b32 v74, v60 offset:68
  ds_read_b32 v75, v60 offset:84
  s_waitcnt lgkmcnt(0)
  s_add_u32 s22, s21, 0
  buffer_store_dwordx4 v[64:67], v4, s[8:11], s22 offen
  s_add_u32 s22, s21, 256
  buffer_store_dwordx4 v[68:71], v4, s[8:11], s22 offen
  s_add_u32 s22, s21, 512
  buffer_store_dwordx4 v[72:75], v4, s[8:11], s22 offen
  ds_read_b32 v76, v60 offset:12
  ds_read_b32 v77, v60 offset:28
  ds_read_b32 v78, v60 offset:76
  ds_read_b32 v79, v60 offset:92
  ds_read_b32 v80, v61 offset:128
  ds_read_b32 v81, v61 offset:144
  ds_read_b32 v82, v61 offset:160
  ds_read_b32 v83, v61 offset:176
  ds_read_b32 v84, v61 offset:136
  ds_read_b32 v85, v61 offset:152
  ds_read_b32 v86, v61 offset:168
  ds_read_b32 v87, v61 offset:184
  s_waitcnt lgkmcnt(0)
  s_add_u32 s22, s21, 768
  buffer_store_dwordx4 v[76:79], v4, s[8:11], s22 offen
  s_add_u32 s22, s21, 1024
  buffer_store_dwordx4 v[80:83], v4, s[8:11], s22 offen
  s_add_u32 s22, s21, 1280
  buffer_store_dwordx4 v[84:87], v4, s[8:11], s22 offen
  ds_read_b32 v88, v62 offset:192
  ds_read_b32 v89, v62 offset:200
  ds_read_b32 v90, v62 offset:196
  ds_read_b32 v91, v62 offset:204
  s_waitcnt lgkmcnt(0)
  s_add_u32 s22, s21, 1536
  buffer_store_dwordx4 v[88:91], v4, s[8:11], s22 offen
  s_mov_b64 exec, -1
  s_branch L_done
L_t1:
  s_load_dwordx2 s[16:17], s[0:1], 64
  s_waitcnt lgkmcnt(0)
  s_mov_b32 s12, s16
  s_mov_b32 s13, s17
  s_mov_b32 s14, 7340032
  s_mov_b32 s15, 0x00020000
  s_mul_hi_u32 s26, s20, 613566757
  s_mul_i32 s21, s26, 7
  s_sub_u32 s27, s20, s21
  v_lshrrev_b32 v1, 5, v0
  v_and_b32 v2, 31, v0
  s_lshl_b32 s21, s3, 4
  v_add_u32 v1, s21, v1
  v_mul_u32_u24 v3, 3584, v1
  v_lshl_add_u32 v3, v2, 4, v3
  s_mul_i32 s21, s26, 229376
  s_lshl_b32 s22, s27, 9
  s_add_u32 s21, s21, s22
  s_add_u32 s22, s21, 0
  buffer_load_dwordx4 v[8:11], v3, s[12:15], s22 offen
  s_add_u32 s22, s21, 7168
  buffer_load_dwordx4 v[12:15], v3, s[12:15], s22 offen
  s_add_u32 s22, s21, 14336
  buffer_load_dwordx4 v[16:19], v3, s[12:15], s22 offen
  s_add_u32 s22, s21, 21504
  buffer_load_dwordx4 v[20:23], v3, s[12:15], s22 offen
  s_add_u32 s22, s21, 28672
  buffer_load_dwordx4 v[24:27], v3, s[12:15], s22 offen
  s_add_u32 s22, s21, 35840
  buffer_load_dwordx4 v[28:31], v3, s[12:15], s22 offen
  s_add_u32 s22, s21, 43008
  buffer_load_dwordx4 v[32:35], v3, s[12:15], s22 offen
  s_add_u32 s22, s21, 50176
  buffer_load_dwordx4 v[36:39], v3, s[12:15], s22 offen
  v_mul_u32_u24 v1, 528, v1
  v_lshl_add_u32 v1, v2, 4, v1
  s_waitcnt vmcnt(0)
  ds_write_b128 v1, v[8:11] offset:0
  ds_write_b128 v1, v[12:15] offset:1056
  ds_write_b128 v1, v[16:19] offset:2112
  ds_write_b128 v1, v[20:23] offset:3168
  ds_write_b128 v1, v[24:27] offset:4224
  ds_write_b128 v1, v[28:31] offset:5280
  ds_write_b128 v1, v[32:35] offset:6336
  ds_write_b128 v1, v[36:39] offset:7392
  s_waitcnt lgkmcnt(0)
  s_barrier
  v_lshrrev_b32 v4, 4, v0
  v_and_b32 v5, 15, v0
  v_lshrrev_b32 v6, 1, v4
  v_lshlrev_b32 v6, 3, v6
  v_lshrrev_b32 v7, 2, v5
  v_add_u32 v6, v6, v7
  v_mul_u32_u24 v6, 528, v6
  v_and_b32 v7, 1, v4
  v_lshl_add_u32 v6, v7, 5, v6
  v_and_b32 v7, 3, v5
  v_lshl_add_u32 v6, v7, 3, v6
  s_lshl_b32 s21, s3, 7
  v_add_u32 v6, s21, v6
  v_lshlrev_b32 v7, 4, v0
  s_lshl_b32 s21, s27, 3
  s_lshl_b32 s22, s3, 1
  s_add_u32 s21, s21, s22
  s_mul_i32 s21, s21, 131072
  s_lshl_b32 s22, s26, 12
  s_add_u32 s21, s21, s22
  s_add_u32 s21, s21, 66768896
  ds_read_b64_tr_b16 v[8:9], v6 offset:0
  ds_read_b64_tr_b16 v[10:11], v6 offset:2112
  s_waitcnt lgkmcnt(0)
  s_add_u32 s22, s21, 0
  buffer_store_dwordx4 v[8:11], v7, s[8:11], s22 offen
  ds_read_b64_tr_b16 v[12:13], v6 offset:8448
  ds_read_b64_tr_b16 v[14:15], v6 offset:10560
  s_waitcnt lgkmcnt(0)
  s_add_u32 s22, s21, 1024
  buffer_store_dwordx4 v[12:15], v7, s[8:11], s22 offen
  ds_read_b64_tr_b16 v[16:17], v6 offset:16896
  ds_read_b64_tr_b16 v[18:19], v6 offset:19008
  s_waitcnt lgkmcnt(0)
  s_add_u32 s22, s21, 2048
  buffer_store_dwordx4 v[16:19], v7, s[8:11], s22 offen
  ds_read_b64_tr_b16 v[20:21], v6 offset:25344
  ds_read_b64_tr_b16 v[22:23], v6 offset:27456
  s_waitcnt lgkmcnt(0)
  s_add_u32 s22, s21, 3072
  buffer_store_dwordx4 v[20:23], v7, s[8:11], s22 offen
  ds_read_b64_tr_b16 v[24:25], v6 offset:64
  ds_read_b64_tr_b16 v[26:27], v6 offset:2176
  s_waitcnt lgkmcnt(0)
  s_add_u32 s22, s21, 131072
  buffer_store_dwordx4 v[24:27], v7, s[8:11], s22 offen
  ds_read_b64_tr_b16 v[28:29], v6 offset:8512
  ds_read_b64_tr_b16 v[30:31], v6 offset:10624
  s_waitcnt lgkmcnt(0)
  s_add_u32 s22, s21, 132096
  buffer_store_dwordx4 v[28:31], v7, s[8:11], s22 offen
  ds_read_b64_tr_b16 v[32:33], v6 offset:16960
  ds_read_b64_tr_b16 v[34:35], v6 offset:19072
  s_waitcnt lgkmcnt(0)
  s_add_u32 s22, s21, 133120
  buffer_store_dwordx4 v[32:35], v7, s[8:11], s22 offen
  ds_read_b64_tr_b16 v[36:37], v6 offset:25408
  ds_read_b64_tr_b16 v[38:39], v6 offset:27520
  s_waitcnt lgkmcnt(0)
  s_add_u32 s22, s21, 134144
  buffer_store_dwordx4 v[36:39], v7, s[8:11], s22 offen
  s_branch L_done
L_t2:
  s_load_dwordx2 s[16:17], s[0:1], 80
  s_waitcnt lgkmcnt(0)
  s_mov_b32 s12, s16
  s_mov_b32 s13, s17
  s_mov_b32 s14, 7340032
  s_mov_b32 s15, 0x00020000
  s_mul_hi_u32 s26, s20, 536870912
  s_mul_i32 s21, s26, 8
  s_sub_u32 s27, s20, s21
  v_lshrrev_b32 v1, 5, v0
  v_and_b32 v2, 31, v0
  s_lshl_b32 s21, s3, 4
  v_add_u32 v1, s21, v1
  v_mul_u32_u24 v3, 4096, v1
  v_lshl_add_u32 v3, v2, 4, v3
  s_mul_i32 s21, s26, 262144
  s_lshl_b32 s22, s27, 9
  s_add_u32 s21, s21, s22
  s_add_u32 s22, s21, 0
  buffer_load_dwordx4 v[8:11], v3, s[12:15], s22 offen
  s_add_u32 s22, s21, 8192
  buffer_load_dwordx4 v[12:15], v3, s[12:15], s22 offen
  s_add_u32 s22, s21, 16384
  buffer_load_dwordx4 v[16:19], v3, s[12:15], s22 offen
  s_add_u32 s22, s21, 24576
  buffer_load_dwordx4 v[20:23], v3, s[12:15], s22 offen
  s_add_u32 s22, s21, 32768
  buffer_load_dwordx4 v[24:27], v3, s[12:15], s22 offen
  s_add_u32 s22, s21, 40960
  buffer_load_dwordx4 v[28:31], v3, s[12:15], s22 offen
  s_add_u32 s22, s21, 49152
  buffer_load_dwordx4 v[32:35], v3, s[12:15], s22 offen
  s_add_u32 s22, s21, 57344
  buffer_load_dwordx4 v[36:39], v3, s[12:15], s22 offen
  v_mul_u32_u24 v1, 528, v1
  v_lshl_add_u32 v1, v2, 4, v1
  s_waitcnt vmcnt(0)
  ds_write_b128 v1, v[8:11] offset:0
  ds_write_b128 v1, v[12:15] offset:1056
  ds_write_b128 v1, v[16:19] offset:2112
  ds_write_b128 v1, v[20:23] offset:3168
  ds_write_b128 v1, v[24:27] offset:4224
  ds_write_b128 v1, v[28:31] offset:5280
  ds_write_b128 v1, v[32:35] offset:6336
  ds_write_b128 v1, v[36:39] offset:7392
  s_waitcnt lgkmcnt(0)
  s_barrier
  v_lshrrev_b32 v4, 4, v0
  v_and_b32 v5, 15, v0
  v_lshrrev_b32 v6, 1, v4
  v_lshlrev_b32 v6, 3, v6
  v_lshrrev_b32 v7, 2, v5
  v_add_u32 v6, v6, v7
  v_mul_u32_u24 v6, 528, v6
  v_and_b32 v7, 1, v4
  v_lshl_add_u32 v6, v7, 5, v6
  v_and_b32 v7, 3, v5
  v_lshl_add_u32 v6, v7, 3, v6
  s_lshl_b32 s21, s3, 7
  v_add_u32 v6, s21, v6
  v_lshlrev_b32 v7, 4, v0
  s_lshl_b32 s21, s27, 3
  s_lshl_b32 s22, s3, 1
  s_add_u32 s21, s21, s22
  s_mul_i32 s21, s21, 114688
  s_lshl_b32 s22, s26, 12
  s_add_u32 s21, s21, s22
  s_add_u32 s21, s21, 74108928
  ds_read_b64_tr_b16 v[8:9], v6 offset:0
  ds_read_b64_tr_b16 v[10:11], v6 offset:2112
  s_waitcnt lgkmcnt(0)
  s_add_u32 s22, s21, 0
  buffer_store_dwordx4 v[8:11], v7, s[8:11], s22 offen
  ds_read_b64_tr_b16 v[12:13], v6 offset:8448
  ds_read_b64_tr_b16 v[14:15], v6 offset:10560
  s_waitcnt lgkmcnt(0)
  s_add_u32 s22, s21, 1024
  buffer_store_dwordx4 v[12:15], v7, s[8:11], s22 offen
  ds_read_b64_tr_b16 v[16:17], v6 offset:16896
  ds_read_b64_tr_b16 v[18:19], v6 offset:19008
  s_waitcnt lgkmcnt(0)
  s_add_u32 s22, s21, 2048
  buffer_store_dwordx4 v[16:19], v7, s[8:11], s22 offen
  ds_read_b64_tr_b16 v[20:21], v6 offset:25344
  ds_read_b64_tr_b16 v[22:23], v6 offset:27456
  s_waitcnt lgkmcnt(0)
  s_add_u32 s22, s21, 3072
  buffer_store_dwordx4 v[20:23], v7, s[8:11], s22 offen
  ds_read_b64_tr_b16 v[24:25], v6 offset:64
  ds_read_b64_tr_b16 v[26:27], v6 offset:2176
  s_waitcnt lgkmcnt(0)
  s_add_u32 s22, s21, 114688
  buffer_store_dwordx4 v[24:27], v7, s[8:11], s22 offen
  ds_read_b64_tr_b16 v[28:29], v6 offset:8512
  ds_read_b64_tr_b16 v[30:31], v6 offset:10624
  s_waitcnt lgkmcnt(0)
  s_add_u32 s22, s21, 115712
  buffer_store_dwordx4 v[28:31], v7, s[8:11], s22 offen
  ds_read_b64_tr_b16 v[32:33], v6 offset:16960
  ds_read_b64_tr_b16 v[34:35], v6 offset:19072
  s_waitcnt lgkmcnt(0)
  s_add_u32 s22, s21, 116736
  buffer_store_dwordx4 v[32:35], v7, s[8:11], s22 offen
  ds_read_b64_tr_b16 v[36:37], v6 offset:25408
  ds_read_b64_tr_b16 v[38:39], v6 offset:27520
  s_waitcnt lgkmcnt(0)
  s_add_u32 s22, s21, 117760
  buffer_store_dwordx4 v[36:39], v7, s[8:11], s22 offen
  s_branch L_done
L_done:
  s_waitcnt vmcnt(0)
L_done2:
  s_endpgm

.section .rodata,"a"
.p2align 6
.amdhsa_kernel prep_kernel
  .amdhsa_next_free_vgpr 512
  .amdhsa_next_free_sgpr 100
  .amdhsa_accum_offset 256
  .amdhsa_group_segment_fixed_size 0
  .amdhsa_kernarg_size 120
  .amdhsa_user_sgpr_count 2
  .amdhsa_user_sgpr_kernarg_segment_ptr 1
  .amdhsa_system_sgpr_workgroup_id_x 1
.end_amdhsa_kernel
.text
.p2align 8
.globl main_kernel
.type main_kernel,@function
main_kernel:
  s_cmp_ge_u32 s2, 256
  s_cbranch_scc1 L_ch_end
  s_load_dwordx2 s[4:5], s[0:1], 112
  s_load_dwordx2 s[6:7], s[0:1], 104
  s_getreg_b32 s12, hwreg(HW_REG_XCC_ID, 0, 4)
  v_lshrrev_b32 v1, 6, v0
  v_and_b32 v0, 63, v0
  v_readfirstlane_b32 s13, v1
  s_waitcnt lgkmcnt(0)
  s_mov_b32 s8, s4
  s_mov_b32 s9, s5
  s_mov_b32 s10, 0x10000000
  s_mov_b32 s11, 0x00020000
  s_cmp_lg_u32 s13, 0
  s_cbranch_scc1 L_ch_el_wait
  s_mov_b64 s[18:19], exec
  s_mov_b64 exec, 1
  s_lshl_b32 s16, s12, 7
  s_add_u32 s16, s16, 49951744
  v_mov_b32 v3, 1
  buffer_atomic_add v3, off, s[8:11], s16 sc0
  s_mov_b32 s20, 49954048
  s_waitcnt vmcnt(0)
  v_readfirstlane_b32 s14, v3
  s_nop 0
  s_mov_b32 s34, s14
  s_cmp_lg_u32 s14, 31
  s_nop 0
  s_cbranch_scc1 L_ch_el_poll0
  s_lshl_b32 s16, s12, 2
  s_lshr_b32 s17, 0x37470536, s16
  s_and_b32 s17, s17, 15
L_ch_el_d:
  s_cmp_eq_u32 s17, 0
  s_nop 0
  s_cbranch_scc1 L_ch_el_dd
  s_sleep 8
  s_sub_u32 s17, s17, 1
  s_branch L_ch_el_d
L_ch_el_dd:
  s_add_u32 s16, s12, 1
  v_mov_b32 v4, s16
  v_mov_b32 v5, 0
  buffer_atomic_cmpswap v[4:5], off, s[8:11], s20
L_ch_el_poll0:
  s_mov_b32 s17, 0
  s_mov_b32 s15, 0
L_ch_el_poll:
  buffer_load_dword v3, off, s[8:11], s20 sc1
  s_add_u32 s17, s17, 1
  s_cmp_gt_u32 s17, 50000
  s_cbranch_scc1 L_ch_el_no
  s_waitcnt vmcnt(0)
  v_readfirstlane_b32 s16, v3
  s_nop 0
  s_cmp_eq_u32 s16, 0
  s_cbranch_scc1 L_ch_el_poll
  s_sub_u32 s15, s16, 1
  s_cmp_ge_u32 s14, 32
  s_cbranch_scc1 L_ch_el_no
  s_cmp_eq_u32 s15, s12
  s_cbranch_scc1 L_ch_el_yes
L_ch_el_no:
  s_mov_b32 s14, 255
L_ch_el_yes:
  v_mov_b32 v1, 20480
  v_mov_b32 v2, s14
  v_mov_b32 v3, s15
  v_mov_b32 v4, s34
  ds_write_b96 v1, v[2:4]
  s_waitcnt vmcnt(0) lgkmcnt(0)
  s_mov_b64 exec, s[18:19]
L_ch_el_wait:
  s_barrier
  v_mov_b32 v1, 20480
  ds_read_b96 v[2:4], v1
  s_waitcnt lgkmcnt(0)
  v_readfirstlane_b32 s14, v2
  v_readfirstlane_b32 s15, v3
  v_readfirstlane_b32 s34, v4
  s_cmp_ge_u32 s14, 32
  s_cbranch_scc1 L_worker
  v_and_b32 v2, 15, v0
  v_lshrrev_b32 v3, 4, v0
  v_lshrrev_b32 v4, 5, v0
  v_and_b32 v5, 1, v3
  v_lshlrev_b32 v1, 9, v3
  v_lshl_add_u32 v1, v2, 4, v1
  s_mul_i32 s22, s13, 7
  s_mov_b32 s38, s14
  s_cmp_ge_u32 s14, 16
  s_cbranch_scc1 L_ch_value
  s_mul_i32 s23, s14, 401408
  s_add_u32 s23, s23, 6553600
  s_lshl_b32 s40, s13, 1
  s_add_u32 s40, s40, 0
  s_sub_u32 s16, s40, 7
  s_cmp_ge_u32 s40, 7
  s_cselect_b32 s40, s16, s40
  s_sub_u32 s16, s40, 7
  s_cmp_ge_u32 s40, 7
  s_cselect_b32 s40, s16, s40
  s_lshl_b32 s40, s40, 12
  s_lshl_b32 s41, s13, 1
  s_add_u32 s41, s41, 1
  s_sub_u32 s16, s41, 7
  s_cmp_ge_u32 s41, 7
  s_cselect_b32 s41, s16, s41
  s_sub_u32 s16, s41, 7
  s_cmp_ge_u32 s41, 7
  s_cselect_b32 s41, s16, s41
  s_lshl_b32 s41, s41, 12
  s_lshl_b32 s42, s13, 1
  s_add_u32 s42, s42, 2
  s_sub_u32 s16, s42, 7
  s_cmp_ge_u32 s42, 7
  s_cselect_b32 s42, s16, s42
  s_sub_u32 s16, s42, 7
  s_cmp_ge_u32 s42, 7
  s_cselect_b32 s42, s16, s42
  s_lshl_b32 s42, s42, 12
  s_lshl_b32 s43, s13, 1
  s_add_u32 s43, s43, 3
  s_sub_u32 s16, s43, 7
  s_cmp_ge_u32 s43, 7
  s_cselect_b32 s43, s16, s43
  s_sub_u32 s16, s43, 7
  s_cmp_ge_u32 s43, 7
  s_cselect_b32 s43, s16, s43
  s_lshl_b32 s43, s43, 12
  s_lshl_b32 s44, s13, 1
  s_add_u32 s44, s44, 4
  s_sub_u32 s16, s44, 7
  s_cmp_ge_u32 s44, 7
  s_cselect_b32 s44, s16, s44
  s_sub_u32 s16, s44, 7
  s_cmp_ge_u32 s44, 7
  s_cselect_b32 s44, s16, s44
  s_lshl_b32 s44, s44, 12
  s_lshl_b32 s45, s13, 1
  s_add_u32 s45, s45, 5
  s_sub_u32 s16, s45, 7
  s_cmp_ge_u32 s45, 7
  s_cselect_b32 s45, s16, s45
  s_sub_u32 s16, s45, 7
  s_cmp_ge_u32 s45, 7
  s_cselect_b32 s45, s16, s45
  s_lshl_b32 s45, s45, 12
  s_lshl_b32 s46, s13, 1
  s_add_u32 s46, s46, 6
  s_sub_u32 s16, s46, 7
  s_cmp_ge_u32 s46, 7
  s_cselect_b32 s46, s16, s46
  s_sub_u32 s16, s46, 7
  s_cmp_ge_u32 s46, 7
  s_cselect_b32 s46, s16, s46
  s_lshl_b32 s46, s46, 12
  s_add_u32 s16, s22, 0
  s_lshr_b32 s17, s16, 1
  s_mul_i32 s17, s17, 28672
  s_and_b32 s16, s16, 1
  s_lshl_b32 s16, s16, 8
  s_add_u32 s16, s16, s17
  s_add_u32 s16, s16, s23
  s_add_u32 s20, s16, s40
  buffer_load_dwordx4 a[0:3], v1, s[8:11], s20 offen
  buffer_load_dwordx4 a[4:7], v1, s[8:11], s20 offen offset:2048
  s_add_u32 s20, s16, s41
  buffer_load_dwordx4 a[8:11], v1, s[8:11], s20 offen
  buffer_load_dwordx4 a[12:15], v1, s[8:11], s20 offen offset:2048
  s_add_u32 s20, s16, s42
  buffer_load_dwordx4 a[16:19], v1, s[8:11], s20 offen
  buffer_load_dwordx4 a[20:23], v1, s[8:11], s20 offen offset:2048
  s_add_u32 s20, s16, s43
  buffer_load_dwordx4 a[24:27], v1, s[8:11], s20 offen
  buffer_load_dwordx4 a[28:31], v1, s[8:11], s20 offen offset:2048
  s_add_u32 s20, s16, s44
  buffer_load_dwordx4 a[32:35], v1, s[8:11], s20 offen
  buffer_load_dwordx4 a[36:39], v1, s[8:11], s20 offen offset:2048
  s_add_u32 s20, s16, s45
  buffer_load_dwordx4 a[40:43], v1, s[8:11], s20 offen
  buffer_load_dwordx4 a[44:47], v1, s[8:11], s20 offen offset:2048
  s_add_u32 s20, s16, s46
  buffer_load_dwordx4 a[48:51], v1, s[8:11], s20 offen
  buffer_load_dwordx4 a[52:55], v1, s[8:11], s20 offen offset:2048
  s_add_u32 s16, s22, 1
  s_lshr_b32 s17, s16, 1
  s_mul_i32 s17, s17, 28672
  s_and_b32 s16, s16, 1
  s_lshl_b32 s16, s16, 8
  s_add_u32 s16, s16, s17
  s_add_u32 s16, s16, s23
  s_add_u32 s20, s16, s40
  buffer_load_dwordx4 a[56:59], v1, s[8:11], s20 offen
  buffer_load_dwordx4 a[60:63], v1, s[8:11], s20 offen offset:2048
  s_add_u32 s20, s16, s41
  buffer_load_dwordx4 a[64:67], v1, s[8:11], s20 offen
  buffer_load_dwordx4 a[68:71], v1, s[8:11], s20 offen offset:2048
  s_add_u32 s20, s16, s42
  buffer_load_dwordx4 a[72:75], v1, s[8:11], s20 offen
  buffer_load_dwordx4 a[76:79], v1, s[8:11], s20 offen offset:2048
  s_add_u32 s20, s16, s43
  buffer_load_dwordx4 a[80:83], v1, s[8:11], s20 offen
  buffer_load_dwordx4 a[84:87], v1, s[8:11], s20 offen offset:2048
  s_add_u32 s20, s16, s44
  buffer_load_dwordx4 a[88:91], v1, s[8:11], s20 offen
  buffer_load_dwordx4 a[92:95], v1, s[8:11], s20 offen offset:2048
  s_add_u32 s20, s16, s45
  buffer_load_dwordx4 a[96:99], v1, s[8:11], s20 offen
  buffer_load_dwordx4 a[100:103], v1, s[8:11], s20 offen offset:2048
  s_add_u32 s20, s16, s46
  buffer_load_dwordx4 a[104:107], v1, s[8:11], s20 offen
  buffer_load_dwordx4 a[108:111], v1, s[8:11], s20 offen offset:2048
  s_add_u32 s16, s22, 2
  s_lshr_b32 s17, s16, 1
  s_mul_i32 s17, s17, 28672
  s_and_b32 s16, s16, 1
  s_lshl_b32 s16, s16, 8
  s_add_u32 s16, s16, s17
  s_add_u32 s16, s16, s23
  s_add_u32 s20, s16, s40
  buffer_load_dwordx4 a[112:115], v1, s[8:11], s20 offen
  buffer_load_dwordx4 a[116:119], v1, s[8:11], s20 offen offset:2048
  s_add_u32 s20, s16, s41
  buffer_load_dwordx4 a[120:123], v1, s[8:11], s20 offen
  buffer_load_dwordx4 a[124:127], v1, s[8:11], s20 offen offset:2048
  s_add_u32 s20, s16, s42
  buffer_load_dwordx4 a[128:131], v1, s[8:11], s20 offen
  buffer_load_dwordx4 a[132:135], v1, s[8:11], s20 offen offset:2048
  s_add_u32 s20, s16, s43
  buffer_load_dwordx4 a[136:139], v1, s[8:11], s20 offen
  buffer_load_dwordx4 a[140:143], v1, s[8:11], s20 offen offset:2048
  s_add_u32 s20, s16, s44
  buffer_load_dwordx4 a[144:147], v1, s[8:11], s20 offen
  buffer_load_dwordx4 a[148:151], v1, s[8:11], s20 offen offset:2048
  s_add_u32 s20, s16, s45
  buffer_load_dwordx4 a[152:155], v1, s[8:11], s20 offen
  buffer_load_dwordx4 a[156:159], v1, s[8:11], s20 offen offset:2048
  s_add_u32 s20, s16, s46
  buffer_load_dwordx4 a[160:163], v1, s[8:11], s20 offen
  buffer_load_dwordx4 a[164:167], v1, s[8:11], s20 offen offset:2048
  s_add_u32 s16, s22, 3
  s_lshr_b32 s17, s16, 1
  s_mul_i32 s17, s17, 28672
  s_and_b32 s16, s16, 1
  s_lshl_b32 s16, s16, 8
  s_add_u32 s16, s16, s17
  s_add_u32 s16, s16, s23
  s_add_u32 s20, s16, s40
  buffer_load_dwordx4 a[168:171], v1, s[8:11], s20 offen
  buffer_load_dwordx4 a[172:175], v1, s[8:11], s20 offen offset:2048
  s_add_u32 s20, s16, s41
  buffer_load_dwordx4 a[176:179], v1, s[8:11], s20 offen
  buffer_load_dwordx4 a[180:183], v1, s[8:11], s20 offen offset:2048
  s_add_u32 s20, s16, s42
  buffer_load_dwordx4 a[184:187], v1, s[8:11], s20 offen
  buffer_load_dwordx4 a[188:191], v1, s[8:11], s20 offen offset:2048
  s_add_u32 s20, s16, s43
  buffer_load_dwordx4 a[192:195], v1, s[8:11], s20 offen
  buffer_load_dwordx4 a[196:199], v1, s[8:11], s20 offen offset:2048
  s_add_u32 s20, s16, s44
  buffer_load_dwordx4 a[200:203], v1, s[8:11], s20 offen
  buffer_load_dwordx4 a[204:207], v1, s[8:11], s20 offen offset:2048
  s_add_u32 s20, s16, s45
  buffer_load_dwordx4 a[208:211], v1, s[8:11], s20 offen
  buffer_load_dwordx4 a[212:215], v1, s[8:11], s20 offen offset:2048
  s_add_u32 s20, s16, s46
  buffer_load_dwordx4 a[216:219], v1, s[8:11], s20 offen
  buffer_load_dwordx4 a[220:223], v1, s[8:11], s20 offen offset:2048
  s_waitcnt vmcnt(42)
  s_add_u32 s16, s22, 4
  s_lshr_b32 s17, s16, 1
  s_mul_i32 s17, s17, 28672
  s_and_b32 s16, s16, 1
  s_lshl_b32 s16, s16, 8
  s_add_u32 s16, s16, s17
  s_add_u32 s16, s16, s23
  s_add_u32 s20, s16, s40
  buffer_load_dwordx4 a[224:227], v1, s[8:11], s20 offen
  buffer_load_dwordx4 a[228:231], v1, s[8:11], s20 offen offset:2048
  s_add_u32 s20, s16, s41
  buffer_load_dwordx4 a[232:235], v1, s[8:11], s20 offen
  buffer_load_dwordx4 a[236:239], v1, s[8:11], s20 offen offset:2048
  s_add_u32 s20, s16, s42
  buffer_load_dwordx4 a[240:243], v1, s[8:11], s20 offen
  buffer_load_dwordx4 a[244:247], v1, s[8:11], s20 offen offset:2048
  s_add_u32 s20, s16, s43
  buffer_load_dwordx4 a[248:251], v1, s[8:11], s20 offen
  buffer_load_dwordx4 a[252:255], v1, s[8:11], s20 offen offset:2048
  s_add_u32 s20, s16, s44
  buffer_load_dwordx4 v[120:123], v1, s[8:11], s20 offen
  buffer_load_dwordx4 v[124:127], v1, s[8:11], s20 offen offset:2048
  s_add_u32 s20, s16, s45
  buffer_load_dwordx4 v[128:131], v1, s[8:11], s20 offen
  buffer_load_dwordx4 v[132:135], v1, s[8:11], s20 offen offset:2048
  s_add_u32 s20, s16, s46
  buffer_load_dwordx4 v[136:139], v1, s[8:11], s20 offen
  buffer_load_dwordx4 v[140:143], v1, s[8:11], s20 offen offset:2048
  s_waitcnt vmcnt(42)
  s_add_u32 s16, s22, 5
  s_lshr_b32 s17, s16, 1
  s_mul_i32 s17, s17, 28672
  s_and_b32 s16, s16, 1
  s_lshl_b32 s16, s16, 8
  s_add_u32 s16, s16, s17
  s_add_u32 s16, s16, s23
  s_add_u32 s20, s16, s40
  buffer_load_dwordx4 v[144:147], v1, s[8:11], s20 offen
  buffer_load_dwordx4 v[148:151], v1, s[8:11], s20 offen offset:2048
  s_add_u32 s20, s16, s41
  buffer_load_dwordx4 v[152:155], v1, s[8:11], s20 offen
  buffer_load_dwordx4 v[156:159], v1, s[8:11], s20 offen offset:2048
  s_add_u32 s20, s16, s42
  buffer_load_dwordx4 v[160:163], v1, s[8:11], s20 offen
  buffer_load_dwordx4 v[164:167], v1, s[8:11], s20 offen offset:2048
  s_add_u32 s20, s16, s43
  buffer_load_dwordx4 v[168:171], v1, s[8:11], s20 offen
  buffer_load_dwordx4 v[172:175], v1, s[8:11], s20 offen offset:2048
  s_add_u32 s20, s16, s44
  buffer_load_dwordx4 v[176:179], v1, s[8:11], s20 offen
  buffer_load_dwordx4 v[180:183], v1, s[8:11], s20 offen offset:2048
  s_add_u32 s20, s16, s45
  buffer_load_dwordx4 v[184:187], v1, s[8:11], s20 offen
  buffer_load_dwordx4 v[188:191], v1, s[8:11], s20 offen offset:2048
  s_add_u32 s20, s16, s46
  buffer_load_dwordx4 v[192:195], v1, s[8:11], s20 offen
  buffer_load_dwordx4 v[196:199], v1, s[8:11], s20 offen offset:2048
  s_waitcnt vmcnt(42)
  s_add_u32 s16, s22, 6
  s_lshr_b32 s17, s16, 1
  s_mul_i32 s17, s17, 28672
  s_and_b32 s16, s16, 1
  s_lshl_b32 s16, s16, 8
  s_add_u32 s16, s16, s17
  s_add_u32 s16, s16, s23
  s_add_u32 s20, s16, s40
  buffer_load_dwordx4 v[200:203], v1, s[8:11], s20 offen
  buffer_load_dwordx4 v[204:207], v1, s[8:11], s20 offen offset:2048
  s_add_u32 s20, s16, s41
  buffer_load_dwordx4 v[208:211], v1, s[8:11], s20 offen
  buffer_load_dwordx4 v[212:215], v1, s[8:11], s20 offen offset:2048
  s_add_u32 s20, s16, s42
  buffer_load_dwordx4 v[216:219], v1, s[8:11], s20 offen
  buffer_load_dwordx4 v[220:223], v1, s[8:11], s20 offen offset:2048
  s_add_u32 s20, s16, s43
  buffer_load_dwordx4 v[224:227], v1, s[8:11], s20 offen
  buffer_load_dwordx4 v[228:231], v1, s[8:11], s20 offen offset:2048
  s_add_u32 s20, s16, s44
  buffer_load_dwordx4 v[232:235], v1, s[8:11], s20 offen
  buffer_load_dwordx4 v[236:239], v1, s[8:11], s20 offen offset:2048
  s_add_u32 s20, s16, s45
  buffer_load_dwordx4 v[240:243], v1, s[8:11], s20 offen
  buffer_load_dwordx4 v[244:247], v1, s[8:11], s20 offen offset:2048
  s_add_u32 s20, s16, s46
  buffer_load_dwordx4 v[248:251], v1, s[8:11], s20 offen
  buffer_load_dwordx4 v[252:255], v1, s[8:11], s20 offen offset:2048
  s_waitcnt vmcnt(42)
  v_bfe_u32 v6, v0, 3, 1
  v_mov_b32 v102, 0x44444444
  v_mov_b32 v7, 0xeeeeeeee
  v_cmp_eq_u32 vcc, 1, v6
  s_nop 1
  v_cndmask_b32 v102, v102, v7, vcc
  v_bfe_u32 v6, v2, 2, 1
  v_cmp_eq_u32 vcc, v6, v5
  v_and_b32 v7, 1, v2
  v_lshlrev_b32 v7, 4, v7
  v_mov_b32 v8, 0x3f80
  v_lshlrev_b32 v7, v7, v8
  v_cndmask_b32 v7, 0, v7, vcc
  v_lshrrev_b32 v8, 3, v2
  v_lshlrev_b32 v8, 1, v8
  v_bfe_u32 v9, v2, 1, 1
  v_add_u32 v8, v8, v9
  v_cmp_eq_u32 vcc, 0, v8
  s_nop 1
  v_cndmask_b32 v98, 0, v7, vcc
  v_cmp_eq_u32 vcc, 1, v8
  s_nop 1
  v_cndmask_b32 v99, 0, v7, vcc
  v_cmp_eq_u32 vcc, 2, v8
  s_nop 1
  v_cndmask_b32 v100, 0, v7, vcc
  v_cmp_eq_u32 vcc, 3, v8
  s_nop 1
  v_cndmask_b32 v101, 0, v7, vcc
  v_lshlrev_b32 v105, 4, v0
  s_lshr_b32 s16, s40, 2
  v_add_u32 v103, s16, v105
  s_lshr_b32 s16, s41, 2
  v_add_u32 v104, s16, v105
  s_lshl_b32 s16, s13, 11
  v_add_u32 v111, s16, v105
  s_mul_i32 s16, s13, 1792
  v_and_b32 v6, 7, v2
  v_lshlrev_b32 v6, 4, v6
  v_lshl_add_u32 v7, v3, 7, v6
  v_add_u32 v106, s16, v7
  v_lshrrev_b32 v7, 1, v3
  v_lshl_add_u32 v7, v7, 7, v6
  v_and_b32 v8, 1, v3
  v_lshl_add_u32 v7, v8, 3, v7
  v_add_u32 v7, 1536, v7
  v_add_u32 v107, s16, v7
  s_mul_i32 s16, s13, 1536
  s_add_u32 s16, s16, 16384
  v_mul_u32_u24 v6, 768, v5
  v_lshl_add_u32 v6, v2, 2, v6
  v_add_u32 v6, s16, v6
  v_lshl_add_u32 v108, v4, 6, v6
  v_mul_u32_u24 v7, 192, v4
  v_add_u32 v7, 128, v7
  v_add_u32 v109, v6, v7
  v_and_b32 v6, 31, v0
  s_lshl_b32 s16, s13, 1
  v_add_u32 v7, s16, v4
  v_lshlrev_b32 v8, 1, v6
  v_add_u32 v9, 8, v8
  v_cmp_gt_u32 vcc, 4, v6
  s_nop 1
  v_cndmask_b32 v8, v9, v8, vcc
  v_mul_u32_u24 v9, 192, v7
  v_lshl_add_u32 v9, v8, 2, v9
  v_add_u32 v9, 16384, v9
  v_mov_b32 v10, 22528
  v_cmp_gt_u32 vcc, 20, v6
  s_nop 1
  v_cndmask_b32 v110, v10, v9, vcc
  v_mov_b32 v8, 0xff800000
  v_mov_b32 v9, 0xff800000
  ds_write_b64 v10, v[8:9]
  v_mov_b32 v8, 0
  v_mov_b32 v9, 0
  ds_write_b64 v10, v[8:9] offset:1536
  ds_write_b64 v10, v[8:9] offset:3072
  ds_write_b64 v10, v[8:9] offset:4608
  s_lshr_b32 s16, s14, 2
  s_mul_i32 s16, s16, 2560
  s_and_b32 s17, s14, 3
  v_and_b32 v8, 1, v6
  v_lshl_add_u32 v8, v8, 3, v7
  s_lshl_b32 s20, s17, 4
  v_add_u32 v8, s20, v8
  v_lshlrev_b32 v8, 3, v8
  v_lshrrev_b32 v9, 1, v6
  v_lshl_add_u32 v8, v9, 2, v8
  v_add_u32 v8, 2048, v8
  v_subrev_u32 v9, 4, v6
  v_and_b32 v9, 15, v9
  v_lshrrev_b32 v10, 3, v9
  s_and_b32 s20, s14, 1
  s_lshl_b32 s20, s20, 1
  v_add_u32 v10, s20, v10
  v_lshlrev_b32 v10, 4, v10
  v_and_b32 v11, 1, v9
  v_lshl_add_u32 v10, v11, 3, v10
  v_add_u32 v10, v10, v7
  v_lshlrev_b32 v10, 4, v10
  v_bfe_u32 v11, v9, 1, 2
  v_lshl_add_u32 v10, v11, 2, v10
  s_lshr_b32 s20, s17, 1
  s_lshl_b32 s20, s20, 10
  v_add_u32 v10, s20, v10
  v_cmp_gt_u32 vcc, 4, v6
  s_nop 1
  v_cndmask_b32 v8, v10, v8, vcc
  v_add_u32 v112, s16, v8
  v_lshlrev_b32 v114, 3, v0
  s_mul_i32 s17, s13, 6
  v_add_u32 v9, s17, v0
  s_mul_i32 s16, s14, 14
  v_add_u32 v6, s16, v9
  v_lshlrev_b32 v6, 7, v6
  v_add_u32 v6, 1863680, v6
  v_mov_b32 v116, 28672
  s_mul_i32 s16, s14, 5
  s_sub_u32 s16, s16, 14
  v_add_u32 v7, s16, v9
  v_lshlrev_b32 v7, 7, v7
  v_add_u32 v7, 49231872, v7
  v_mov_b32 v8, 10240
  v_cmp_lt_u32 vcc, 13, v9
  s_nop 1
  v_cndmask_b32 v6, v6, v7, vcc
  v_cndmask_b32 v116, v116, v8, vcc
  s_lshl_b32 s16, s14, 2
  s_sub_u32 s16, s16, 19
  v_add_u32 v7, s16, v9
  v_min_u32 v7, 55, v7
  v_lshlrev_b32 v7, 7, v7
  v_add_u32 v7, 48777216, v7
  v_mov_b32 v8, 7168
  v_cmp_lt_u32 vcc, 18, v9
  s_nop 1
  v_cndmask_b32 v6, v6, v7, vcc
  v_cndmask_b32 v116, v116, v8, vcc
  v_mov_b32 v113, v6
  s_mov_b32 s24, 48762880
  s_mov_b32 s25, 49221632
  s_mul_i32 s16, s13, 7168
  s_add_u32 s26, s16, 1835008
  s_mov_b32 s15, 0
  s_mov_b32 s39, 49876992
  v_lshlrev_b32 v119, 2, v2
  v_lshlrev_b32 v118, 5, v119
  s_lshl_b32 s16, s14, 2
  s_add_u32 s53, s16, 49877056
  s_mov_b32 s56, s4
  s_or_b32 s57, s5, 0x00080000
  s_mov_b32 s58, 0x02000000
  s_mov_b32 s59, 0x00020000
  s_mul_i32 s16, s14, 224
  s_mul_i32 s17, s13, 56
  s_add_u32 s16, s16, s17
  s_lshl_b32 s16, s16, 7
  s_add_u32 s55, s16, 19857408
  s_xor_b32 s19, s14, 1
  s_xor_b32 s18, s13, 2
  s_or_b32 s19, s19, s18
  s_mov_b32 s33, 128
  s_mov_b32 s30, 0x000fffff
  s_mov_b32 s31, 0x000fffff
  s_waitcnt vmcnt(0)
  v_sub_u32 v6, v113, v116
  s_mov_b64 exec, 0x3f
  buffer_load_dword v115, v6, s[8:11], 0 offen
  s_mov_b64 exec, -1
  s_add_u32 s20, s26, 0
  buffer_load_dwordx4 v[56:59], v105, s[8:11], s20 offen
  buffer_load_dwordx4 v[60:63], v105, s[8:11], s20 offen offset:1024
  buffer_load_dwordx4 v[64:67], v105, s[8:11], s20 offen offset:2048
  buffer_load_dwordx2 v[68:69], v114, s[8:11], s20 offen offset:3072
  s_add_u32 s20, s26, 3584
  buffer_load_dwordx4 v[70:73], v105, s[8:11], s20 offen
  buffer_load_dwordx4 v[74:77], v105, s[8:11], s20 offen offset:1024
  buffer_load_dwordx4 v[78:81], v105, s[8:11], s20 offen offset:2048
  buffer_load_dwordx2 v[82:83], v114, s[8:11], s20 offen offset:3072
L_sc_loop:
  v_mov_b32 v0, 0
  v_mov_b32 v1, 0
  v_mov_b32 v2, 0
  v_mov_b32 v3, 0
  v_mov_b32 v4, 0
  v_mov_b32 v5, 0
  v_mov_b32 v6, 0
  v_mov_b32 v7, 0
  v_mov_b32 v8, 0
  v_mov_b32 v9, 0
  v_mov_b32 v10, 0
  v_mov_b32 v11, 0
  v_mov_b32 v12, 0
  v_mov_b32 v13, 0
  v_mov_b32 v14, 0
  v_mov_b32 v15, 0
  v_mov_b32 v16, 0
  v_mov_b32 v17, 0
  v_mov_b32 v18, 0
  v_mov_b32 v19, 0
  v_mov_b32 v20, 0
  v_mov_b32 v21, 0
  v_mov_b32 v22, 0
  v_mov_b32 v23, 0
  v_mov_b32 v24, 0
  v_mov_b32 v25, 0
  v_mov_b32 v26, 0
  v_mov_b32 v27, 0
  s_add_u32 s16, s15, 1
  s_and_b32 s17, s16, 3
  s_or_b32 s17, s17, s14
  s_or_b32 s17, s17, s13
  s_lshr_b32 s18, s16, 6
  s_or_b32 s17, s17, s18
  s_lshr_b32 s16, s16, 2
  s_lshl_b32 s16, s16, 11
  s_add_u32 s60, s16, 49913856
  s_sleep 6
  s_mov_b32 s21, 0
L_pm_sc:
  buffer_load_dwordx4 v[28:31], v103, s[8:11], s24 offen sc1
  buffer_load_dwordx4 v[32:35], v104, s[8:11], s24 offen sc1
  s_add_u32 s21, s21, 1
  s_cmp_gt_u32 s21, 50000
  s_cbranch_scc1 L_ch_fail
  s_waitcnt vmcnt(0)
  ds_write_b128 v103, v[28:31]
  ds_write_b128 v104, v[32:35]
  v_max3_u32 v36, v28, v29, v30
  v_max3_u32 v37, v31, v32, v33
  v_max_u32 v38, v34, v35
  v_max3_u32 v36, v36, v37, v38
  v_cmp_eq_u32 vcc, -1, v36
  s_cbranch_vccnz L_pm_sc
  v_smfmac_f32_16x16x64_bf16 v[0:3], v[28:31], a[0:7], v102
  ds_write_b128 v103, v[28:31] offset:7168
  v_smfmac_f32_16x16x64_bf16 v[4:7], v[28:31], a[56:63], v102
  ds_write_b128 v104, v[32:35] offset:7168
  v_smfmac_f32_16x16x64_bf16 v[8:11], v[28:31], a[112:119], v102
  v_smfmac_f32_16x16x64_bf16 v[12:15], v[28:31], a[168:175], v102
  v_smfmac_f32_16x16x64_bf16 v[16:19], v[28:31], a[224:231], v102
  v_smfmac_f32_16x16x64_bf16 v[20:23], v[28:31], v[144:151], v102
  v_smfmac_f32_16x16x64_bf16 v[24:27], v[28:31], v[200:207], v102
  s_waitcnt lgkmcnt(0)
  s_barrier
  ds_read_b128 v[36:39], v111 offset:2048
  ds_read_b128 v[40:43], v111 offset:3072
  v_smfmac_f32_16x16x64_bf16 v[0:3], v[32:35], a[8:15], v102
  ds_read_b128 v[44:47], v111 offset:4096
  v_smfmac_f32_16x16x64_bf16 v[4:7], v[32:35], a[64:71], v102
  ds_read_b128 v[48:51], v111 offset:5120
  v_smfmac_f32_16x16x64_bf16 v[8:11], v[32:35], a[120:127], v102
  ds_read_b128 v[52:55], v111 offset:6144
  v_smfmac_f32_16x16x64_bf16 v[12:15], v[32:35], a[176:183], v102
  ds_read_b128 v[84:87], v106
  v_smfmac_f32_16x16x64_bf16 v[16:19], v[32:35], a[232:239], v102
  ds_read_b128 v[88:91], v106 offset:512
  v_smfmac_f32_16x16x64_bf16 v[20:23], v[32:35], v[152:159], v102
  ds_read_b128 v[92:95], v106 offset:1024
  v_smfmac_f32_16x16x64_bf16 v[24:27], v[32:35], v[208:215], v102
  ds_read_b64 v[96:97], v107
  s_cmp_eq_u32 s19, 0
  s_cbranch_scc1 L_sc_fc
L_sc_fcb:
  s_waitcnt lgkmcnt(8)
  v_smfmac_f32_16x16x64_bf16 v[0:3], v[36:39], a[16:23], v102
  s_mov_b64 exec, 0x3f
  buffer_load_dword v115, v113, s[8:11], 0 offen
  s_mov_b64 exec, -1
  v_smfmac_f32_16x16x64_bf16 v[4:7], v[36:39], a[72:79], v102
  v_add_u32 v113, v113, v116
  v_smfmac_f32_16x16x64_bf16 v[8:11], v[36:39], a[128:135], v102
  s_cmp_eq_u32 s17, 0
  s_cbranch_scc1 L_sc_fu
L_sc_fub:
  v_smfmac_f32_16x16x64_bf16 v[12:15], v[36:39], a[184:191], v102
  v_smfmac_f32_16x16x64_bf16 v[16:19], v[36:39], a[240:247], v102
  v_smfmac_f32_16x16x64_bf16 v[20:23], v[36:39], v[160:167], v102
  v_smfmac_f32_16x16x64_bf16 v[24:27], v[36:39], v[216:223], v102
  s_waitcnt lgkmcnt(4)
  v_smfmac_f32_16x16x64_bf16 v[24:27], v[40:43], v[224:231], v102
  v_smfmac_f32_16x16x64_bf16 v[24:27], v[44:47], v[232:239], v102
  v_smfmac_f32_16x16x64_bf16 v[24:27], v[48:51], v[240:247], v102
  v_smfmac_f32_16x16x64_bf16 v[24:27], v[52:55], v[248:255], v102
  v_smfmac_f32_16x16x64_bf16 v[16:19], v[40:43], a[248:255], v102
  v_smfmac_f32_16x16x64_bf16 v[20:23], v[40:43], v[168:175], v102
  v_smfmac_f32_16x16x64_bf16 v[16:19], v[44:47], v[120:127], v102
  v_smfmac_f32_16x16x64_bf16 v[20:23], v[44:47], v[176:183], v102
  v_smfmac_f32_16x16x64_bf16 v[16:19], v[48:51], v[128:135], v102
  v_smfmac_f32_16x16x64_bf16 v[20:23], v[48:51], v[184:191], v102
  v_smfmac_f32_16x16x64_bf16 v[16:19], v[52:55], v[136:143], v102
  s_nop 0
  v_cvt_pk_bf16_f32 v28, v24, v25
  v_smfmac_f32_16x16x64_bf16 v[20:23], v[52:55], v[192:199], v102
  v_cvt_pk_bf16_f32 v29, v26, v27
  v_smfmac_f32_16x16x64_bf16 v[0:3], v[40:43], a[24:31], v102
  v_smfmac_f32_16x16x64_bf16 v[4:7], v[40:43], a[80:87], v102
  v_mfma_f32_16x16x16_bf16 v[24:27], v[28:29], v[98:99], 0
  v_smfmac_f32_16x16x64_bf16 v[0:3], v[44:47], a[32:39], v102
  v_smfmac_f32_16x16x64_bf16 v[4:7], v[44:47], a[88:95], v102
  v_smfmac_f32_16x16x64_bf16 v[0:3], v[48:51], a[40:47], v102
  v_cvt_pk_bf16_f32 v32, v16, v17
  v_smfmac_f32_16x16x64_bf16 v[4:7], v[48:51], a[96:103], v102
  v_cvt_pk_bf16_f32 v33, v18, v19
  v_smfmac_f32_16x16x64_bf16 v[0:3], v[52:55], a[48:55], v102
  v_cvt_pk_bf16_f32 v34, v20, v21
  v_smfmac_f32_16x16x64_bf16 v[4:7], v[52:55], a[104:111], v102
  v_cvt_pk_bf16_f32 v35, v22, v23
  v_smfmac_f32_16x16x64_bf16 v[8:11], v[40:43], a[136:143], v102
  v_smfmac_f32_16x16x64_bf16 v[12:15], v[40:43], a[192:199], v102
  v_mfma_f32_16x16x32_bf16 v[16:19], v[32:35], v[98:101], 0
  v_smfmac_f32_16x16x64_bf16 v[8:11], v[44:47], a[144:151], v102
  v_cvt_pk_bf16_f32 v20, v24, v25
  v_smfmac_f32_16x16x64_bf16 v[12:15], v[44:47], a[200:207], v102
  v_cvt_pk_bf16_f32 v21, v26, v27
  v_smfmac_f32_16x16x64_bf16 v[8:11], v[48:51], a[152:159], v102
  v_cvt_pk_bf16_f32 v28, v0, v1
  v_smfmac_f32_16x16x64_bf16 v[12:15], v[48:51], a[208:215], v102
  v_cvt_pk_bf16_f32 v29, v2, v3
  v_smfmac_f32_16x16x64_bf16 v[8:11], v[52:55], a[160:167], v102
  v_cvt_pk_bf16_f32 v30, v4, v5
  v_smfmac_f32_16x16x64_bf16 v[12:15], v[52:55], a[216:223], v102
  v_cvt_pk_bf16_f32 v31, v6, v7
  s_waitcnt lgkmcnt(0)
  s_nop 0
  v_mfma_f32_16x16x32_bf16 v[0:3], v[28:31], v[98:101], 0
  v_mfma_f32_16x16x16_bf16 v[36:39], v[20:21], v[96:97], 0
  v_cvt_pk_bf16_f32 v22, v16, v17
  v_cvt_pk_bf16_f32 v23, v18, v19
  v_mfma_f32_16x16x16_bf16 v[40:43], v[20:21], v[68:69], 0
  v_cvt_pk_bf16_f32 v32, v8, v9
  v_cvt_pk_bf16_f32 v33, v10, v11
  v_mfma_f32_16x16x16_bf16 v[44:47], v[20:21], v[82:83], 0
  v_cvt_pk_bf16_f32 v34, v12, v13
  v_cvt_pk_bf16_f32 v35, v14, v15
  s_nop 1
  v_mfma_f32_16x16x32_bf16 v[8:11], v[32:35], v[98:101], 0
  v_smfmac_f32_16x16x32_bf16 v[36:39], v[22:23], v[92:95], v102
  v_smfmac_f32_16x16x32_bf16 v[40:43], v[22:23], v[64:67], v102
  v_cvt_pk_bf16_f32 v4, v0, v1
  v_cvt_pk_bf16_f32 v5, v2, v3
  v_smfmac_f32_16x16x32_bf16 v[44:47], v[22:23], v[78:81], v102
  s_nop 2
  v_cvt_pk_bf16_f32 v6, v8, v9
  v_cvt_pk_bf16_f32 v7, v10, v11
  s_nop 1
  v_smfmac_f32_16x16x64_bf16 v[36:39], v[4:7], v[84:91], v102
  v_smfmac_f32_16x16x64_bf16 v[40:43], v[4:7], v[56:63], v102
  v_smfmac_f32_16x16x64_bf16 v[44:47], v[4:7], v[70:77], v102
  s_nop 6
  v_permlane32_swap_b32 v36, v40
  v_permlane32_swap_b32 v37, v41
  v_permlane32_swap_b32 v38, v42
  v_permlane32_swap_b32 v39, v43
  v_permlane32_swap_b32 v44, v45
  v_permlane32_swap_b32 v46, v47
  v_add_f32 v0, v36, v40
  v_add_f32 v1, v37, v41
  v_add_f32 v2, v38, v42
  v_add_f32 v3, v39, v43
  v_add_f32 v4, v44, v45
  v_add_f32 v5, v46, v47
  ds_write_b32 v108, v0 offset:0
  ds_write_b32 v108, v1 offset:192
  ds_write_b32 v108, v2 offset:384
  ds_write_b32 v108, v3 offset:576
  ds_write_b32 v109, v4 offset:0
  ds_write_b32 v109, v5 offset:384
  s_waitcnt lgkmcnt(0)
  s_barrier
  ds_read_b64 v[28:29], v110 offset:0
  ds_read_b64 v[30:31], v110 offset:1536
  ds_read_b64 v[32:33], v110 offset:3072
  ds_read_b64 v[34:35], v110 offset:4608
  s_waitcnt lgkmcnt(2)
  v_pk_add_f32 v[28:29], v[28:29], v[30:31]
  s_waitcnt lgkmcnt(0)
  v_pk_add_f32 v[32:33], v[32:33], v[34:35]
  v_pk_add_f32 v[28:29], v[28:29], v[32:33]
  v_max_f32 v36, v28, v29
  s_nop 1
  v_max_f32_dpp v36, v36, v36 row_ror:8 row_mask:0xf bank_mask:0xf
  s_nop 1
  v_max_f32_dpp v36, v36, v36 row_ror:4 row_mask:0xf bank_mask:0xf
  s_nop 1
  v_max_f32_dpp v36, v36, v36 row_ror:2 row_mask:0xf bank_mask:0xf
  s_nop 1
  v_max_f32_dpp v36, v36, v36 row_ror:1 row_mask:0xf bank_mask:0xf
  v_mov_b32 v37, v36
  s_nop 1
  v_permlane16_swap_b32 v36, v37
  v_max_f32 v36, v36, v37
  v_sub_f32 v38, v28, v36
  v_sub_f32 v39, v29, v36
  v_exp_f32 v38, v38
  v_exp_f32 v39, v39
  s_nop 0
  v_add_f32 v36, v38, v39
  s_nop 1
  v_add_f32_dpp v36, v36, v36 row_ror:8 row_mask:0xf bank_mask:0xf
  s_nop 1
  v_add_f32_dpp v36, v36, v36 row_ror:4 row_mask:0xf bank_mask:0xf
  s_nop 1
  v_add_f32_dpp v36, v36, v36 row_ror:2 row_mask:0xf bank_mask:0xf
  s_nop 1
  v_add_f32_dpp v36, v36, v36 row_ror:1 row_mask:0xf bank_mask:0xf
  v_mov_b32 v37, v36
  s_nop 1
  v_permlane16_swap_b32 v36, v37
  v_add_f32 v36, v36, v37
  v_rcp_f32 v36, v36
  s_nop 0
  v_mul_f32 v38, v38, v36
  v_mul_f32 v39, v39, v36
  v_cvt_pk_bf16_f32 v38, v38, v39
  s_cmp_eq_u32 s17, 0
  s_cbranch_scc1 L_sc_fuchk
L_sc_fuok:
  s_mov_b64 exec, s[30:31]
  buffer_store_dword v38, v112, s[8:11], s25 offen
  s_mov_b64 exec, -1
  s_add_u32 s24, s24, 7168
  s_add_u32 s25, s25, 10240
  s_add_u32 s26, s26, 28672
  s_add_u32 s15, s15, 1
  s_cmp_ge_u32 s15, 63
  s_cbranch_scc1 L_ch_done
  s_add_u32 s20, s26, 0
  buffer_load_dwordx4 v[56:59], v105, s[8:11], s20 offen
  buffer_load_dwordx4 v[60:63], v105, s[8:11], s20 offen offset:1024
  buffer_load_dwordx4 v[64:67], v105, s[8:11], s20 offen offset:2048
  buffer_load_dwordx2 v[68:69], v114, s[8:11], s20 offen offset:3072
  s_add_u32 s20, s26, 3584
  buffer_load_dwordx4 v[70:73], v105, s[8:11], s20 offen
  buffer_load_dwordx4 v[74:77], v105, s[8:11], s20 offen offset:1024
  buffer_load_dwordx4 v[78:81], v105, s[8:11], s20 offen offset:2048
  buffer_load_dwordx2 v[82:83], v114, s[8:11], s20 offen offset:3072
  s_branch L_sc_loop
L_sc_fc:
  s_lshl_b32 s16, s15, 4
  v_mov_b32 v117, s16
  s_mov_b32 s16, 49883136
  s_mov_b64 exec, 1
  buffer_store_dword v117, off, s[8:11], s16 sc1
  s_mov_b64 exec, -1
  s_branch L_sc_fcb
L_sc_fu:
  buffer_load_dword v117, v118, s[8:11], s60 offen sc1
  s_branch L_sc_fub
L_sc_fuchk:
  s_mov_b32 s21, 0
L_sc_fuw:
  s_waitcnt vmcnt(0)
  v_cmp_gt_u32 vcc, 7, v117
  s_cbranch_vccz L_sc_fuok
  s_add_u32 s21, s21, 1
  s_cmp_gt_u32 s21, 50000
  s_cbranch_scc1 L_ch_fail
  s_sleep 4
  buffer_load_dword v117, v118, s[8:11], s60 offen sc1
  s_branch L_sc_fuw
L_ch_value:
  s_sub_u32 s14, s14, 16
  s_mul_i32 s23, s14, 28
  s_add_u32 s27, s23, s22
  s_mov_b32 s28, 12976128
  s_add_u32 s16, s27, 0
  s_lshr_b32 s17, s16, 1
  s_mul_i32 s17, s17, 28672
  s_and_b32 s16, s16, 1
  s_lshl_b32 s16, s16, 8
  s_add_u32 s16, s16, s17
  s_add_u32 s16, s16, s28
  s_add_u32 s20, s16, 0
  buffer_load_dwordx4 a[0:3], v1, s[8:11], s20 offen
  buffer_load_dwordx4 a[4:7], v1, s[8:11], s20 offen offset:2048
  s_add_u32 s20, s16, 4096
  buffer_load_dwordx4 a[8:11], v1, s[8:11], s20 offen
  buffer_load_dwordx4 a[12:15], v1, s[8:11], s20 offen offset:2048
  s_add_u32 s20, s16, 8192
  buffer_load_dwordx4 a[16:19], v1, s[8:11], s20 offen
  buffer_load_dwordx4 a[20:23], v1, s[8:11], s20 offen offset:2048
  s_add_u32 s20, s16, 12288
  buffer_load_dwordx4 a[24:27], v1, s[8:11], s20 offen
  buffer_load_dwordx4 a[28:31], v1, s[8:11], s20 offen offset:2048
  s_add_u32 s20, s16, 16384
  buffer_load_dwordx4 a[32:35], v1, s[8:11], s20 offen
  buffer_load_dwordx4 a[36:39], v1, s[8:11], s20 offen offset:2048
  s_add_u32 s20, s16, 20480
  buffer_load_dwordx4 a[40:43], v1, s[8:11], s20 offen
  buffer_load_dwordx4 a[44:47], v1, s[8:11], s20 offen offset:2048
  s_add_u32 s20, s16, 24576
  buffer_load_dwordx4 a[48:51], v1, s[8:11], s20 offen
  buffer_load_dwordx4 a[52:55], v1, s[8:11], s20 offen offset:2048
  s_add_u32 s16, s27, 1
  s_lshr_b32 s17, s16, 1
  s_mul_i32 s17, s17, 28672
  s_and_b32 s16, s16, 1
  s_lshl_b32 s16, s16, 8
  s_add_u32 s16, s16, s17
  s_add_u32 s16, s16, s28
  s_add_u32 s20, s16, 0
  buffer_load_dwordx4 a[56:59], v1, s[8:11], s20 offen
  buffer_load_dwordx4 a[60:63], v1, s[8:11], s20 offen offset:2048
  s_add_u32 s20, s16, 4096
  buffer_load_dwordx4 a[64:67], v1, s[8:11], s20 offen
  buffer_load_dwordx4 a[68:71], v1, s[8:11], s20 offen offset:2048
  s_add_u32 s20, s16, 8192
  buffer_load_dwordx4 a[72:75], v1, s[8:11], s20 offen
  buffer_load_dwordx4 a[76:79], v1, s[8:11], s20 offen offset:2048
  s_add_u32 s20, s16, 12288
  buffer_load_dwordx4 a[80:83], v1, s[8:11], s20 offen
  buffer_load_dwordx4 a[84:87], v1, s[8:11], s20 offen offset:2048
  s_add_u32 s20, s16, 16384
  buffer_load_dwordx4 a[88:91], v1, s[8:11], s20 offen
  buffer_load_dwordx4 a[92:95], v1, s[8:11], s20 offen offset:2048
  s_add_u32 s20, s16, 20480
  buffer_load_dwordx4 a[96:99], v1, s[8:11], s20 offen
  buffer_load_dwordx4 a[100:103], v1, s[8:11], s20 offen offset:2048
  s_add_u32 s20, s16, 24576
  buffer_load_dwordx4 a[104:107], v1, s[8:11], s20 offen
  buffer_load_dwordx4 a[108:111], v1, s[8:11], s20 offen offset:2048
  s_add_u32 s16, s27, 2
  s_lshr_b32 s17, s16, 1
  s_mul_i32 s17, s17, 28672
  s_and_b32 s16, s16, 1
  s_lshl_b32 s16, s16, 8
  s_add_u32 s16, s16, s17
  s_add_u32 s16, s16, s28
  s_add_u32 s20, s16, 0
  buffer_load_dwordx4 a[112:115], v1, s[8:11], s20 offen
  buffer_load_dwordx4 a[116:119], v1, s[8:11], s20 offen offset:2048
  s_add_u32 s20, s16, 4096
  buffer_load_dwordx4 a[120:123], v1, s[8:11], s20 offen
  buffer_load_dwordx4 a[124:127], v1, s[8:11], s20 offen offset:2048
  s_add_u32 s20, s16, 8192
  buffer_load_dwordx4 a[128:131], v1, s[8:11], s20 offen
  buffer_load_dwordx4 a[132:135], v1, s[8:11], s20 offen offset:2048
  s_add_u32 s20, s16, 12288
  buffer_load_dwordx4 a[136:139], v1, s[8:11], s20 offen
  buffer_load_dwordx4 a[140:143], v1, s[8:11], s20 offen offset:2048
  s_add_u32 s20, s16, 16384
  buffer_load_dwordx4 a[144:147], v1, s[8:11], s20 offen
  buffer_load_dwordx4 a[148:151], v1, s[8:11], s20 offen offset:2048
  s_add_u32 s20, s16, 20480
  buffer_load_dwordx4 a[152:155], v1, s[8:11], s20 offen
  buffer_load_dwordx4 a[156:159], v1, s[8:11], s20 offen offset:2048
  s_add_u32 s20, s16, 24576
  buffer_load_dwordx4 a[160:163], v1, s[8:11], s20 offen
  buffer_load_dwordx4 a[164:167], v1, s[8:11], s20 offen offset:2048
  s_add_u32 s16, s27, 3
  s_lshr_b32 s17, s16, 1
  s_mul_i32 s17, s17, 28672
  s_and_b32 s16, s16, 1
  s_lshl_b32 s16, s16, 8
  s_add_u32 s16, s16, s17
  s_add_u32 s16, s16, s28
  s_add_u32 s20, s16, 0
  buffer_load_dwordx4 a[168:171], v1, s[8:11], s20 offen
  buffer_load_dwordx4 a[172:175], v1, s[8:11], s20 offen offset:2048
  s_add_u32 s20, s16, 4096
  buffer_load_dwordx4 a[176:179], v1, s[8:11], s20 offen
  buffer_load_dwordx4 a[180:183], v1, s[8:11], s20 offen offset:2048
  s_add_u32 s20, s16, 8192
  buffer_load_dwordx4 a[184:187], v1, s[8:11], s20 offen
  buffer_load_dwordx4 a[188:191], v1, s[8:11], s20 offen offset:2048
  s_add_u32 s20, s16, 12288
  buffer_load_dwordx4 a[192:195], v1, s[8:11], s20 offen
  buffer_load_dwordx4 a[196:199], v1, s[8:11], s20 offen offset:2048
  s_add_u32 s20, s16, 16384
  buffer_load_dwordx4 a[200:203], v1, s[8:11], s20 offen
  buffer_load_dwordx4 a[204:207], v1, s[8:11], s20 offen offset:2048
  s_add_u32 s20, s16, 20480
  buffer_load_dwordx4 a[208:211], v1, s[8:11], s20 offen
  buffer_load_dwordx4 a[212:215], v1, s[8:11], s20 offen offset:2048
  s_add_u32 s20, s16, 24576
  buffer_load_dwordx4 a[216:219], v1, s[8:11], s20 offen
  buffer_load_dwordx4 a[220:223], v1, s[8:11], s20 offen offset:2048
  s_waitcnt vmcnt(42)
  s_add_u32 s16, s27, 4
  s_lshr_b32 s17, s16, 1
  s_mul_i32 s17, s17, 28672
  s_and_b32 s16, s16, 1
  s_lshl_b32 s16, s16, 8
  s_add_u32 s16, s16, s17
  s_add_u32 s16, s16, s28
  s_add_u32 s20, s16, 0
  buffer_load_dwordx4 a[224:227], v1, s[8:11], s20 offen
  buffer_load_dwordx4 a[228:231], v1, s[8:11], s20 offen offset:2048
  s_add_u32 s20, s16, 4096
  buffer_load_dwordx4 a[232:235], v1, s[8:11], s20 offen
  buffer_load_dwordx4 a[236:239], v1, s[8:11], s20 offen offset:2048
  s_add_u32 s20, s16, 8192
  buffer_load_dwordx4 a[240:243], v1, s[8:11], s20 offen
  buffer_load_dwordx4 a[244:247], v1, s[8:11], s20 offen offset:2048
  s_add_u32 s20, s16, 12288
  buffer_load_dwordx4 a[248:251], v1, s[8:11], s20 offen
  buffer_load_dwordx4 a[252:255], v1, s[8:11], s20 offen offset:2048
  s_add_u32 s20, s16, 16384
  buffer_load_dwordx4 v[120:123], v1, s[8:11], s20 offen
  buffer_load_dwordx4 v[124:127], v1, s[8:11], s20 offen offset:2048
  s_add_u32 s20, s16, 20480
  buffer_load_dwordx4 v[128:131], v1, s[8:11], s20 offen
  buffer_load_dwordx4 v[132:135], v1, s[8:11], s20 offen offset:2048
  s_add_u32 s20, s16, 24576
  buffer_load_dwordx4 v[136:139], v1, s[8:11], s20 offen
  buffer_load_dwordx4 v[140:143], v1, s[8:11], s20 offen offset:2048
  s_waitcnt vmcnt(42)
  s_add_u32 s16, s27, 5
  s_lshr_b32 s17, s16, 1
  s_mul_i32 s17, s17, 28672
  s_and_b32 s16, s16, 1
  s_lshl_b32 s16, s16, 8
  s_add_u32 s16, s16, s17
  s_add_u32 s16, s16, s28
  s_add_u32 s20, s16, 0
  buffer_load_dwordx4 v[144:147], v1, s[8:11], s20 offen
  buffer_load_dwordx4 v[148:151], v1, s[8:11], s20 offen offset:2048
  s_add_u32 s20, s16, 4096
  buffer_load_dwordx4 v[152:155], v1, s[8:11], s20 offen
  buffer_load_dwordx4 v[156:159], v1, s[8:11], s20 offen offset:2048
  s_add_u32 s20, s16, 8192
  buffer_load_dwordx4 v[160:163], v1, s[8:11], s20 offen
  buffer_load_dwordx4 v[164:167], v1, s[8:11], s20 offen offset:2048
  s_add_u32 s20, s16, 12288
  buffer_load_dwordx4 v[168:171], v1, s[8:11], s20 offen
  buffer_load_dwordx4 v[172:175], v1, s[8:11], s20 offen offset:2048
  s_add_u32 s20, s16, 16384
  buffer_load_dwordx4 v[176:179], v1, s[8:11], s20 offen
  buffer_load_dwordx4 v[180:183], v1, s[8:11], s20 offen offset:2048
  s_add_u32 s20, s16, 20480
  buffer_load_dwordx4 v[184:187], v1, s[8:11], s20 offen
  buffer_load_dwordx4 v[188:191], v1, s[8:11], s20 offen offset:2048
  s_add_u32 s20, s16, 24576
  buffer_load_dwordx4 v[192:195], v1, s[8:11], s20 offen
  buffer_load_dwordx4 v[196:199], v1, s[8:11], s20 offen offset:2048
  s_waitcnt vmcnt(42)
  s_add_u32 s16, s27, 6
  s_lshr_b32 s17, s16, 1
  s_mul_i32 s17, s17, 28672
  s_and_b32 s16, s16, 1
  s_lshl_b32 s16, s16, 8
  s_add_u32 s16, s16, s17
  s_add_u32 s16, s16, s28
  s_add_u32 s20, s16, 0
  buffer_load_dwordx4 v[200:203], v1, s[8:11], s20 offen
  buffer_load_dwordx4 v[204:207], v1, s[8:11], s20 offen offset:2048
  s_add_u32 s20, s16, 4096
  buffer_load_dwordx4 v[208:211], v1, s[8:11], s20 offen
  buffer_load_dwordx4 v[212:215], v1, s[8:11], s20 offen offset:2048
  s_add_u32 s20, s16, 8192
  buffer_load_dwordx4 v[216:219], v1, s[8:11], s20 offen
  buffer_load_dwordx4 v[220:223], v1, s[8:11], s20 offen offset:2048
  s_add_u32 s20, s16, 12288
  buffer_load_dwordx4 v[224:227], v1, s[8:11], s20 offen
  buffer_load_dwordx4 v[228:231], v1, s[8:11], s20 offen offset:2048
  s_add_u32 s20, s16, 16384
  buffer_load_dwordx4 v[232:235], v1, s[8:11], s20 offen
  buffer_load_dwordx4 v[236:239], v1, s[8:11], s20 offen offset:2048
  s_add_u32 s20, s16, 20480
  buffer_load_dwordx4 v[240:243], v1, s[8:11], s20 offen
  buffer_load_dwordx4 v[244:247], v1, s[8:11], s20 offen offset:2048
  s_add_u32 s20, s16, 24576
  buffer_load_dwordx4 v[248:251], v1, s[8:11], s20 offen
  buffer_load_dwordx4 v[252:255], v1, s[8:11], s20 offen offset:2048
  s_waitcnt vmcnt(42)
  v_bfe_u32 v6, v0, 3, 1
  v_mov_b32 v104, 0x44444444
  v_mov_b32 v7, 0xeeeeeeee
  v_cmp_eq_u32 vcc, 1, v6
  s_nop 1
  v_cndmask_b32 v104, v104, v7, vcc
  v_lshlrev_b32 v107, 4, v0
  s_cmp_eq_u32 s13, 3
  s_cselect_b32 s16, 4096, 0
  s_cselect_b32 s35, 3584, 0
  s_cselect_b32 s58, 1, 0
  s_cmp_eq_u32 s13, 0
  s_cselect_b32 s58, 1, s58
  s_mov_b32 s36, 0
  s_add_u32 s16, s16, 8192
  v_add_u32 v105, s16, v107
  v_mov_b32 v6, 256
  v_cmp_le_u32 vcc, 48, v0
  s_nop 1
  v_cndmask_b32 v6, 0, v6, vcc
  v_add_u32 v106, v105, v6
  v_lshl_add_u32 v6, v4, 4, v2
  v_lshlrev_b32 v6, 4, v6
  v_lshl_add_u32 v6, v5, 3, v6
  s_lshl_b32 s16, s13, 11
  s_add_u32 s16, s16, 8192
  v_add_u32 v108, s16, v6
  s_mul_i32 s17, s13, 1792
  v_add_u32 v110, s17, v6
  v_mul_u32_u24 v6, 28, v3
  v_add_u32 v6, v6, v2
  v_lshlrev_b32 v6, 4, v6
  v_add_u32 v109, s16, v6
  v_lshlrev_b32 v6, 6, v2
  v_lshl_add_u32 v111, v3, 4, v6
  s_mul_i32 s16, s13, 2560
  v_add_u32 v112, s16, v107
  v_lshlrev_b32 v6, 3, v0
  v_add_u32 v6, 2048, v6
  v_add_u32 v113, s16, v6
  v_lshl_add_u32 v6, v4, 4, v2
  v_lshlrev_b32 v6, 2, v6
  v_lshl_add_u32 v6, v5, 9, v6
  s_lshl_b32 s16, s13, 10
  s_mul_i32 s16, s16, 1
  s_add_u32 s16, s16, 16384
  v_add_u32 v114, s16, v6
  v_mov_b32 v8, 0
  v_mov_b32 v9, 0
  v_lshlrev_b32 v10, 3, v0
  v_add_u32 v10, 16384, v10
  ds_write_b64 v10, v[8:9]
  ds_write_b64 v10, v[8:9] offset:512
  s_cmp_eq_u32 s13, 3
  s_cselect_b32 s16, 4, 0
  v_add_u32 v8, s16, v3
  v_min_u32 v6, 13, v2
  v_lshlrev_b32 v7, 7, v8
  v_lshl_add_u32 v7, v6, 3, v7
  v_add_u32 v115, 16384, v7
  v_lshlrev_b32 v6, 1, v6
  v_add_u32 v6, s23, v6
  v_lshrrev_b32 v7, 3, v6
  v_lshlrev_b32 v7, 7, v7
  v_and_b32 v9, 7, v6
  v_lshl_add_u32 v7, v9, 1, v7
  v_lshl_add_u32 v116, v8, 4, v7
  v_min_u32 v6, 27, v0
  v_add_u32 v6, s23, v6
  v_and_b32 v7, 7, v6
  v_lshrrev_b32 v6, 3, v6
  v_and_b32 v8, 1, v6
  v_lshrrev_b32 v9, 1, v6
  s_mov_b32 s16, 613566757
  v_mul_hi_u32 v10, v9, s16
  v_mul_u32_u24 v11, 7, v10
  v_sub_u32 v11, v9, v11
  v_mul_u32_u24 v10, 112, v10
  v_lshrrev_b32 v12, 1, v11
  v_lshlrev_b32 v12, 3, v12
  v_lshl_add_u32 v12, v8, 4, v12
  v_and_b32 v13, 1, v11
  v_lshl_add_u32 v12, v13, 1, v12
  v_mov_b32 v14, 32
  v_mov_b32 v15, 4
  v_subrev_u32 v13, 4, v11
  v_lshlrev_b32 v13, 1, v13
  v_lshl_add_u32 v13, v8, 3, v13
  v_add_u32 v13, 64, v13
  v_mov_b32 v16, 16
  v_cmp_le_u32 vcc, 4, v11
  s_nop 1
  v_cndmask_b32 v12, v12, v13, vcc
  v_cndmask_b32 v14, v14, v16, vcc
  v_lshlrev_b32 v13, 2, v8
  v_add_u32 v13, 96, v13
  v_mov_b32 v16, 8
  v_mov_b32 v17, 2
  v_cmp_le_u32 vcc, 6, v11
  s_nop 1
  v_cndmask_b32 v12, v12, v13, vcc
  v_cndmask_b32 v14, v14, v16, vcc
  v_cndmask_b32 v15, v15, v17, vcc
  v_add_u32 v12, v12, v10
  v_mov_b32 v13, v12
  v_lshrrev_b32 v16, 3, v13
  v_lshlrev_b32 v16, 7, v16
  v_and_b32 v13, 7, v13
  v_lshl_add_u32 v16, v13, 1, v16
  v_lshl_add_u32 v18, v7, 4, v16
  v_mov_b32 v13, v12
  v_add_u32 v13, v13, v15
  v_lshrrev_b32 v16, 3, v13
  v_lshlrev_b32 v16, 7, v16
  v_and_b32 v13, 7, v13
  v_lshl_add_u32 v16, v13, 1, v16
  v_lshl_add_u32 v19, v7, 4, v16
  v_mov_b32 v13, v12
  v_add_u32 v13, v13, v14
  v_lshrrev_b32 v16, 3, v13
  v_lshlrev_b32 v16, 7, v16
  v_and_b32 v13, 7, v13
  v_lshl_add_u32 v16, v13, 1, v16
  v_lshl_add_u32 v20, v7, 4, v16
  v_mov_b32 v13, v12
  v_add_u32 v13, v13, v14
  v_add_u32 v13, v13, v15
  v_lshrrev_b32 v16, 3, v13
  v_lshlrev_b32 v16, 7, v16
  v_and_b32 v13, 7, v13
  v_lshl_add_u32 v16, v13, 1, v16
  v_lshl_add_u32 v21, v7, 4, v16
  v_lshl_add_u32 v117, v19, 16, v18
  v_lshl_add_u32 v118, v21, 16, v20
  s_mov_b32 s33, 136
  s_mov_b32 s30, 0x3fff3fff
  s_mov_b32 s31, 0x3fff3fff
  s_mov_b32 s24, 48762880
  s_mov_b32 s25, 49221632
  s_mul_i32 s16, s14, 28672
  s_add_u32 s37, s16, 19398656
  s_mul_i32 s17, s13, 7168
  s_add_u32 s26, s37, s17
  s_mul_i32 s16, s14, 7168
  s_add_u32 s27, s16, 49954816
  s_mov_b32 s15, 0
  s_mov_b32 s39, 49876992
  v_lshlrev_b32 v119, 2, v2
  s_lshl_b32 s16, s14, 2
  s_add_u32 s53, s16, 49876992
  s_waitcnt vmcnt(0)
  s_lshl_b32 s60, s14, 7
  s_add_u32 s60, s60, 49913856
  s_mov_b32 s21, 0
L_sp_vafu:
  buffer_load_dword v88, off, s[8:11], s60 sc1
  s_add_u32 s21, s21, 1
  s_cmp_gt_u32 s21, 50000
  s_cbranch_scc1 L_ch_fail
  s_waitcnt vmcnt(0)
  v_readfirstlane_b32 s20, v88
  s_nop 0
  s_cmp_ge_u32 s20, 7
  s_cbranch_scc1 L_sp_vafu_ok
  s_sleep 4
  s_branch L_sp_vafu
L_sp_vafu_ok:
  s_mov_b32 s61, 49883648
  s_mov_b32 s62, 0x0fff0fff
  s_mov_b32 s63, 0x0fff0fff
L_va_loop:
  v_mov_b32 v0, 0
  v_mov_b32 v1, 0
  v_mov_b32 v2, 0
  v_mov_b32 v3, 0
  v_mov_b32 v4, 0
  v_mov_b32 v5, 0
  v_mov_b32 v6, 0
  v_mov_b32 v7, 0
  v_mov_b32 v8, 0
  v_mov_b32 v9, 0
  v_mov_b32 v10, 0
  v_mov_b32 v11, 0
  v_mov_b32 v12, 0
  v_mov_b32 v13, 0
  v_mov_b32 v14, 0
  v_mov_b32 v15, 0
  v_mov_b32 v16, 0
  v_mov_b32 v17, 0
  v_mov_b32 v18, 0
  v_mov_b32 v19, 0
  v_mov_b32 v20, 0
  v_mov_b32 v21, 0
  v_mov_b32 v22, 0
  v_mov_b32 v23, 0
  v_mov_b32 v24, 0
  v_mov_b32 v25, 0
  v_mov_b32 v26, 0
  v_mov_b32 v27, 0
  s_cmp_eq_u32 s13, 1
  s_cbranch_scc1 L_va_g1
  s_cmp_eq_u32 s13, 2
  s_cbranch_scc0 L_va_gj
  s_add_u32 s20, s24, 4096
  s_mov_b32 s21, 0
L_pm_va2:
  buffer_load_dwordx4 v[28:31], v107, s[8:11], s20 offen offset:0 sc1
  buffer_load_dwordx4 v[32:35], v107, s[8:11], s20 offen offset:1024 sc1
  buffer_load_dwordx4 v[36:39], v107, s[8:11], s20 offen offset:2048 sc1
  s_add_u32 s21, s21, 1
  s_cmp_gt_u32 s21, 50000
  s_cbranch_scc1 L_ch_fail
  s_waitcnt vmcnt(0)
  v_max3_u32 v44, v28, v29, v30
  v_max3_u32 v45, v31, v32, v33
  v_max3_u32 v46, v34, v35, v36
  v_max3_u32 v47, v37, v38, v39
  v_max3_u32 v44, v44, v45, v46
  v_max_u32 v44, v44, v47
  v_cmp_eq_u32 vcc, -1, v44
  s_cbranch_vccnz L_pm_va2
  ds_write_b128 v107, v[28:31] offset:4096
  ds_write_b128 v107, v[32:35] offset:5120
  ds_write_b128 v107, v[36:39] offset:6144
  s_branch L_va_gj
L_va_g1:
  s_mov_b32 s21, 0
L_pm_va1:
  buffer_load_dwordx4 v[28:31], v107, s[8:11], s24 offen offset:0 sc1
  buffer_load_dwordx4 v[32:35], v107, s[8:11], s24 offen offset:1024 sc1
  buffer_load_dwordx4 v[36:39], v107, s[8:11], s24 offen offset:2048 sc1
  buffer_load_dwordx4 v[40:43], v107, s[8:11], s24 offen offset:3072 sc1
  s_add_u32 s21, s21, 1
  s_cmp_gt_u32 s21, 50000
  s_cbranch_scc1 L_ch_fail
  s_waitcnt vmcnt(0)
  v_max3_u32 v44, v28, v29, v30
  v_max3_u32 v45, v31, v32, v33
  v_max3_u32 v46, v34, v35, v36
  v_max3_u32 v47, v37, v38, v39
  v_max3_u32 v48, v40, v41, v42
  v_max3_u32 v44, v44, v45, v46
  v_max3_u32 v45, v47, v48, v43
  v_max_u32 v44, v44, v45
  v_cmp_eq_u32 vcc, -1, v44
  s_cbranch_vccnz L_pm_va1
  ds_write_b128 v107, v[28:31] offset:0
  ds_write_b128 v107, v[32:35] offset:1024
  ds_write_b128 v107, v[36:39] offset:2048
  ds_write_b128 v107, v[40:43] offset:3072
L_va_gj:
  s_waitcnt lgkmcnt(0)
  s_barrier
  ds_read_b128 v[28:31], v107 offset:0
  ds_read_b128 v[32:35], v107 offset:1024
  ds_read_b128 v[36:39], v107 offset:2048
  ds_read_b128 v[40:43], v107 offset:3072
  ds_read_b128 v[44:47], v107 offset:4096
  ds_read_b128 v[48:51], v107 offset:5120
  ds_read_b128 v[52:55], v107 offset:6144
  s_waitcnt lgkmcnt(6)
  v_smfmac_f32_16x16x64_bf16 v[0:3], v[28:31], a[0:7], v104
  s_add_u32 s20, s26, 0
  buffer_load_dwordx4 v[56:59], v111, s[8:11], s20 offen sc1
  v_smfmac_f32_16x16x64_bf16 v[4:7], v[28:31], a[56:63], v104
  v_smfmac_f32_16x16x64_bf16 v[8:11], v[28:31], a[112:119], v104
  v_smfmac_f32_16x16x64_bf16 v[12:15], v[28:31], a[168:175], v104
  s_add_u32 s20, s26, 1024
  s_mov_b64 exec, s[62:63]
  buffer_load_dwordx4 v[64:67], v111, s[8:11], s20 offen sc1
  s_mov_b64 exec, -1
  v_smfmac_f32_16x16x64_bf16 v[16:19], v[28:31], a[224:231], v104
  v_smfmac_f32_16x16x64_bf16 v[20:23], v[28:31], v[144:151], v104
  v_smfmac_f32_16x16x64_bf16 v[24:27], v[28:31], v[200:207], v104
  s_add_u32 s20, s26, 1792
  buffer_load_dwordx4 v[60:63], v111, s[8:11], s20 offen sc1
  s_waitcnt lgkmcnt(5)
  v_smfmac_f32_16x16x64_bf16 v[0:3], v[32:35], a[8:15], v104
  s_add_u32 s20, s26, 2816
  s_mov_b64 exec, s[62:63]
  buffer_load_dwordx4 v[68:71], v111, s[8:11], s20 offen sc1
  s_mov_b64 exec, -1
  v_smfmac_f32_16x16x64_bf16 v[4:7], v[32:35], a[64:71], v104
  v_smfmac_f32_16x16x64_bf16 v[8:11], v[32:35], a[120:127], v104
  v_smfmac_f32_16x16x64_bf16 v[12:15], v[32:35], a[176:183], v104
  s_add_u32 s20, s26, 3584
  buffer_load_dwordx4 v[72:75], v111, s[8:11], s20 offen sc1
  v_smfmac_f32_16x16x64_bf16 v[16:19], v[32:35], a[232:239], v104
  v_smfmac_f32_16x16x64_bf16 v[20:23], v[32:35], v[152:159], v104
  v_smfmac_f32_16x16x64_bf16 v[24:27], v[32:35], v[208:215], v104
  s_add_u32 s20, s26, 4608
  s_mov_b64 exec, s[62:63]
  buffer_load_dwordx4 v[80:83], v111, s[8:11], s20 offen sc1
  s_mov_b64 exec, -1
  s_cmp_eq_u32 s36, 1
  s_cbranch_scc1 L_va_ypub
L_va_ypubb:
  s_waitcnt lgkmcnt(0)
  v_smfmac_f32_16x16x64_bf16 v[24:27], v[36:39], v[216:223], v104
  v_smfmac_f32_16x16x64_bf16 v[24:27], v[40:43], v[224:231], v104
  s_add_u32 s20, s26, 5376
  buffer_load_dwordx4 v[76:79], v111, s[8:11], s20 offen sc1
  v_smfmac_f32_16x16x64_bf16 v[24:27], v[44:47], v[232:239], v104
  v_smfmac_f32_16x16x64_bf16 v[24:27], v[48:51], v[240:247], v104
  v_smfmac_f32_16x16x64_bf16 v[24:27], v[52:55], v[248:255], v104
  s_add_u32 s20, s26, 6400
  s_mov_b64 exec, s[62:63]
  buffer_load_dwordx4 v[84:87], v111, s[8:11], s20 offen sc1
  s_mov_b64 exec, -1
  v_smfmac_f32_16x16x64_bf16 v[0:3], v[36:39], a[16:23], v104
  v_smfmac_f32_16x16x64_bf16 v[4:7], v[36:39], a[72:79], v104
  v_smfmac_f32_16x16x64_bf16 v[0:3], v[40:43], a[24:31], v104
  v_smfmac_f32_16x16x64_bf16 v[4:7], v[40:43], a[80:87], v104
  v_smfmac_f32_16x16x64_bf16 v[0:3], v[44:47], a[32:39], v104
  v_smfmac_f32_16x16x64_bf16 v[4:7], v[44:47], a[88:95], v104
  v_smfmac_f32_16x16x64_bf16 v[0:3], v[48:51], a[40:47], v104
  v_smfmac_f32_16x16x64_bf16 v[4:7], v[48:51], a[96:103], v104
  v_smfmac_f32_16x16x64_bf16 v[0:3], v[52:55], a[48:55], v104
  v_smfmac_f32_16x16x64_bf16 v[4:7], v[52:55], a[104:111], v104
  v_smfmac_f32_16x16x64_bf16 v[8:11], v[36:39], a[128:135], v104
  v_smfmac_f32_16x16x64_bf16 v[12:15], v[36:39], a[184:191], v104
  v_smfmac_f32_16x16x64_bf16 v[8:11], v[40:43], a[136:143], v104
  v_mov_b32 v32, v24
  v_mov_b32 v33, v25
  v_mov_b32 v34, v26
  v_smfmac_f32_16x16x64_bf16 v[12:15], v[40:43], a[192:199], v104
  v_mov_b32 v35, v27
  v_permlane32_swap_b32 v24, v32
  v_permlane32_swap_b32 v25, v33
  v_smfmac_f32_16x16x64_bf16 v[8:11], v[44:47], a[144:151], v104
  v_permlane32_swap_b32 v26, v34
  v_permlane32_swap_b32 v27, v35
  v_add_f32 v28, v24, v32
  v_smfmac_f32_16x16x64_bf16 v[12:15], v[44:47], a[200:207], v104
  v_add_f32 v29, v25, v33
  v_add_f32 v30, v26, v34
  v_add_f32 v31, v27, v35
  v_smfmac_f32_16x16x64_bf16 v[8:11], v[48:51], a[152:159], v104
  v_cvt_pk_bf16_f32 v24, v28, v29
  v_cvt_pk_bf16_f32 v25, v30, v31
  ds_write_b64 v108, v[24:25] offset:1536
  v_smfmac_f32_16x16x64_bf16 v[12:15], v[48:51], a[208:215], v104
  v_permlane32_swap_b32 v0, v4
  v_permlane32_swap_b32 v1, v5
  v_permlane32_swap_b32 v2, v6
  v_smfmac_f32_16x16x64_bf16 v[8:11], v[52:55], a[160:167], v104
  v_permlane32_swap_b32 v3, v7
  v_add_f32 v28, v0, v4
  v_add_f32 v29, v1, v5
  v_smfmac_f32_16x16x64_bf16 v[12:15], v[52:55], a[216:223], v104
  v_add_f32 v30, v2, v6
  v_add_f32 v31, v3, v7
  v_cvt_pk_bf16_f32 v26, v28, v29
  v_cvt_pk_bf16_f32 v27, v30, v31
  ds_write_b64 v108, v[26:27] offset:0
  v_smfmac_f32_16x16x64_bf16 v[16:19], v[36:39], a[240:247], v104
  v_smfmac_f32_16x16x64_bf16 v[20:23], v[36:39], v[160:167], v104
  v_smfmac_f32_16x16x64_bf16 v[16:19], v[40:43], a[248:255], v104
  v_smfmac_f32_16x16x64_bf16 v[20:23], v[40:43], v[168:175], v104
  v_smfmac_f32_16x16x64_bf16 v[16:19], v[44:47], v[120:127], v104
  v_smfmac_f32_16x16x64_bf16 v[20:23], v[44:47], v[176:183], v104
  v_smfmac_f32_16x16x64_bf16 v[16:19], v[48:51], v[128:135], v104
  v_smfmac_f32_16x16x64_bf16 v[20:23], v[48:51], v[184:191], v104
  v_permlane32_swap_b32 v8, v12
  v_permlane32_swap_b32 v9, v13
  v_smfmac_f32_16x16x64_bf16 v[16:19], v[52:55], v[136:143], v104
  v_permlane32_swap_b32 v10, v14
  v_permlane32_swap_b32 v11, v15
  v_smfmac_f32_16x16x64_bf16 v[20:23], v[52:55], v[192:199], v104
  v_add_f32 v28, v8, v12
  v_add_f32 v29, v9, v13
  v_add_f32 v30, v10, v14
  v_add_f32 v31, v11, v15
  v_cvt_pk_bf16_f32 v0, v28, v29
  v_cvt_pk_bf16_f32 v1, v30, v31
  ds_write_b64 v108, v[0:1] offset:512
  s_nop 0
  v_permlane32_swap_b32 v16, v20
  v_permlane32_swap_b32 v17, v21
  v_permlane32_swap_b32 v18, v22
  v_permlane32_swap_b32 v19, v23
  v_add_f32 v28, v16, v20
  v_add_f32 v29, v17, v21
  v_add_f32 v30, v18, v22
  v_add_f32 v31, v19, v23
  v_cvt_pk_bf16_f32 v2, v28, v29
  v_cvt_pk_bf16_f32 v3, v30, v31
  ds_write_b64 v108, v[2:3] offset:1024
  s_cmp_lt_u32 s15, 63
  s_cbranch_scc1 L_va_cont
  buffer_store_dwordx2 v[26:27], v110, s[8:11], s27 offen offset:0 sc1
  buffer_store_dwordx2 v[0:1], v110, s[8:11], s27 offen offset:512 sc1
  buffer_store_dwordx2 v[2:3], v110, s[8:11], s27 offen offset:1024 sc1
  s_mov_b32 exec_hi, 0
  buffer_store_dwordx2 v[24:25], v110, s[8:11], s27 offen offset:1536 sc1
  s_mov_b32 exec_hi, -1
  s_waitcnt vmcnt(0)
  s_barrier
  s_cmp_lg_u32 s13, 0
  s_cbranch_scc1 L_ch_done
  v_mov_b32 v28, 1
  s_mov_b64 exec, 1
  buffer_atomic_add v28, off, s[8:11], s61
  s_mov_b64 exec, -1
  s_branch L_ch_done
L_va_cont:
  s_waitcnt lgkmcnt(0)
  ds_read_b128 v[88:91], v109
  ds_read_b128 v[92:95], v109 offset:256
  v_mov_b32 v96, 0
  v_mov_b32 v97, 0
  v_mov_b32 v98, 0
  v_mov_b32 v99, 0
  v_mov_b32 v100, 0
  v_mov_b32 v101, 0
  v_mov_b32 v102, 0
  v_mov_b32 v103, 0
  s_sleep 4
  s_mov_b32 s21, 0
L_pp_va:
  buffer_load_dwordx4 v[28:31], v112, s[8:11], s25 offen sc1
  buffer_load_dwordx4 v[32:35], v112, s[8:11], s25 offen offset:1024 sc1
  buffer_load_dwordx2 v[36:37], v113, s[8:11], s25 offen sc1
  s_add_u32 s21, s21, 1
  s_cmp_gt_u32 s21, 50000
  s_cbranch_scc1 L_ch_fail
  s_waitcnt vmcnt(0)
  v_max3_u32 v48, v28, v29, v30
  v_max3_u32 v49, v31, v32, v33
  v_max3_u32 v50, v34, v35, v36
  v_max3_u32 v48, v48, v49, v50
  v_max_u32 v48, v48, v37
  v_cmp_eq_u32 vcc, -1, v48
  s_cbranch_vccnz L_pp_va
  s_waitcnt lgkmcnt(0)
  v_smfmac_f32_16x16x32_bf16 v[96:99], v[36:37], v[88:91], v104
  v_smfmac_f32_16x16x32_bf16 v[100:103], v[36:37], v[92:95], v104
  v_smfmac_f32_16x16x64_bf16 v[96:99], v[28:31], v[56:63], v104
  v_smfmac_f32_16x16x64_bf16 v[100:103], v[28:31], v[64:71], v104
  v_smfmac_f32_16x16x64_bf16 v[96:99], v[32:35], v[72:79], v104
  v_smfmac_f32_16x16x64_bf16 v[100:103], v[32:35], v[80:87], v104
  s_nop 7
  v_permlane32_swap_b32 v96, v100
  v_permlane32_swap_b32 v97, v101
  v_permlane32_swap_b32 v98, v102
  v_permlane32_swap_b32 v99, v103
  v_add_f32 v52, v96, v100
  v_add_f32 v53, v97, v101
  v_add_f32 v54, v98, v102
  v_add_f32 v55, v99, v103
  ds_write_b32 v114, v52 offset:0
  ds_write_b32 v114, v53 offset:128
  ds_write_b32 v114, v54 offset:256
  ds_write_b32 v114, v55 offset:384
  s_waitcnt lgkmcnt(0)
  s_barrier
  s_cmp_eq_u32 s13, 1
  s_cbranch_scc1 L_va_next
  s_cmp_eq_u32 s13, 2
  s_cbranch_scc1 L_va_next
  ds_read_b64 v[4:5], v115 offset:0
  ds_read_b64 v[6:7], v115 offset:1024
  ds_read_b64 v[8:9], v115 offset:2048
  ds_read_b64 v[10:11], v115 offset:3072
  s_waitcnt lgkmcnt(2)
  v_pk_add_f32 v[4:5], v[4:5], v[6:7]
  s_waitcnt lgkmcnt(0)
  v_pk_add_f32 v[8:9], v[8:9], v[10:11]
  v_pk_add_f32 v[4:5], v[4:5], v[8:9]
  s_add_u32 s20, s24, 7168
  v_cvt_pk_bf16_f32 v6, v4, v5
  s_mov_b64 exec, s[30:31]
  buffer_store_dword v6, v116, s[8:11], s20 offen
  s_mov_b64 exec, -1
  s_cmp_lg_u32 s15, 62
  s_cbranch_scc1 L_va_next
  s_cmp_lg_u32 s13, 3
  s_cbranch_scc1 L_va_next
  v_mov_b32 v8, 1
  s_mov_b32 s20, 49884160
  s_mov_b64 exec, 1
  buffer_atomic_add v8, off, s[8:11], s20
  s_mov_b64 exec, -1
L_va_next:
  s_add_u32 s24, s24, 7168
  s_add_u32 s25, s25, 10240
  s_add_u32 s26, s26, 458752
  s_add_u32 s27, s27, 114688
  s_add_u32 s15, s15, 1
  s_mov_b32 s36, s58
  s_branch L_va_loop
L_va_ypub:
  ds_read_b128 v[88:91], v105 offset:0
  ds_read_b128 v[92:95], v106 offset:1024
  ds_read_b128 v[96:99], v105 offset:2304
  ds_read_b128 v[100:103], v105 offset:3328
  s_sub_u32 s20, s27, 114688
  s_add_u32 s20, s20, s35
  s_waitcnt lgkmcnt(0)
  buffer_store_dwordx4 v[88:91], v107, s[8:11], s20 offen offset:0 sc1
  buffer_store_dwordx4 v[92:95], v107, s[8:11], s20 offen offset:1024 sc1
  buffer_store_dwordx4 v[96:99], v107, s[8:11], s20 offen offset:2048 sc1
  s_mov_b32 exec_hi, 0
  buffer_store_dwordx4 v[100:103], v107, s[8:11], s20 offen offset:3072 sc1
  s_mov_b32 exec_hi, -1
  s_cmp_lg_u32 s13, 0
  s_cbranch_scc1 L_va_ypubb
  v_and_b32 v88, 0xffff, v117
  v_lshrrev_b32 v89, 16, v117
  v_and_b32 v90, 0xffff, v118
  v_lshrrev_b32 v91, 16, v118
  ds_read_b32 v92, v88
  ds_read_b32 v93, v89
  ds_read_b32 v94, v90
  ds_read_b32 v95, v91
  s_mul_i32 s20, s14, 448
  s_add_u32 s20, s20, s24
  s_add_u32 s20, s20, -43257856
  s_waitcnt lgkmcnt(0)
  s_mov_b32 exec_lo, 0x0fffffff
  s_mov_b32 exec_hi, 0
  buffer_store_dwordx4 v[92:95], v107, s[8:11], s20 offen sc1
  s_mov_b64 exec, -1
  s_cmp_lg_u32 s15, 63
  s_cbranch_scc1 L_va_ypubb
  v_mov_b32 v88, 1
  s_mov_b32 s20, 49884288
  s_waitcnt vmcnt(0)
  s_mov_b64 exec, 1
  buffer_atomic_add v88, off, s[8:11], s20
  s_mov_b64 exec, -1
  s_branch L_va_ypubb
L_ch_fail:
  s_mov_b64 exec, 1
  v_mov_b32 v1, 68
  v_mov_b32 v2, 1
  global_atomic_add v1, v2, s[6:7]
L_ch_done:
  s_waitcnt vmcnt(0)
L_ch_end:
  s_endpgm
L_worker:
  s_mov_b32 s3, s13
  s_cmp_gt_u32 s12, s15
  s_cselect_b32 s16, 1, 0
  s_sub_u32 s86, s12, s16
  s_min_u32 s86, s86, 6
  s_and_b32 s81, s15, 0xfffffffe
  s_cmp_gt_u32 s86, s81
  s_cselect_b32 s16, 1, 0
  s_sub_u32 s82, s86, s16
  s_cmp_eq_u32 s86, s81
  s_cselect_b32 s82, 6, s82
  s_lshl_b32 s90, s82, 5
  s_add_u32 s90, s90, s34
  s_cmp_ge_u32 s34, 32
  s_nop 0
  s_cbranch_scc1 L_w_ovf
  s_cmp_ge_u32 s12, 8
  s_nop 0
  s_cbranch_scc1 L_w_ovf
  s_branch L_w_idok
L_w_ovf:
  s_mov_b32 s23, 0
  v_and_b32 v1, 15, v0
  v_lshlrev_b32 v1, 7, v1
  s_mov_b32 s16, 49951744
L_w_o1:
  buffer_load_dword v2, v1, s[8:11], s16 offen sc1
  s_add_u32 s23, s23, 1
  s_cmp_gt_u32 s23, 50000
  s_cbranch_scc1 L_w_fail
  s_waitcnt vmcnt(0)
  s_mov_b32 s17, 0
  s_mov_b32 s18, 0
  s_mov_b32 s19, 0
L_w_o2:
  s_nop 3
  v_readlane_b32 s20, v2, s19
  s_nop 0
  s_add_u32 s17, s17, s20
  s_sub_i32 s21, s20, 32
  s_max_i32 s21, s21, 0
  s_cmp_ge_u32 s19, 8
  s_cselect_b32 s21, s20, s21
  s_cmp_lt_u32 s19, s12
  s_cselect_b32 s21, s21, 0
  s_add_u32 s18, s18, s21
  s_add_u32 s19, s19, 1
  s_cmp_lt_u32 s19, 16
  s_cbranch_scc1 L_w_o2
  s_cmp_lg_u32 s17, 256
  s_cbranch_scc1 L_w_o1
  s_sub_u32 s21, s34, 32
  s_cmp_ge_u32 s12, 8
  s_cselect_b32 s21, s34, s21
  s_add_u32 s18, s18, s21
  s_mov_b32 s19, 0
  s_mov_b32 s90, 224
L_w_o3:
  s_cmp_eq_u32 s19, s15
  s_cbranch_scc1 L_w_o4
  s_nop 3
  v_readlane_b32 s20, v2, s19
  s_nop 0
  s_sub_i32 s21, 32, s20
  s_max_i32 s21, s21, 0
  s_cmp_lt_u32 s18, s21
  s_cbranch_scc0 L_w_o5
  s_cmp_gt_u32 s19, s15
  s_cselect_b32 s16, 1, 0
  s_sub_u32 s16, s19, s16
  s_cmp_gt_u32 s16, s81
  s_cselect_b32 s21, 1, 0
  s_sub_u32 s21, s16, s21
  s_cmp_eq_u32 s16, s81
  s_cselect_b32 s16, 6, s21
  s_lshl_b32 s90, s16, 5
  s_add_u32 s90, s90, s20
  s_add_u32 s90, s90, s18
  s_branch L_w_idok
L_w_o5:
  s_sub_u32 s18, s18, s21
L_w_o4:
  s_add_u32 s19, s19, 1
  s_cmp_lt_u32 s19, 8
  s_cbranch_scc1 L_w_o3
L_w_idok:
  s_cmp_ge_u32 s90, 224
  s_cbranch_scc1 L_w_end
  s_cmp_ge_u32 s90, 112
  s_cbranch_scc1 L_w_xv
  v_lshlrev_b32 v1, 4, v0
  s_mul_i32 s26, s90, 57344
  s_add_u32 s26, s26, 12976128
  s_add_u32 s23, s26, 0
  buffer_load_dwordx4 a[0:3], v1, s[8:11], s23 offen
  s_add_u32 s23, s26, 1024
  buffer_load_dwordx4 a[4:7], v1, s[8:11], s23 offen
  s_add_u32 s23, s26, 2048
  buffer_load_dwordx4 a[8:11], v1, s[8:11], s23 offen
  s_add_u32 s23, s26, 3072
  buffer_load_dwordx4 a[12:15], v1, s[8:11], s23 offen
  s_add_u32 s23, s26, 4096
  buffer_load_dwordx4 a[16:19], v1, s[8:11], s23 offen
  s_add_u32 s23, s26, 5120
  buffer_load_dwordx4 a[20:23], v1, s[8:11], s23 offen
  s_add_u32 s23, s26, 6144
  buffer_load_dwordx4 a[24:27], v1, s[8:11], s23 offen
  s_add_u32 s23, s26, 7168
  buffer_load_dwordx4 a[28:31], v1, s[8:11], s23 offen
  s_add_u32 s23, s26, 8192
  buffer_load_dwordx4 a[32:35], v1, s[8:11], s23 offen
  s_add_u32 s23, s26, 9216
  buffer_load_dwordx4 a[36:39], v1, s[8:11], s23 offen
  s_add_u32 s23, s26, 10240
  buffer_load_dwordx4 a[40:43], v1, s[8:11], s23 offen
  s_add_u32 s23, s26, 11264
  buffer_load_dwordx4 a[44:47], v1, s[8:11], s23 offen
  s_add_u32 s23, s26, 12288
  buffer_load_dwordx4 a[48:51], v1, s[8:11], s23 offen
  s_add_u32 s23, s26, 13312
  buffer_load_dwordx4 a[52:55], v1, s[8:11], s23 offen
  s_add_u32 s23, s26, 14336
  buffer_load_dwordx4 a[56:59], v1, s[8:11], s23 offen
  s_add_u32 s23, s26, 15360
  buffer_load_dwordx4 a[60:63], v1, s[8:11], s23 offen
  s_add_u32 s23, s26, 16384
  buffer_load_dwordx4 a[64:67], v1, s[8:11], s23 offen
  s_add_u32 s23, s26, 17408
  buffer_load_dwordx4 a[68:71], v1, s[8:11], s23 offen
  s_add_u32 s23, s26, 18432
  buffer_load_dwordx4 a[72:75], v1, s[8:11], s23 offen
  s_add_u32 s23, s26, 19456
  buffer_load_dwordx4 a[76:79], v1, s[8:11], s23 offen
  s_add_u32 s23, s26, 20480
  buffer_load_dwordx4 a[80:83], v1, s[8:11], s23 offen
  s_add_u32 s23, s26, 21504
  buffer_load_dwordx4 a[84:87], v1, s[8:11], s23 offen
  s_add_u32 s23, s26, 22528
  buffer_load_dwordx4 a[88:91], v1, s[8:11], s23 offen
  s_add_u32 s23, s26, 23552
  buffer_load_dwordx4 a[92:95], v1, s[8:11], s23 offen
  s_add_u32 s23, s26, 24576
  buffer_load_dwordx4 a[96:99], v1, s[8:11], s23 offen
  s_add_u32 s23, s26, 25600
  buffer_load_dwordx4 a[100:103], v1, s[8:11], s23 offen
  s_add_u32 s23, s26, 26624
  buffer_load_dwordx4 a[104:107], v1, s[8:11], s23 offen
  s_add_u32 s23, s26, 27648
  buffer_load_dwordx4 a[108:111], v1, s[8:11], s23 offen
  s_waitcnt vmcnt(8)
  s_add_u32 s23, s26, 28672
  buffer_load_dwordx4 a[112:115], v1, s[8:11], s23 offen
  s_add_u32 s23, s26, 29696
  buffer_load_dwordx4 a[116:119], v1, s[8:11], s23 offen
  s_add_u32 s23, s26, 30720
  buffer_load_dwordx4 a[120:123], v1, s[8:11], s23 offen
  s_add_u32 s23, s26, 31744
  buffer_load_dwordx4 a[124:127], v1, s[8:11], s23 offen
  s_add_u32 s23, s26, 32768
  buffer_load_dwordx4 a[128:131], v1, s[8:11], s23 offen
  s_add_u32 s23, s26, 33792
  buffer_load_dwordx4 a[132:135], v1, s[8:11], s23 offen
  s_add_u32 s23, s26, 34816
  buffer_load_dwordx4 a[136:139], v1, s[8:11], s23 offen
  s_add_u32 s23, s26, 35840
  buffer_load_dwordx4 a[140:143], v1, s[8:11], s23 offen
  s_add_u32 s23, s26, 36864
  buffer_load_dwordx4 a[144:147], v1, s[8:11], s23 offen
  s_add_u32 s23, s26, 37888
  buffer_load_dwordx4 a[148:151], v1, s[8:11], s23 offen
  s_add_u32 s23, s26, 38912
  buffer_load_dwordx4 a[152:155], v1, s[8:11], s23 offen
  s_add_u32 s23, s26, 39936
  buffer_load_dwordx4 a[156:159], v1, s[8:11], s23 offen
  s_add_u32 s23, s26, 40960
  buffer_load_dwordx4 a[160:163], v1, s[8:11], s23 offen
  s_add_u32 s23, s26, 41984
  buffer_load_dwordx4 a[164:167], v1, s[8:11], s23 offen
  s_add_u32 s23, s26, 43008
  buffer_load_dwordx4 a[168:171], v1, s[8:11], s23 offen
  s_add_u32 s23, s26, 44032
  buffer_load_dwordx4 a[172:175], v1, s[8:11], s23 offen
  s_add_u32 s23, s26, 45056
  buffer_load_dwordx4 a[176:179], v1, s[8:11], s23 offen
  s_add_u32 s23, s26, 46080
  buffer_load_dwordx4 a[180:183], v1, s[8:11], s23 offen
  s_add_u32 s23, s26, 47104
  buffer_load_dwordx4 a[184:187], v1, s[8:11], s23 offen
  s_add_u32 s23, s26, 48128
  buffer_load_dwordx4 a[188:191], v1, s[8:11], s23 offen
  s_add_u32 s23, s26, 49152
  buffer_load_dwordx4 a[192:195], v1, s[8:11], s23 offen
  s_add_u32 s23, s26, 50176
  buffer_load_dwordx4 a[196:199], v1, s[8:11], s23 offen
  s_add_u32 s23, s26, 51200
  buffer_load_dwordx4 a[200:203], v1, s[8:11], s23 offen
  s_add_u32 s23, s26, 52224
  buffer_load_dwordx4 a[204:207], v1, s[8:11], s23 offen
  s_add_u32 s23, s26, 53248
  buffer_load_dwordx4 a[208:211], v1, s[8:11], s23 offen
  s_add_u32 s23, s26, 54272
  buffer_load_dwordx4 a[212:215], v1, s[8:11], s23 offen
  s_add_u32 s23, s26, 55296
  buffer_load_dwordx4 a[216:219], v1, s[8:11], s23 offen
  s_add_u32 s23, s26, 56320
  buffer_load_dwordx4 a[220:223], v1, s[8:11], s23 offen
  s_mul_i32 s27, s3, 28672
  s_add_u32 s27, s27, 0
  s_waitcnt vmcnt(20)
  s_add_u32 s23, s27, 0
  buffer_load_dwordx4 v[8:11], v1, s[8:11], s23 offen
  s_add_u32 s23, s27, 1024
  buffer_load_dwordx4 v[12:15], v1, s[8:11], s23 offen
  s_add_u32 s23, s27, 2048
  buffer_load_dwordx4 v[16:19], v1, s[8:11], s23 offen
  s_add_u32 s23, s27, 3072
  buffer_load_dwordx4 v[20:23], v1, s[8:11], s23 offen
  s_add_u32 s23, s27, 4096
  buffer_load_dwordx4 v[24:27], v1, s[8:11], s23 offen
  s_add_u32 s23, s27, 5120
  buffer_load_dwordx4 v[28:31], v1, s[8:11], s23 offen
  s_add_u32 s23, s27, 6144
  buffer_load_dwordx4 v[32:35], v1, s[8:11], s23 offen
  s_add_u32 s23, s27, 7168
  buffer_load_dwordx4 v[36:39], v1, s[8:11], s23 offen
  s_add_u32 s23, s27, 8192
  buffer_load_dwordx4 v[40:43], v1, s[8:11], s23 offen
  s_add_u32 s23, s27, 9216
  buffer_load_dwordx4 v[44:47], v1, s[8:11], s23 offen
  s_add_u32 s23, s27, 10240
  buffer_load_dwordx4 v[48:51], v1, s[8:11], s23 offen
  s_add_u32 s23, s27, 11264
  buffer_load_dwordx4 v[52:55], v1, s[8:11], s23 offen
  s_add_u32 s23, s27, 12288
  buffer_load_dwordx4 v[56:59], v1, s[8:11], s23 offen
  s_add_u32 s23, s27, 13312
  buffer_load_dwordx4 v[60:63], v1, s[8:11], s23 offen
  s_add_u32 s23, s27, 14336
  buffer_load_dwordx4 v[64:67], v1, s[8:11], s23 offen
  s_add_u32 s23, s27, 15360
  buffer_load_dwordx4 v[68:71], v1, s[8:11], s23 offen
  s_add_u32 s23, s27, 16384
  buffer_load_dwordx4 v[72:75], v1, s[8:11], s23 offen
  s_add_u32 s23, s27, 17408
  buffer_load_dwordx4 v[76:79], v1, s[8:11], s23 offen
  s_add_u32 s23, s27, 18432
  buffer_load_dwordx4 v[80:83], v1, s[8:11], s23 offen
  s_add_u32 s23, s27, 19456
  buffer_load_dwordx4 v[84:87], v1, s[8:11], s23 offen
  s_add_u32 s23, s27, 20480
  buffer_load_dwordx4 v[88:91], v1, s[8:11], s23 offen
  s_add_u32 s23, s27, 21504
  buffer_load_dwordx4 v[92:95], v1, s[8:11], s23 offen
  s_add_u32 s23, s27, 22528
  buffer_load_dwordx4 v[96:99], v1, s[8:11], s23 offen
  s_add_u32 s23, s27, 23552
  buffer_load_dwordx4 v[100:103], v1, s[8:11], s23 offen
  s_add_u32 s23, s27, 24576
  buffer_load_dwordx4 v[104:107], v1, s[8:11], s23 offen
  s_add_u32 s23, s27, 25600
  buffer_load_dwordx4 v[108:111], v1, s[8:11], s23 offen
  s_add_u32 s23, s27, 26624
  buffer_load_dwordx4 v[112:115], v1, s[8:11], s23 offen
  s_add_u32 s23, s27, 27648
  buffer_load_dwordx4 v[116:119], v1, s[8:11], s23 offen
  buffer_load_dword v200, off, s[8:11], s27
  buffer_load_dword v201, off, s[8:11], s27
  buffer_load_dword v202, off, s[8:11], s27
  buffer_load_dword v203, off, s[8:11], s27
  v_and_b32 v5, 31, v0
  v_lshrrev_b32 v6, 5, v0
  v_lshlrev_b32 v4, 6, v5
  v_lshl_add_u32 v4, v6, 4, v4
  s_lshl_b32 s21, s3, 12
  v_add_u32 v5, s21, v4
  v_add_u32 v6, s21, v1
  s_mul_hi_u32 s20, s90, 613566757
  s_mul_i32 s21, s20, 7
  s_sub_u32 s21, s90, s21
  s_lshl_b32 s31, s3, 4
  s_add_u32 s31, s31, s20
  s_mul_i32 s31, s31, 28672
  s_lshl_b32 s21, s21, 12
  s_add_u32 s31, s31, s21
  s_add_u32 s31, s31, 19398656
  s_lshl_b32 s32, s20, 7
  s_add_u32 s32, s32, 49913856
  s_mov_b32 s24, 0
L_u_blk:
  s_cmp_lt_u32 s24, 5
  s_cbranch_scc1 L_u_go
  s_sub_u32 s73, s24, 4
  s_lshl_b32 s73, s73, 6
  s_cmp_lg_u32 s3, 0
  s_cbranch_scc1 L_fc_up_j
  s_mov_b32 s77, 49883136
  s_mov_b32 s23, 0
L_fc_up:
  buffer_load_dword v2, off, s[8:11], s77 sc1
  s_add_u32 s23, s23, 1
  s_cmp_gt_u32 s23, 50000
  s_cbranch_scc1 L_w_fail
  s_waitcnt vmcnt(0)
  v_readfirstlane_b32 s22, v2
  s_nop 0
  s_cmp_ge_u32 s22, s73
  s_cbranch_scc1 L_fc_up_j
  s_sub_u32 s22, s73, s22
  s_lshr_b32 s22, s22, 4
  s_min_u32 s22, s22, 16
  s_cmp_lt_u32 s22, 2
  s_cbranch_scc1 L_fc_up_s
  s_sub_u32 s22, s22, 1
L_fc_up_l:
  s_sleep 44
  s_sub_u32 s22, s22, 1
  s_cmp_lg_u32 s22, 0
  s_cbranch_scc1 L_fc_up_l
  s_branch L_fc_up
L_fc_up_s:
  s_sleep 56
  s_branch L_fc_up
L_fc_up_j:
  s_barrier
L_u_go:
  s_add_u32 s28, s27, 114688
  s_cmp_eq_u32 s24, 15
  s_cselect_b32 s28, s27, s28
  s_waitcnt vmcnt(31)
  v_mfma_f32_32x32x16_bf16 v[120:135], v[8:11], a[0:3], 0
  v_mfma_f32_32x32x16_bf16 v[136:151], v[8:11], a[112:115], 0
  s_add_u32 s23, s28, 0
  buffer_load_dwordx4 v[8:11], v1, s[8:11], s23 offen
  s_waitcnt vmcnt(31)
  v_mfma_f32_32x32x16_bf16 v[120:135], v[12:15], a[4:7], v[120:135]
  v_mfma_f32_32x32x16_bf16 v[136:151], v[12:15], a[116:119], v[136:151]
  s_add_u32 s23, s28, 1024
  buffer_load_dwordx4 v[12:15], v1, s[8:11], s23 offen
  s_waitcnt vmcnt(31)
  v_mfma_f32_32x32x16_bf16 v[120:135], v[16:19], a[8:11], v[120:135]
  v_mfma_f32_32x32x16_bf16 v[136:151], v[16:19], a[120:123], v[136:151]
  s_add_u32 s23, s28, 2048
  buffer_load_dwordx4 v[16:19], v1, s[8:11], s23 offen
  s_waitcnt vmcnt(31)
  v_mfma_f32_32x32x16_bf16 v[120:135], v[20:23], a[12:15], v[120:135]
  v_mfma_f32_32x32x16_bf16 v[136:151], v[20:23], a[124:127], v[136:151]
  s_add_u32 s23, s28, 3072
  buffer_load_dwordx4 v[20:23], v1, s[8:11], s23 offen
  s_waitcnt vmcnt(31)
  v_mfma_f32_32x32x16_bf16 v[120:135], v[24:27], a[16:19], v[120:135]
  v_mfma_f32_32x32x16_bf16 v[136:151], v[24:27], a[128:131], v[136:151]
  s_add_u32 s23, s28, 4096
  buffer_load_dwordx4 v[24:27], v1, s[8:11], s23 offen
  s_waitcnt vmcnt(31)
  v_mfma_f32_32x32x16_bf16 v[120:135], v[28:31], a[20:23], v[120:135]
  v_mfma_f32_32x32x16_bf16 v[136:151], v[28:31], a[132:135], v[136:151]
  s_add_u32 s23, s28, 5120
  buffer_load_dwordx4 v[28:31], v1, s[8:11], s23 offen
  s_waitcnt vmcnt(31)
  v_mfma_f32_32x32x16_bf16 v[120:135], v[32:35], a[24:27], v[120:135]
  v_mfma_f32_32x32x16_bf16 v[136:151], v[32:35], a[136:139], v[136:151]
  s_add_u32 s23, s28, 6144
  buffer_load_dwordx4 v[32:35], v1, s[8:11], s23 offen
  s_waitcnt vmcnt(31)
  v_mfma_f32_32x32x16_bf16 v[120:135], v[36:39], a[28:31], v[120:135]
  v_mfma_f32_32x32x16_bf16 v[136:151], v[36:39], a[140:143], v[136:151]
  s_add_u32 s23, s28, 7168
  buffer_load_dwordx4 v[36:39], v1, s[8:11], s23 offen
  s_waitcnt vmcnt(31)
  v_mfma_f32_32x32x16_bf16 v[120:135], v[40:43], a[32:35], v[120:135]
  v_mfma_f32_32x32x16_bf16 v[136:151], v[40:43], a[144:147], v[136:151]
  s_add_u32 s23, s28, 8192
  buffer_load_dwordx4 v[40:43], v1, s[8:11], s23 offen
  s_waitcnt vmcnt(31)
  v_mfma_f32_32x32x16_bf16 v[120:135], v[44:47], a[36:39], v[120:135]
  v_mfma_f32_32x32x16_bf16 v[136:151], v[44:47], a[148:151], v[136:151]
  s_add_u32 s23, s28, 9216
  buffer_load_dwordx4 v[44:47], v1, s[8:11], s23 offen
  s_waitcnt vmcnt(31)
  v_mfma_f32_32x32x16_bf16 v[120:135], v[48:51], a[40:43], v[120:135]
  v_mfma_f32_32x32x16_bf16 v[136:151], v[48:51], a[152:155], v[136:151]
  s_add_u32 s23, s28, 10240
  buffer_load_dwordx4 v[48:51], v1, s[8:11], s23 offen
  s_waitcnt vmcnt(31)
  v_mfma_f32_32x32x16_bf16 v[120:135], v[52:55], a[44:47], v[120:135]
  v_mfma_f32_32x32x16_bf16 v[136:151], v[52:55], a[156:159], v[136:151]
  s_add_u32 s23, s28, 11264
  buffer_load_dwordx4 v[52:55], v1, s[8:11], s23 offen
  s_waitcnt vmcnt(31)
  v_mfma_f32_32x32x16_bf16 v[120:135], v[56:59], a[48:51], v[120:135]
  v_mfma_f32_32x32x16_bf16 v[136:151], v[56:59], a[160:163], v[136:151]
  s_add_u32 s23, s28, 12288
  buffer_load_dwordx4 v[56:59], v1, s[8:11], s23 offen
  s_waitcnt vmcnt(31)
  v_mfma_f32_32x32x16_bf16 v[120:135], v[60:63], a[52:55], v[120:135]
  v_mfma_f32_32x32x16_bf16 v[136:151], v[60:63], a[164:167], v[136:151]
  s_add_u32 s23, s28, 13312
  buffer_load_dwordx4 v[60:63], v1, s[8:11], s23 offen
  s_waitcnt vmcnt(31)
  v_mfma_f32_32x32x16_bf16 v[120:135], v[64:67], a[56:59], v[120:135]
  v_mfma_f32_32x32x16_bf16 v[136:151], v[64:67], a[168:171], v[136:151]
  s_add_u32 s23, s28, 14336
  buffer_load_dwordx4 v[64:67], v1, s[8:11], s23 offen
  s_waitcnt vmcnt(31)
  v_mfma_f32_32x32x16_bf16 v[120:135], v[68:71], a[60:63], v[120:135]
  v_mfma_f32_32x32x16_bf16 v[136:151], v[68:71], a[172:175], v[136:151]
  s_add_u32 s23, s28, 15360
  buffer_load_dwordx4 v[68:71], v1, s[8:11], s23 offen
  s_waitcnt vmcnt(31)
  v_mfma_f32_32x32x16_bf16 v[120:135], v[72:75], a[64:67], v[120:135]
  v_mfma_f32_32x32x16_bf16 v[136:151], v[72:75], a[176:179], v[136:151]
  s_add_u32 s23, s28, 16384
  buffer_load_dwordx4 v[72:75], v1, s[8:11], s23 offen
  s_waitcnt vmcnt(31)
  v_mfma_f32_32x32x16_bf16 v[120:135], v[76:79], a[68:71], v[120:135]
  v_mfma_f32_32x32x16_bf16 v[136:151], v[76:79], a[180:183], v[136:151]
  s_add_u32 s23, s28, 17408
  buffer_load_dwordx4 v[76:79], v1, s[8:11], s23 offen
  s_waitcnt vmcnt(31)
  v_mfma_f32_32x32x16_bf16 v[120:135], v[80:83], a[72:75], v[120:135]
  v_mfma_f32_32x32x16_bf16 v[136:151], v[80:83], a[184:187], v[136:151]
  s_add_u32 s23, s28, 18432
  buffer_load_dwordx4 v[80:83], v1, s[8:11], s23 offen
  s_waitcnt vmcnt(31)
  v_mfma_f32_32x32x16_bf16 v[120:135], v[84:87], a[76:79], v[120:135]
  v_mfma_f32_32x32x16_bf16 v[136:151], v[84:87], a[188:191], v[136:151]
  s_add_u32 s23, s28, 19456
  buffer_load_dwordx4 v[84:87], v1, s[8:11], s23 offen
  s_waitcnt vmcnt(31)
  v_mfma_f32_32x32x16_bf16 v[120:135], v[88:91], a[80:83], v[120:135]
  v_mfma_f32_32x32x16_bf16 v[136:151], v[88:91], a[192:195], v[136:151]
  s_add_u32 s23, s28, 20480
  buffer_load_dwordx4 v[88:91], v1, s[8:11], s23 offen
  s_waitcnt vmcnt(31)
  v_mfma_f32_32x32x16_bf16 v[120:135], v[92:95], a[84:87], v[120:135]
  v_mfma_f32_32x32x16_bf16 v[136:151], v[92:95], a[196:199], v[136:151]
  s_add_u32 s23, s28, 21504
  buffer_load_dwordx4 v[92:95], v1, s[8:11], s23 offen
  s_waitcnt vmcnt(31)
  v_mfma_f32_32x32x16_bf16 v[120:135], v[96:99], a[88:91], v[120:135]
  v_mfma_f32_32x32x16_bf16 v[136:151], v[96:99], a[200:203], v[136:151]
  s_add_u32 s23, s28, 22528
  buffer_load_dwordx4 v[96:99], v1, s[8:11], s23 offen
  s_waitcnt vmcnt(31)
  v_mfma_f32_32x32x16_bf16 v[120:135], v[100:103], a[92:95], v[120:135]
  v_mfma_f32_32x32x16_bf16 v[136:151], v[100:103], a[204:207], v[136:151]
  s_add_u32 s23, s28, 23552
  buffer_load_dwordx4 v[100:103], v1, s[8:11], s23 offen
  s_waitcnt vmcnt(31)
  v_mfma_f32_32x32x16_bf16 v[120:135], v[104:107], a[96:99], v[120:135]
  v_mfma_f32_32x32x16_bf16 v[136:151], v[104:107], a[208:211], v[136:151]
  s_add_u32 s23, s28, 24576
  buffer_load_dwordx4 v[104:107], v1, s[8:11], s23 offen
  s_waitcnt vmcnt(31)
  v_mfma_f32_32x32x16_bf16 v[120:135], v[108:111], a[100:103], v[120:135]
  v_mfma_f32_32x32x16_bf16 v[136:151], v[108:111], a[212:215], v[136:151]
  s_add_u32 s23, s28, 25600
  buffer_load_dwordx4 v[108:111], v1, s[8:11], s23 offen
  s_waitcnt vmcnt(31)
  v_mfma_f32_32x32x16_bf16 v[120:135], v[112:115], a[104:107], v[120:135]
  v_mfma_f32_32x32x16_bf16 v[136:151], v[112:115], a[216:219], v[136:151]
  s_add_u32 s23, s28, 26624
  buffer_load_dwordx4 v[112:115], v1, s[8:11], s23 offen
  s_waitcnt vmcnt(31)
  v_mfma_f32_32x32x16_bf16 v[120:135], v[116:119], a[108:111], v[120:135]
  v_mfma_f32_32x32x16_bf16 v[136:151], v[116:119], a[220:223], v[136:151]
  s_add_u32 s23, s28, 27648
  buffer_load_dwordx4 v[116:119], v1, s[8:11], s23 offen
  s_cmp_eq_u32 s24, 0
  s_nop 6
  s_cbranch_scc1 L_u_nf
  s_waitcnt vmcnt(28)
  s_barrier
  s_cmp_lg_u32 s3, 0
  s_cbranch_scc1 L_u_nf
  s_sub_u32 s33, s32, 2048
  v_mov_b32 v2, 1
  s_mov_b64 exec, 1
  buffer_atomic_add v2, off, s[8:11], s33
  s_mov_b64 exec, -1
L_u_nf:
  v_cvt_pk_bf16_f32 v152, v120, v121
  v_cvt_pk_bf16_f32 v153, v122, v123
  v_cvt_pk_bf16_f32 v154, v124, v125
  v_cvt_pk_bf16_f32 v155, v126, v127
  v_cvt_pk_bf16_f32 v156, v128, v129
  v_cvt_pk_bf16_f32 v157, v130, v131
  v_cvt_pk_bf16_f32 v158, v132, v133
  v_cvt_pk_bf16_f32 v159, v134, v135
  v_permlane32_swap_b32 v152, v154
  v_permlane32_swap_b32 v153, v155
  v_permlane32_swap_b32 v156, v158
  v_permlane32_swap_b32 v157, v159
  ds_write_b128 v5, v[152:155] offset:0
  ds_write_b128 v5, v[156:159] offset:32
  s_waitcnt lgkmcnt(0)
  ds_read_b128 v[160:163], v6 offset:0
  ds_read_b128 v[164:167], v6 offset:1024
  s_waitcnt lgkmcnt(0)
  buffer_store_dwordx4 v[160:163], v1, s[8:11], s31 offen offset:0 sc1
  buffer_store_dwordx4 v[164:167], v1, s[8:11], s31 offen offset:1024 sc1
  v_cvt_pk_bf16_f32 v152, v136, v137
  v_cvt_pk_bf16_f32 v153, v138, v139
  v_cvt_pk_bf16_f32 v154, v140, v141
  v_cvt_pk_bf16_f32 v155, v142, v143
  v_cvt_pk_bf16_f32 v156, v144, v145
  v_cvt_pk_bf16_f32 v157, v146, v147
  v_cvt_pk_bf16_f32 v158, v148, v149
  v_cvt_pk_bf16_f32 v159, v150, v151
  v_permlane32_swap_b32 v152, v154
  v_permlane32_swap_b32 v153, v155
  v_permlane32_swap_b32 v156, v158
  v_permlane32_swap_b32 v157, v159
  ds_write_b128 v5, v[152:155] offset:2048
  ds_write_b128 v5, v[156:159] offset:2080
  s_waitcnt lgkmcnt(0)
  ds_read_b128 v[168:171], v6 offset:2048
  ds_read_b128 v[172:175], v6 offset:3072
  s_waitcnt lgkmcnt(0)
  buffer_store_dwordx4 v[168:171], v1, s[8:11], s31 offen offset:2048 sc1
  buffer_store_dwordx4 v[172:175], v1, s[8:11], s31 offen offset:3072 sc1
  s_mov_b32 s27, s28
  s_add_u32 s31, s31, 1835008
  s_add_u32 s32, s32, 2048
  s_add_u32 s24, s24, 1
  s_cmp_lt_u32 s24, 16
  s_cbranch_scc1 L_u_blk
  s_waitcnt vmcnt(0)
  s_barrier
  s_cmp_lg_u32 s3, 0
  s_nop 0
  s_cbranch_scc1 L_u_fin
  s_sub_u32 s33, s32, 2048
  v_mov_b32 v2, 1
  s_mov_b64 exec, 1
  buffer_atomic_add v2, off, s[8:11], s33
  s_mov_b64 exec, -1
L_u_fin:
  s_cmp_ge_u32 s90, 98
  s_cbranch_scc1 L_w_g2pre
  s_mov_b32 s72, 49883776
  s_cmp_lg_u32 s3, 0
  s_cbranch_scc1 L_wf_w1
  s_mov_b32 s23, 0
L_sp_w1:
  buffer_load_dword v2, off, s[8:11], s72 sc1
  s_add_u32 s23, s23, 1
  s_cmp_gt_u32 s23, 50000
  s_cbranch_scc1 L_w_fail
  s_waitcnt vmcnt(0)
  v_readfirstlane_b32 s22, v2
  s_nop 0
  s_cmp_ge_u32 s22, 224
  s_cbranch_scc1 L_sp_w1_ok
  s_sleep 16
  s_branch L_sp_w1
L_sp_w1_ok:
L_wf_w1:
  s_barrier
  s_mov_b32 s85, s86
  s_mov_b32 s88, 0
L_q_a:
  s_cmp_lg_u32 s3, 0
  s_cbranch_scc1 L_qp_a
  s_lshl_b32 s16, s85, 7
  s_add_u32 s16, s16, 49950720
  v_mov_b32 v1, 1
  s_mov_b64 exec, 1
  buffer_atomic_add v1, off, s[8:11], s16 sc0
  s_waitcnt vmcnt(0)
  v_mov_b32 v2, 20488
  ds_write_b32 v2, v1
  s_waitcnt lgkmcnt(0)
  s_mov_b64 exec, -1
L_qp_a:
  s_barrier
  v_mov_b32 v2, 20488
  ds_read_b32 v1, v2
  s_waitcnt lgkmcnt(0)
  v_readfirstlane_b32 s84, v1
  s_barrier
  s_cmp_lt_u32 s84, 32
  s_nop 0
  s_cbranch_scc1 L_qh_a
  s_add_u32 s88, s88, 1
  s_cmp_ge_u32 s88, 7
  s_cbranch_scc1 L_w_end
  s_add_u32 s85, s85, 1
  s_cmp_ge_u32 s85, 7
  s_cselect_b32 s85, 0, s85
  s_branch L_q_a
L_qh_a:
  s_mov_b32 s72, 49883904
  s_cmp_lg_u32 s3, 0
  s_cbranch_scc1 L_wf_w2a
  s_mov_b32 s23, 0
L_sp_w2a:
  buffer_load_dword v2, off, s[8:11], s72 sc1
  s_add_u32 s23, s23, 1
  s_cmp_gt_u32 s23, 50000
  s_cbranch_scc1 L_w_fail
  s_waitcnt vmcnt(0)
  v_readfirstlane_b32 s22, v2
  s_nop 0
  s_cmp_ge_u32 s22, 224
  s_cbranch_scc1 L_sp_w2a_ok
  s_sleep 16
  s_branch L_sp_w2a
L_sp_w2a_ok:
L_wf_w2a:
  s_barrier
  v_lshlrev_b32 v1, 4, v0
  s_mul_i32 s27, s84, 229376
  s_mul_i32 s21, s3, 28672
  s_add_u32 s27, s27, s21
  s_add_u32 s27, s27, 74108928
  s_mov_b32 s83, s27
  s_load_dwordx2 s[16:17], s[0:1], 72
  s_waitcnt lgkmcnt(0)
  s_mov_b32 s12, s16
  s_mov_b32 s13, s17
  s_mov_b32 s14, 3584
  s_mov_b32 s15, 0x00020000
  v_lshlrev_b32 v1, 4, v0
  s_lshl_b32 s20, s90, 2
  s_add_u32 s20, s20, s3
  s_mul_hi_u32 s25, s20, 613566757
  s_mul_i32 s21, s25, 7
  s_sub_u32 s26, s20, s21
  s_mul_i32 s30, s25, 131072
  s_add_u32 s30, s30, 66768896
  s_mul_i32 s31, s26, 262144
  s_add_u32 s31, s31, 63328256
  v_and_b32 v2, 15, v0
  v_lshlrev_b32 v2, 7, v2
  v_mov_b32 v8, 0
  v_mov_b32 v9, 0
  v_mov_b32 v10, 0
  v_mov_b32 v11, 0
  v_mov_b32 v12, 0
  v_mov_b32 v13, 0
  v_mov_b32 v14, 0
  v_mov_b32 v15, 0
  v_mov_b32 v16, 0
  v_mov_b32 v17, 0
  v_mov_b32 v18, 0
  v_mov_b32 v19, 0
  v_mov_b32 v20, 0
  v_mov_b32 v21, 0
  v_mov_b32 v22, 0
  v_mov_b32 v23, 0
  v_mov_b32 v24, 0
  v_mov_b32 v25, 0
  v_mov_b32 v26, 0
  v_mov_b32 v27, 0
  v_mov_b32 v28, 0
  v_mov_b32 v29, 0
  v_mov_b32 v30, 0
  v_mov_b32 v31, 0
  v_mov_b32 v32, 0
  v_mov_b32 v33, 0
  v_mov_b32 v34, 0
  v_mov_b32 v35, 0
  v_mov_b32 v36, 0
  v_mov_b32 v37, 0
  v_mov_b32 v38, 0
  v_mov_b32 v39, 0
  v_lshrrev_b32 v3, 5, v0
  s_lshl_b32 s21, s25, 6
  v_lshlrev_b32 v4, 3, v3
  buffer_load_dwordx2 v[140:141], v4, s[12:15], s21 offen offset:0
  buffer_load_dwordx2 v[142:143], v4, s[12:15], s21 offen offset:16
  buffer_load_dwordx2 v[144:145], v4, s[12:15], s21 offen offset:32
  buffer_load_dwordx2 v[146:147], v4, s[12:15], s21 offen offset:48
  s_mov_b32 s79, 0
L_g1_blk:
  s_add_u32 s73, s79, 6
  s_lshr_b32 s22, s79, 2
  s_mul_i32 s22, s22, 1
  s_add_u32 s22, s22, 30
  s_max_u32 s73, s73, s22
  s_min_u32 s73, s73, 62
  s_lshl_b32 s73, s73, 4
  s_cmp_lg_u32 s3, 0
  s_cbranch_scc1 L_fc_g1_j
  s_mov_b32 s77, 49883136
  s_mov_b32 s23, 0
L_fc_g1:
  buffer_load_dword v3, off, s[8:11], s77 sc1
  s_add_u32 s23, s23, 1
  s_cmp_gt_u32 s23, 50000
  s_cbranch_scc1 L_w_fail
  s_waitcnt vmcnt(0)
  v_readfirstlane_b32 s22, v3
  s_nop 0
  s_cmp_ge_u32 s22, s73
  s_cbranch_scc1 L_fc_g1_j
  s_sub_u32 s22, s73, s22
  s_lshr_b32 s22, s22, 4
  s_min_u32 s22, s22, 16
  s_cmp_lt_u32 s22, 2
  s_cbranch_scc1 L_fc_g1_s
  s_sub_u32 s22, s22, 1
L_fc_g1_l:
  s_sleep 44
  s_sub_u32 s22, s22, 1
  s_cmp_lg_u32 s22, 0
  s_cbranch_scc1 L_fc_g1_l
  s_branch L_fc_g1
L_fc_g1_s:
  s_sleep 40
  s_branch L_fc_g1
L_fc_g1_j:
  s_barrier
  s_cmp_lg_u32 s3, 0
  s_cbranch_scc1 L_gh_b_j
  s_lshl_b32 s77, s79, 7
  s_add_u32 s77, s77, 49905664
  s_mov_b32 s23, 0
  s_mov_b64 exec, 0xf
L_gh_b:
  buffer_load_dword v3, v2, s[8:11], s77 offen sc1
  s_add_u32 s23, s23, 1
  s_cmp_gt_u32 s23, 50000
  s_cbranch_scc1 L_w_fail
  s_waitcnt vmcnt(0)
  v_cmp_gt_u32 vcc, 4, v3
  s_cbranch_vccz L_gh_b_k
  s_sleep 24
  s_branch L_gh_b
L_gh_b_k:
  s_mov_b64 exec, -1
L_gh_b_j:
  s_barrier
  s_lshl_b32 s21, s79, 11
  s_add_u32 s23, s21, 0
  s_add_u32 s22, s23, s30
  buffer_load_dwordx4 v[40:43], v1, s[8:11], s22 offen sc1
  s_add_u32 s22, s23, s31
  s_add_u32 s22, s22, 0
  buffer_load_dwordx4 v[44:47], v1, s[8:11], s22 offen sc1
  s_add_u32 s22, s23, s31
  s_add_u32 s22, s22, 131072
  buffer_load_dwordx4 v[48:51], v1, s[8:11], s22 offen sc1
  s_add_u32 s23, s21, 1024
  s_add_u32 s22, s23, s30
  buffer_load_dwordx4 v[52:55], v1, s[8:11], s22 offen sc1
  s_add_u32 s22, s23, s31
  s_add_u32 s22, s22, 0
  buffer_load_dwordx4 v[56:59], v1, s[8:11], s22 offen sc1
  s_add_u32 s22, s23, s31
  s_add_u32 s22, s22, 131072
  buffer_load_dwordx4 v[60:63], v1, s[8:11], s22 offen sc1
  s_add_u32 s23, s21, 2048
  s_add_u32 s22, s23, s30
  buffer_load_dwordx4 v[64:67], v1, s[8:11], s22 offen sc1
  s_add_u32 s22, s23, s31
  s_add_u32 s22, s22, 0
  buffer_load_dwordx4 v[68:71], v1, s[8:11], s22 offen sc1
  s_add_u32 s22, s23, s31
  s_add_u32 s22, s22, 131072
  buffer_load_dwordx4 v[72:75], v1, s[8:11], s22 offen sc1
  s_add_u32 s23, s21, 3072
  s_add_u32 s22, s23, s30
  buffer_load_dwordx4 v[76:79], v1, s[8:11], s22 offen sc1
  s_add_u32 s22, s23, s31
  s_add_u32 s22, s22, 0
  buffer_load_dwordx4 v[80:83], v1, s[8:11], s22 offen sc1
  s_add_u32 s22, s23, s31
  s_add_u32 s22, s22, 131072
  buffer_load_dwordx4 v[84:87], v1, s[8:11], s22 offen sc1
  s_add_u32 s23, s21, 4096
  s_add_u32 s22, s23, s30
  buffer_load_dwordx4 v[88:91], v1, s[8:11], s22 offen sc1
  s_add_u32 s22, s23, s31
  s_add_u32 s22, s22, 0
  buffer_load_dwordx4 v[92:95], v1, s[8:11], s22 offen sc1
  s_add_u32 s22, s23, s31
  s_add_u32 s22, s22, 131072
  buffer_load_dwordx4 v[96:99], v1, s[8:11], s22 offen sc1
  s_add_u32 s23, s21, 5120
  s_add_u32 s22, s23, s30
  buffer_load_dwordx4 v[100:103], v1, s[8:11], s22 offen sc1
  s_add_u32 s22, s23, s31
  s_add_u32 s22, s22, 0
  buffer_load_dwordx4 v[104:107], v1, s[8:11], s22 offen sc1
  s_add_u32 s22, s23, s31
  s_add_u32 s22, s22, 131072
  buffer_load_dwordx4 v[108:111], v1, s[8:11], s22 offen sc1
  s_add_u32 s23, s21, 6144
  s_add_u32 s22, s23, s30
  buffer_load_dwordx4 v[112:115], v1, s[8:11], s22 offen sc1
  s_add_u32 s22, s23, s31
  s_add_u32 s22, s22, 0
  buffer_load_dwordx4 v[116:119], v1, s[8:11], s22 offen sc1
  s_add_u32 s22, s23, s31
  s_add_u32 s22, s22, 131072
  buffer_load_dwordx4 v[120:123], v1, s[8:11], s22 offen sc1
  s_add_u32 s23, s21, 7168
  s_add_u32 s22, s23, s30
  buffer_load_dwordx4 v[124:127], v1, s[8:11], s22 offen sc1
  s_add_u32 s22, s23, s31
  s_add_u32 s22, s22, 0
  buffer_load_dwordx4 v[128:131], v1, s[8:11], s22 offen sc1
  s_add_u32 s22, s23, s31
  s_add_u32 s22, s22, 131072
  buffer_load_dwordx4 v[132:135], v1, s[8:11], s22 offen sc1
  s_waitcnt vmcnt(21)
  v_mfma_f32_32x32x16_bf16 v[8:23], v[40:43], v[44:47], v[8:23]
  v_mfma_f32_32x32x16_bf16 v[24:39], v[40:43], v[48:51], v[24:39]
  s_waitcnt vmcnt(18)
  v_mfma_f32_32x32x16_bf16 v[8:23], v[52:55], v[56:59], v[8:23]
  v_mfma_f32_32x32x16_bf16 v[24:39], v[52:55], v[60:63], v[24:39]
  s_waitcnt vmcnt(15)
  v_mfma_f32_32x32x16_bf16 v[8:23], v[64:67], v[68:71], v[8:23]
  v_mfma_f32_32x32x16_bf16 v[24:39], v[64:67], v[72:75], v[24:39]
  s_waitcnt vmcnt(12)
  v_mfma_f32_32x32x16_bf16 v[8:23], v[76:79], v[80:83], v[8:23]
  v_mfma_f32_32x32x16_bf16 v[24:39], v[76:79], v[84:87], v[24:39]
  s_waitcnt vmcnt(9)
  v_mfma_f32_32x32x16_bf16 v[8:23], v[88:91], v[92:95], v[8:23]
  v_mfma_f32_32x32x16_bf16 v[24:39], v[88:91], v[96:99], v[24:39]
  s_waitcnt vmcnt(6)
  v_mfma_f32_32x32x16_bf16 v[8:23], v[100:103], v[104:107], v[8:23]
  v_mfma_f32_32x32x16_bf16 v[24:39], v[100:103], v[108:111], v[24:39]
  s_waitcnt vmcnt(3)
  v_mfma_f32_32x32x16_bf16 v[8:23], v[112:115], v[116:119], v[8:23]
  v_mfma_f32_32x32x16_bf16 v[24:39], v[112:115], v[120:123], v[24:39]
  s_waitcnt vmcnt(0)
  v_mfma_f32_32x32x16_bf16 v[8:23], v[124:127], v[128:131], v[8:23]
  v_mfma_f32_32x32x16_bf16 v[24:39], v[124:127], v[132:135], v[24:39]
  s_cmp_lg_u32 s79, 0
  s_cbranch_scc1 L_g1_pl0
  s_add_u32 s23, s83, 0
  buffer_load_dwordx4 a[0:3], v1, s[8:11], s23 offen sc1
  s_add_u32 s23, s83, 1024
  buffer_load_dwordx4 a[4:7], v1, s[8:11], s23 offen sc1
  s_add_u32 s23, s83, 2048
  buffer_load_dwordx4 a[8:11], v1, s[8:11], s23 offen sc1
  s_add_u32 s23, s83, 3072
  buffer_load_dwordx4 a[12:15], v1, s[8:11], s23 offen sc1
L_g1_pl0:
  s_cmp_lg_u32 s79, 4
  s_cbranch_scc1 L_g1_pl1
  s_add_u32 s23, s83, 4096
  buffer_load_dwordx4 a[16:19], v1, s[8:11], s23 offen sc1
  s_add_u32 s23, s83, 5120
  buffer_load_dwordx4 a[20:23], v1, s[8:11], s23 offen sc1
  s_add_u32 s23, s83, 6144
  buffer_load_dwordx4 a[24:27], v1, s[8:11], s23 offen sc1
  s_add_u32 s23, s83, 7168
  buffer_load_dwordx4 a[28:31], v1, s[8:11], s23 offen sc1
L_g1_pl1:
  s_cmp_lg_u32 s79, 8
  s_cbranch_scc1 L_g1_pl2
  s_add_u32 s23, s83, 8192
  buffer_load_dwordx4 a[32:35], v1, s[8:11], s23 offen sc1
  s_add_u32 s23, s83, 9216
  buffer_load_dwordx4 a[36:39], v1, s[8:11], s23 offen sc1
  s_add_u32 s23, s83, 10240
  buffer_load_dwordx4 a[40:43], v1, s[8:11], s23 offen sc1
  s_add_u32 s23, s83, 11264
  buffer_load_dwordx4 a[44:47], v1, s[8:11], s23 offen sc1
L_g1_pl2:
  s_cmp_lg_u32 s79, 12
  s_cbranch_scc1 L_g1_pl3
  s_add_u32 s23, s83, 12288
  buffer_load_dwordx4 a[48:51], v1, s[8:11], s23 offen sc1
  s_add_u32 s23, s83, 13312
  buffer_load_dwordx4 a[52:55], v1, s[8:11], s23 offen sc1
  s_add_u32 s23, s83, 14336
  buffer_load_dwordx4 a[56:59], v1, s[8:11], s23 offen sc1
  s_add_u32 s23, s83, 15360
  buffer_load_dwordx4 a[60:63], v1, s[8:11], s23 offen sc1
L_g1_pl3:
  s_cmp_lg_u32 s79, 16
  s_cbranch_scc1 L_g1_pl4
  s_add_u32 s23, s83, 16384
  buffer_load_dwordx4 a[64:67], v1, s[8:11], s23 offen sc1
  s_add_u32 s23, s83, 17408
  buffer_load_dwordx4 a[68:71], v1, s[8:11], s23 offen sc1
  s_add_u32 s23, s83, 18432
  buffer_load_dwordx4 a[72:75], v1, s[8:11], s23 offen sc1
  s_add_u32 s23, s83, 19456
  buffer_load_dwordx4 a[76:79], v1, s[8:11], s23 offen sc1
L_g1_pl4:
  s_cmp_lg_u32 s79, 20
  s_cbranch_scc1 L_g1_pl5
  s_add_u32 s23, s83, 20480
  buffer_load_dwordx4 a[80:83], v1, s[8:11], s23 offen sc1
  s_add_u32 s23, s83, 21504
  buffer_load_dwordx4 a[84:87], v1, s[8:11], s23 offen sc1
  s_add_u32 s23, s83, 22528
  buffer_load_dwordx4 a[88:91], v1, s[8:11], s23 offen sc1
  s_add_u32 s23, s83, 23552
  buffer_load_dwordx4 a[92:95], v1, s[8:11], s23 offen sc1
L_g1_pl5:
  s_cmp_lg_u32 s79, 24
  s_cbranch_scc1 L_g1_pl6
  s_add_u32 s23, s83, 24576
  buffer_load_dwordx4 a[96:99], v1, s[8:11], s23 offen sc1
  s_add_u32 s23, s83, 25600
  buffer_load_dwordx4 a[100:103], v1, s[8:11], s23 offen sc1
  s_add_u32 s23, s83, 26624
  buffer_load_dwordx4 a[104:107], v1, s[8:11], s23 offen sc1
  s_add_u32 s23, s83, 27648
  buffer_load_dwordx4 a[108:111], v1, s[8:11], s23 offen sc1
L_g1_pl6:
  s_cmp_lg_u32 s79, 28
  s_cbranch_scc1 L_g1_pl7
  s_add_u32 s23, s83, 114688
  buffer_load_dwordx4 a[112:115], v1, s[8:11], s23 offen sc1
  s_add_u32 s23, s83, 115712
  buffer_load_dwordx4 a[116:119], v1, s[8:11], s23 offen sc1
  s_add_u32 s23, s83, 116736
  buffer_load_dwordx4 a[120:123], v1, s[8:11], s23 offen sc1
  s_add_u32 s23, s83, 117760
  buffer_load_dwordx4 a[124:127], v1, s[8:11], s23 offen sc1
L_g1_pl7:
  s_cmp_lg_u32 s79, 32
  s_cbranch_scc1 L_g1_pl8
  s_add_u32 s23, s83, 118784
  buffer_load_dwordx4 a[128:131], v1, s[8:11], s23 offen sc1
  s_add_u32 s23, s83, 119808
  buffer_load_dwordx4 a[132:135], v1, s[8:11], s23 offen sc1
  s_add_u32 s23, s83, 120832
  buffer_load_dwordx4 a[136:139], v1, s[8:11], s23 offen sc1
  s_add_u32 s23, s83, 121856
  buffer_load_dwordx4 a[140:143], v1, s[8:11], s23 offen sc1
L_g1_pl8:
  s_cmp_lg_u32 s79, 36
  s_cbranch_scc1 L_g1_pl9
  s_add_u32 s23, s83, 122880
  buffer_load_dwordx4 a[144:147], v1, s[8:11], s23 offen sc1
  s_add_u32 s23, s83, 123904
  buffer_load_dwordx4 a[148:151], v1, s[8:11], s23 offen sc1
  s_add_u32 s23, s83, 124928
  buffer_load_dwordx4 a[152:155], v1, s[8:11], s23 offen sc1
  s_add_u32 s23, s83, 125952
  buffer_load_dwordx4 a[156:159], v1, s[8:11], s23 offen sc1
L_g1_pl9:
  s_cmp_lg_u32 s79, 40
  s_cbranch_scc1 L_g1_pl10
  s_add_u32 s23, s83, 126976
  buffer_load_dwordx4 a[160:163], v1, s[8:11], s23 offen sc1
  s_add_u32 s23, s83, 128000
  buffer_load_dwordx4 a[164:167], v1, s[8:11], s23 offen sc1
  s_add_u32 s23, s83, 129024
  buffer_load_dwordx4 a[168:171], v1, s[8:11], s23 offen sc1
  s_add_u32 s23, s83, 130048
  buffer_load_dwordx4 a[172:175], v1, s[8:11], s23 offen sc1
L_g1_pl10:
  s_cmp_lg_u32 s79, 44
  s_cbranch_scc1 L_g1_pl11
  s_add_u32 s23, s83, 131072
  buffer_load_dwordx4 a[176:179], v1, s[8:11], s23 offen sc1
  s_add_u32 s23, s83, 132096
  buffer_load_dwordx4 a[180:183], v1, s[8:11], s23 offen sc1
  s_add_u32 s23, s83, 133120
  buffer_load_dwordx4 a[184:187], v1, s[8:11], s23 offen sc1
  s_add_u32 s23, s83, 134144
  buffer_load_dwordx4 a[188:191], v1, s[8:11], s23 offen sc1
L_g1_pl11:
  s_cmp_lg_u32 s79, 48
  s_cbranch_scc1 L_g1_pl12
  s_add_u32 s23, s83, 135168
  buffer_load_dwordx4 a[192:195], v1, s[8:11], s23 offen sc1
  s_add_u32 s23, s83, 136192
  buffer_load_dwordx4 a[196:199], v1, s[8:11], s23 offen sc1
  s_add_u32 s23, s83, 137216
  buffer_load_dwordx4 a[200:203], v1, s[8:11], s23 offen sc1
  s_add_u32 s23, s83, 138240
  buffer_load_dwordx4 a[204:207], v1, s[8:11], s23 offen sc1
L_g1_pl12:
  s_cmp_lg_u32 s79, 52
  s_cbranch_scc1 L_g1_pl13
  s_add_u32 s23, s83, 139264
  buffer_load_dwordx4 a[208:211], v1, s[8:11], s23 offen sc1
  s_add_u32 s23, s83, 140288
  buffer_load_dwordx4 a[212:215], v1, s[8:11], s23 offen sc1
  s_add_u32 s23, s83, 141312
  buffer_load_dwordx4 a[216:219], v1, s[8:11], s23 offen sc1
  s_add_u32 s23, s83, 142336
  buffer_load_dwordx4 a[220:223], v1, s[8:11], s23 offen sc1
L_g1_pl13:
  s_add_u32 s79, s79, 4
  s_cmp_lt_u32 s79, 60
  s_cbranch_scc1 L_g1_blk
L_g1_one:
  s_cmp_lg_u32 s3, 0
  s_cbranch_scc1 L_gh_o_j
  s_lshl_b32 s77, s79, 7
  s_add_u32 s77, s77, 49905664
  s_mov_b32 s23, 0
  s_mov_b64 exec, 0x1
L_gh_o:
  buffer_load_dword v3, v2, s[8:11], s77 offen sc1
  s_add_u32 s23, s23, 1
  s_cmp_gt_u32 s23, 50000
  s_cbranch_scc1 L_w_fail
  s_waitcnt vmcnt(0)
  v_cmp_gt_u32 vcc, 4, v3
  s_cbranch_vccz L_gh_o_k
  s_sleep 1
  s_branch L_gh_o
L_gh_o_k:
  s_mov_b64 exec, -1
L_gh_o_j:
  s_barrier
  s_lshl_b32 s21, s79, 11
  s_add_u32 s23, s21, 0
  s_add_u32 s22, s23, s30
  buffer_load_dwordx4 v[40:43], v1, s[8:11], s22 offen sc1
  s_add_u32 s22, s23, s31
  s_add_u32 s22, s22, 0
  buffer_load_dwordx4 v[44:47], v1, s[8:11], s22 offen sc1
  s_add_u32 s22, s23, s31
  s_add_u32 s22, s22, 131072
  buffer_load_dwordx4 v[48:51], v1, s[8:11], s22 offen sc1
  s_add_u32 s23, s21, 1024
  s_add_u32 s22, s23, s30
  buffer_load_dwordx4 v[52:55], v1, s[8:11], s22 offen sc1
  s_add_u32 s22, s23, s31
  s_add_u32 s22, s22, 0
  buffer_load_dwordx4 v[56:59], v1, s[8:11], s22 offen sc1
  s_add_u32 s22, s23, s31
  s_add_u32 s22, s22, 131072
  buffer_load_dwordx4 v[60:63], v1, s[8:11], s22 offen sc1
  s_waitcnt vmcnt(3)
  v_mfma_f32_32x32x16_bf16 v[8:23], v[40:43], v[44:47], v[8:23]
  v_mfma_f32_32x32x16_bf16 v[24:39], v[40:43], v[48:51], v[24:39]
  s_waitcnt vmcnt(0)
  v_mfma_f32_32x32x16_bf16 v[8:23], v[52:55], v[56:59], v[8:23]
  v_mfma_f32_32x32x16_bf16 v[24:39], v[52:55], v[60:63], v[24:39]
  s_add_u32 s79, s79, 1
  s_cmp_lt_u32 s79, 64
  s_cbranch_scc1 L_g1_one
  s_mov_b32 s28, 0xc0135761
  s_mov_b32 s29, 0x3d372713
  v_lshlrev_b32 v50, 16, v140
  v_and_b32 v51, 0xffff0000, v140
  s_nop 3
  v_add_f32 v8, v8, v50
  v_add_f32 v9, v9, v51
  v_lshlrev_b32 v50, 16, v141
  v_and_b32 v51, 0xffff0000, v141
  v_add_f32 v10, v10, v50
  v_add_f32 v11, v11, v51
  v_lshlrev_b32 v50, 16, v142
  v_and_b32 v51, 0xffff0000, v142
  v_add_f32 v12, v12, v50
  v_add_f32 v13, v13, v51
  v_lshlrev_b32 v50, 16, v143
  v_and_b32 v51, 0xffff0000, v143
  v_add_f32 v14, v14, v50
  v_add_f32 v15, v15, v51
  v_lshlrev_b32 v50, 16, v144
  v_and_b32 v51, 0xffff0000, v144
  v_add_f32 v16, v16, v50
  v_add_f32 v17, v17, v51
  v_lshlrev_b32 v50, 16, v145
  v_and_b32 v51, 0xffff0000, v145
  v_add_f32 v18, v18, v50
  v_add_f32 v19, v19, v51
  v_lshlrev_b32 v50, 16, v146
  v_and_b32 v51, 0xffff0000, v146
  v_add_f32 v20, v20, v50
  v_add_f32 v21, v21, v51
  v_lshlrev_b32 v50, 16, v147
  v_and_b32 v51, 0xffff0000, v147
  v_add_f32 v22, v22, v50
  v_add_f32 v23, v23, v51
  v_mul_f32 v60, v8, v8
  v_mul_f32 v61, v9, v9
  v_mul_f32 v62, v10, v10
  v_mul_f32 v63, v11, v11
  v_mul_f32 v64, v12, v12
  v_mul_f32 v65, v13, v13
  v_mul_f32 v66, v14, v14
  v_mul_f32 v67, v15, v15
  v_mul_f32 v68, v16, v16
  v_mul_f32 v69, v17, v17
  v_mul_f32 v70, v18, v18
  v_mul_f32 v71, v19, v19
  v_mul_f32 v72, v20, v20
  v_mul_f32 v73, v21, v21
  v_mul_f32 v74, v22, v22
  v_mul_f32 v75, v23, v23
  v_fma_f32 v60, v60, s29, 1.0
  v_fma_f32 v61, v61, s29, 1.0
  v_fma_f32 v62, v62, s29, 1.0
  v_fma_f32 v63, v63, s29, 1.0
  v_fma_f32 v64, v64, s29, 1.0
  v_fma_f32 v65, v65, s29, 1.0
  v_fma_f32 v66, v66, s29, 1.0
  v_fma_f32 v67, v67, s29, 1.0
  v_fma_f32 v68, v68, s29, 1.0
  v_fma_f32 v69, v69, s29, 1.0
  v_fma_f32 v70, v70, s29, 1.0
  v_fma_f32 v71, v71, s29, 1.0
  v_fma_f32 v72, v72, s29, 1.0
  v_fma_f32 v73, v73, s29, 1.0
  v_fma_f32 v74, v74, s29, 1.0
  v_fma_f32 v75, v75, s29, 1.0
  v_mul_f32 v60, v60, v8
  v_mul_f32 v61, v61, v9
  v_mul_f32 v62, v62, v10
  v_mul_f32 v63, v63, v11
  v_mul_f32 v64, v64, v12
  v_mul_f32 v65, v65, v13
  v_mul_f32 v66, v66, v14
  v_mul_f32 v67, v67, v15
  v_mul_f32 v68, v68, v16
  v_mul_f32 v69, v69, v17
  v_mul_f32 v70, v70, v18
  v_mul_f32 v71, v71, v19
  v_mul_f32 v72, v72, v20
  v_mul_f32 v73, v73, v21
  v_mul_f32 v74, v74, v22
  v_mul_f32 v75, v75, v23
  v_mul_f32 v60, s28, v60
  v_mul_f32 v61, s28, v61
  v_mul_f32 v62, s28, v62
  v_mul_f32 v63, s28, v63
  v_mul_f32 v64, s28, v64
  v_mul_f32 v65, s28, v65
  v_mul_f32 v66, s28, v66
  v_mul_f32 v67, s28, v67
  v_mul_f32 v68, s28, v68
  v_mul_f32 v69, s28, v69
  v_mul_f32 v70, s28, v70
  v_mul_f32 v71, s28, v71
  v_mul_f32 v72, s28, v72
  v_mul_f32 v73, s28, v73
  v_mul_f32 v74, s28, v74
  v_mul_f32 v75, s28, v75
  v_exp_f32 v60, v60
  v_exp_f32 v61, v61
  v_exp_f32 v62, v62
  v_exp_f32 v63, v63
  v_exp_f32 v64, v64
  v_exp_f32 v65, v65
  v_exp_f32 v66, v66
  v_exp_f32 v67, v67
  v_exp_f32 v68, v68
  v_exp_f32 v69, v69
  v_exp_f32 v70, v70
  v_exp_f32 v71, v71
  v_exp_f32 v72, v72
  v_exp_f32 v73, v73
  v_exp_f32 v74, v74
  v_exp_f32 v75, v75
  v_add_f32 v60, 1.0, v60
  v_add_f32 v61, 1.0, v61
  v_add_f32 v62, 1.0, v62
  v_add_f32 v63, 1.0, v63
  v_add_f32 v64, 1.0, v64
  v_add_f32 v65, 1.0, v65
  v_add_f32 v66, 1.0, v66
  v_add_f32 v67, 1.0, v67
  v_add_f32 v68, 1.0, v68
  v_add_f32 v69, 1.0, v69
  v_add_f32 v70, 1.0, v70
  v_add_f32 v71, 1.0, v71
  v_add_f32 v72, 1.0, v72
  v_add_f32 v73, 1.0, v73
  v_add_f32 v74, 1.0, v74
  v_add_f32 v75, 1.0, v75
  v_rcp_f32 v60, v60
  v_rcp_f32 v61, v61
  v_rcp_f32 v62, v62
  v_rcp_f32 v63, v63
  v_rcp_f32 v64, v64
  v_rcp_f32 v65, v65
  v_rcp_f32 v66, v66
  v_rcp_f32 v67, v67
  v_rcp_f32 v68, v68
  v_rcp_f32 v69, v69
  v_rcp_f32 v70, v70
  v_rcp_f32 v71, v71
  v_rcp_f32 v72, v72
  v_rcp_f32 v73, v73
  v_rcp_f32 v74, v74
  v_rcp_f32 v75, v75
  v_mul_f32 v8, v8, v60
  v_mul_f32 v9, v9, v61
  v_mul_f32 v10, v10, v62
  v_mul_f32 v11, v11, v63
  v_mul_f32 v12, v12, v64
  v_mul_f32 v13, v13, v65
  v_mul_f32 v14, v14, v66
  v_mul_f32 v15, v15, v67
  v_mul_f32 v16, v16, v68
  v_mul_f32 v17, v17, v69
  v_mul_f32 v18, v18, v70
  v_mul_f32 v19, v19, v71
  v_mul_f32 v20, v20, v72
  v_mul_f32 v21, v21, v73
  v_mul_f32 v22, v22, v74
  v_mul_f32 v23, v23, v75
  v_cvt_pk_bf16_f32 v80, v8, v9
  v_cvt_pk_bf16_f32 v81, v10, v11
  v_cvt_pk_bf16_f32 v82, v12, v13
  v_cvt_pk_bf16_f32 v83, v14, v15
  v_cvt_pk_bf16_f32 v84, v16, v17
  v_cvt_pk_bf16_f32 v85, v18, v19
  v_cvt_pk_bf16_f32 v86, v20, v21
  v_cvt_pk_bf16_f32 v87, v22, v23
  v_permlane32_swap_b32 v80, v82
  v_permlane32_swap_b32 v81, v83
  v_permlane32_swap_b32 v84, v86
  v_permlane32_swap_b32 v85, v87
  s_lshl_b32 s22, s26, 1
  s_add_u32 s22, s22, 0
  s_mul_i32 s22, s22, 114688
  s_lshl_b32 s23, s25, 11
  s_add_u32 s22, s22, s23
  s_add_u32 s22, s22, 65163264
  buffer_store_dwordx4 v[80:83], v1, s[8:11], s22 offen sc1
  buffer_store_dwordx4 v[84:87], v1, s[8:11], s22 offen offset:1024 sc1
  v_lshlrev_b32 v50, 16, v140
  v_and_b32 v51, 0xffff0000, v140
  v_add_f32 v24, v24, v50
  v_add_f32 v25, v25, v51
  v_lshlrev_b32 v50, 16, v141
  v_and_b32 v51, 0xffff0000, v141
  v_add_f32 v26, v26, v50
  v_add_f32 v27, v27, v51
  v_lshlrev_b32 v50, 16, v142
  v_and_b32 v51, 0xffff0000, v142
  v_add_f32 v28, v28, v50
  v_add_f32 v29, v29, v51
  v_lshlrev_b32 v50, 16, v143
  v_and_b32 v51, 0xffff0000, v143
  v_add_f32 v30, v30, v50
  v_add_f32 v31, v31, v51
  v_lshlrev_b32 v50, 16, v144
  v_and_b32 v51, 0xffff0000, v144
  v_add_f32 v32, v32, v50
  v_add_f32 v33, v33, v51
  v_lshlrev_b32 v50, 16, v145
  v_and_b32 v51, 0xffff0000, v145
  v_add_f32 v34, v34, v50
  v_add_f32 v35, v35, v51
  v_lshlrev_b32 v50, 16, v146
  v_and_b32 v51, 0xffff0000, v146
  v_add_f32 v36, v36, v50
  v_add_f32 v37, v37, v51
  v_lshlrev_b32 v50, 16, v147
  v_and_b32 v51, 0xffff0000, v147
  v_add_f32 v38, v38, v50
  v_add_f32 v39, v39, v51
  v_mul_f32 v60, v24, v24
  v_mul_f32 v61, v25, v25
  v_mul_f32 v62, v26, v26
  v_mul_f32 v63, v27, v27
  v_mul_f32 v64, v28, v28
  v_mul_f32 v65, v29, v29
  v_mul_f32 v66, v30, v30
  v_mul_f32 v67, v31, v31
  v_mul_f32 v68, v32, v32
  v_mul_f32 v69, v33, v33
  v_mul_f32 v70, v34, v34
  v_mul_f32 v71, v35, v35
  v_mul_f32 v72, v36, v36
  v_mul_f32 v73, v37, v37
  v_mul_f32 v74, v38, v38
  v_mul_f32 v75, v39, v39
  v_fma_f32 v60, v60, s29, 1.0
  v_fma_f32 v61, v61, s29, 1.0
  v_fma_f32 v62, v62, s29, 1.0
  v_fma_f32 v63, v63, s29, 1.0
  v_fma_f32 v64, v64, s29, 1.0
  v_fma_f32 v65, v65, s29, 1.0
  v_fma_f32 v66, v66, s29, 1.0
  v_fma_f32 v67, v67, s29, 1.0
  v_fma_f32 v68, v68, s29, 1.0
  v_fma_f32 v69, v69, s29, 1.0
  v_fma_f32 v70, v70, s29, 1.0
  v_fma_f32 v71, v71, s29, 1.0
  v_fma_f32 v72, v72, s29, 1.0
  v_fma_f32 v73, v73, s29, 1.0
  v_fma_f32 v74, v74, s29, 1.0
  v_fma_f32 v75, v75, s29, 1.0
  v_mul_f32 v60, v60, v24
  v_mul_f32 v61, v61, v25
  v_mul_f32 v62, v62, v26
  v_mul_f32 v63, v63, v27
  v_mul_f32 v64, v64, v28
  v_mul_f32 v65, v65, v29
  v_mul_f32 v66, v66, v30
  v_mul_f32 v67, v67, v31
  v_mul_f32 v68, v68, v32
  v_mul_f32 v69, v69, v33
  v_mul_f32 v70, v70, v34
  v_mul_f32 v71, v71, v35
  v_mul_f32 v72, v72, v36
  v_mul_f32 v73, v73, v37
  v_mul_f32 v74, v74, v38
  v_mul_f32 v75, v75, v39
  v_mul_f32 v60, s28, v60
  v_mul_f32 v61, s28, v61
  v_mul_f32 v62, s28, v62
  v_mul_f32 v63, s28, v63
  v_mul_f32 v64, s28, v64
  v_mul_f32 v65, s28, v65
  v_mul_f32 v66, s28, v66
  v_mul_f32 v67, s28, v67
  v_mul_f32 v68, s28, v68
  v_mul_f32 v69, s28, v69
  v_mul_f32 v70, s28, v70
  v_mul_f32 v71, s28, v71
  v_mul_f32 v72, s28, v72
  v_mul_f32 v73, s28, v73
  v_mul_f32 v74, s28, v74
  v_mul_f32 v75, s28, v75
  v_exp_f32 v60, v60
  v_exp_f32 v61, v61
  v_exp_f32 v62, v62
  v_exp_f32 v63, v63
  v_exp_f32 v64, v64
  v_exp_f32 v65, v65
  v_exp_f32 v66, v66
  v_exp_f32 v67, v67
  v_exp_f32 v68, v68
  v_exp_f32 v69, v69
  v_exp_f32 v70, v70
  v_exp_f32 v71, v71
  v_exp_f32 v72, v72
  v_exp_f32 v73, v73
  v_exp_f32 v74, v74
  v_exp_f32 v75, v75
  v_add_f32 v60, 1.0, v60
  v_add_f32 v61, 1.0, v61
  v_add_f32 v62, 1.0, v62
  v_add_f32 v63, 1.0, v63
  v_add_f32 v64, 1.0, v64
  v_add_f32 v65, 1.0, v65
  v_add_f32 v66, 1.0, v66
  v_add_f32 v67, 1.0, v67
  v_add_f32 v68, 1.0, v68
  v_add_f32 v69, 1.0, v69
  v_add_f32 v70, 1.0, v70
  v_add_f32 v71, 1.0, v71
  v_add_f32 v72, 1.0, v72
  v_add_f32 v73, 1.0, v73
  v_add_f32 v74, 1.0, v74
  v_add_f32 v75, 1.0, v75
  v_rcp_f32 v60, v60
  v_rcp_f32 v61, v61
  v_rcp_f32 v62, v62
  v_rcp_f32 v63, v63
  v_rcp_f32 v64, v64
  v_rcp_f32 v65, v65
  v_rcp_f32 v66, v66
  v_rcp_f32 v67, v67
  v_rcp_f32 v68, v68
  v_rcp_f32 v69, v69
  v_rcp_f32 v70, v70
  v_rcp_f32 v71, v71
  v_rcp_f32 v72, v72
  v_rcp_f32 v73, v73
  v_rcp_f32 v74, v74
  v_rcp_f32 v75, v75
  v_mul_f32 v24, v24, v60
  v_mul_f32 v25, v25, v61
  v_mul_f32 v26, v26, v62
  v_mul_f32 v27, v27, v63
  v_mul_f32 v28, v28, v64
  v_mul_f32 v29, v29, v65
  v_mul_f32 v30, v30, v66
  v_mul_f32 v31, v31, v67
  v_mul_f32 v32, v32, v68
  v_mul_f32 v33, v33, v69
  v_mul_f32 v34, v34, v70
  v_mul_f32 v35, v35, v71
  v_mul_f32 v36, v36, v72
  v_mul_f32 v37, v37, v73
  v_mul_f32 v38, v38, v74
  v_mul_f32 v39, v39, v75
  v_cvt_pk_bf16_f32 v88, v24, v25
  v_cvt_pk_bf16_f32 v89, v26, v27
  v_cvt_pk_bf16_f32 v90, v28, v29
  v_cvt_pk_bf16_f32 v91, v30, v31
  v_cvt_pk_bf16_f32 v92, v32, v33
  v_cvt_pk_bf16_f32 v93, v34, v35
  v_cvt_pk_bf16_f32 v94, v36, v37
  v_cvt_pk_bf16_f32 v95, v38, v39
  v_permlane32_swap_b32 v88, v90
  v_permlane32_swap_b32 v89, v91
  v_permlane32_swap_b32 v92, v94
  v_permlane32_swap_b32 v93, v95
  s_lshl_b32 s22, s26, 1
  s_add_u32 s22, s22, 1
  s_mul_i32 s22, s22, 114688
  s_lshl_b32 s23, s25, 11
  s_add_u32 s22, s22, s23
  s_add_u32 s22, s22, 65163264
  buffer_store_dwordx4 v[88:91], v1, s[8:11], s22 offen sc1
  buffer_store_dwordx4 v[92:95], v1, s[8:11], s22 offen offset:1024 sc1
  s_mul_hi_u32 s72, s25, 306783379
  s_mul_i32 s72, s72, 7
  s_add_u32 s72, s72, s26
  s_lshl_b32 s72, s72, 7
  s_add_u32 s72, s72, 49946624
  v_mov_b32 v2, 1
  s_waitcnt vmcnt(0)
  s_mov_b64 exec, 1
  buffer_atomic_add v2, off, s[8:11], s72
  s_mov_b64 exec, -1
  s_branch L_w_g2
L_w_xv:
  s_cmp_ge_u32 s90, 192
  s_nop 0
  s_cbranch_scc1 L_w_g2late
  s_cmp_ge_u32 s90, 160
  s_nop 0
  s_cbranch_scc1 L_w_v
  s_sub_u32 s92, s90, 112
  s_and_b32 s93, s92, 15
  s_lshr_b32 s92, s92, 4
L_w_x:
  s_lshl_b32 s73, s92, 2
  s_sub_u32 s73, s73, 12
  s_max_i32 s73, s73, 1
  s_lshl_b32 s73, s73, 4
  s_cmp_lg_u32 s3, 0
  s_cbranch_scc1 L_fc_xp_j
  s_mov_b32 s77, 49883136
  s_mov_b32 s23, 0
L_fc_xp:
  buffer_load_dword v10, off, s[8:11], s77 sc1
  s_add_u32 s23, s23, 1
  s_cmp_gt_u32 s23, 50000
  s_cbranch_scc1 L_w_fail
  s_waitcnt vmcnt(0)
  v_readfirstlane_b32 s22, v10
  s_nop 0
  s_cmp_ge_u32 s22, s73
  s_cbranch_scc1 L_fc_xp_j
  s_sub_u32 s22, s73, s22
  s_lshr_b32 s22, s22, 4
  s_min_u32 s22, s22, 16
  s_cmp_lt_u32 s22, 2
  s_cbranch_scc1 L_fc_xp_s
  s_sub_u32 s22, s22, 1
L_fc_xp_l:
  s_sleep 44
  s_sub_u32 s22, s22, 1
  s_cmp_lg_u32 s22, 0
  s_cbranch_scc1 L_fc_xp_l
  s_branch L_fc_xp
L_fc_xp_s:
  s_sleep 40
  s_branch L_fc_xp
L_fc_xp_j:
  s_barrier
  s_mov_b32 s20, s93
  s_mov_b32 s24, s92
  v_lshlrev_b32 v1, 4, v0
  v_mov_b32 v2, v1
  s_lshl_b32 s21, s24, 2
  s_add_u32 s21, s21, s3
  s_mul_i32 s21, s21, 28672
  s_add_u32 s21, s21, 0
  s_mul_i32 s22, s3, 28672
  s_add_u32 m0, s22, 0
  s_add_u32 s23, s21, 0
  buffer_load_dwordx4 v1, s[8:11], s23 offen lds
  s_add_u32 m0, s22, 1024
  s_add_u32 s23, s21, 1024
  buffer_load_dwordx4 v1, s[8:11], s23 offen lds
  s_add_u32 m0, s22, 2048
  s_add_u32 s23, s21, 2048
  buffer_load_dwordx4 v1, s[8:11], s23 offen lds
  s_add_u32 m0, s22, 3072
  s_add_u32 s23, s21, 3072
  buffer_load_dwordx4 v1, s[8:11], s23 offen lds
  s_add_u32 m0, s22, 4096
  s_add_u32 s23, s21, 4096
  buffer_load_dwordx4 v1, s[8:11], s23 offen lds
  s_add_u32 m0, s22, 5120
  s_add_u32 s23, s21, 5120
  buffer_load_dwordx4 v1, s[8:11], s23 offen lds
  s_add_u32 m0, s22, 6144
  s_add_u32 s23, s21, 6144
  buffer_load_dwordx4 v1, s[8:11], s23 offen lds
  s_add_u32 m0, s22, 7168
  s_add_u32 s23, s21, 7168
  buffer_load_dwordx4 v1, s[8:11], s23 offen lds
  s_add_u32 m0, s22, 8192
  s_add_u32 s23, s21, 8192
  buffer_load_dwordx4 v1, s[8:11], s23 offen lds
  s_add_u32 m0, s22, 9216
  s_add_u32 s23, s21, 9216
  buffer_load_dwordx4 v1, s[8:11], s23 offen lds
  s_add_u32 m0, s22, 10240
  s_add_u32 s23, s21, 10240
  buffer_load_dwordx4 v1, s[8:11], s23 offen lds
  s_add_u32 m0, s22, 11264
  s_add_u32 s23, s21, 11264
  buffer_load_dwordx4 v1, s[8:11], s23 offen lds
  s_add_u32 m0, s22, 12288
  s_add_u32 s23, s21, 12288
  buffer_load_dwordx4 v1, s[8:11], s23 offen lds
  s_add_u32 m0, s22, 13312
  s_add_u32 s23, s21, 13312
  buffer_load_dwordx4 v1, s[8:11], s23 offen lds
  s_add_u32 m0, s22, 14336
  s_add_u32 s23, s21, 14336
  buffer_load_dwordx4 v1, s[8:11], s23 offen lds
  s_add_u32 m0, s22, 15360
  s_add_u32 s23, s21, 15360
  buffer_load_dwordx4 v1, s[8:11], s23 offen lds
  s_add_u32 m0, s22, 16384
  s_add_u32 s23, s21, 16384
  buffer_load_dwordx4 v1, s[8:11], s23 offen lds
  s_add_u32 m0, s22, 17408
  s_add_u32 s23, s21, 17408
  buffer_load_dwordx4 v1, s[8:11], s23 offen lds
  s_add_u32 m0, s22, 18432
  s_add_u32 s23, s21, 18432
  buffer_load_dwordx4 v1, s[8:11], s23 offen lds
  s_add_u32 m0, s22, 19456
  s_add_u32 s23, s21, 19456
  buffer_load_dwordx4 v1, s[8:11], s23 offen lds
  s_add_u32 m0, s22, 20480
  s_add_u32 s23, s21, 20480
  buffer_load_dwordx4 v1, s[8:11], s23 offen lds
  s_add_u32 m0, s22, 21504
  s_add_u32 s23, s21, 21504
  buffer_load_dwordx4 v1, s[8:11], s23 offen lds
  s_add_u32 m0, s22, 22528
  s_add_u32 s23, s21, 22528
  buffer_load_dwordx4 v1, s[8:11], s23 offen lds
  s_add_u32 m0, s22, 23552
  s_add_u32 s23, s21, 23552
  buffer_load_dwordx4 v1, s[8:11], s23 offen lds
  s_add_u32 m0, s22, 24576
  s_add_u32 s23, s21, 24576
  buffer_load_dwordx4 v1, s[8:11], s23 offen lds
  s_add_u32 m0, s22, 25600
  s_add_u32 s23, s21, 25600
  buffer_load_dwordx4 v1, s[8:11], s23 offen lds
  s_add_u32 m0, s22, 26624
  s_add_u32 s23, s21, 26624
  buffer_load_dwordx4 v1, s[8:11], s23 offen lds
  s_add_u32 m0, s22, 27648
  s_add_u32 s23, s21, 27648
  buffer_load_dwordx4 v1, s[8:11], s23 offen lds
  s_mul_i32 s25, s20, 14
  s_add_u32 s26, s25, s3
  s_mul_i32 s26, s26, 28672
  s_add_u32 s26, s26, 6553600
  s_add_u32 s27, s26, 114688
  s_add_u32 s28, s26, 229376
  s_lshr_b32 s29, s3, 1
  s_add_u32 s29, s29, s25
  s_add_u32 s29, s29, 12
  s_mul_i32 s29, s29, 28672
  s_add_u32 s29, s29, 6553600
  s_and_b32 s30, s3, 1
  s_mul_i32 s30, s30, 57344
  v_add_u32 v3, s30, v1
  v_add_u32 v7, 57344, v1
  v_and_b32 v216, 31, v0
  v_lshrrev_b32 v217, 5, v0
  v_lshlrev_b32 v4, 6, v216
  v_lshl_add_u32 v4, v217, 4, v4
  v_lshlrev_b32 v6, 4, v216
  v_lshl_add_u32 v6, v217, 3, v6
  v_and_b32 v218, 7, v216
  v_lshlrev_b32 v218, 4, v218
  v_lshl_add_u32 v5, v217, 7, v218
  s_lshl_b32 s31, s24, 2
  s_mul_i32 s35, s31, 28672
  s_add_u32 s35, s35, 3670016
  s_mul_i32 s36, s31, 7168
  s_add_u32 s36, s36, 5505024
  v_lshlrev_b32 v218, 2, v217
  v_sub_u32 v218, v216, v218
  v_cmp_gt_i32 s[40:41], 0, v218
  v_cmp_gt_i32 s[42:43], 1, v218
  v_cmp_gt_i32 s[44:45], 2, v218
  v_cmp_gt_i32 s[46:47], 3, v218
  v_cmp_gt_i32 s[48:49], 8, v218
  v_cmp_gt_i32 s[50:51], 9, v218
  v_cmp_gt_i32 s[52:53], 10, v218
  v_cmp_gt_i32 s[54:55], 11, v218
  v_cmp_gt_i32 s[56:57], 16, v218
  v_cmp_gt_i32 s[58:59], 17, v218
  v_cmp_gt_i32 s[60:61], 18, v218
  v_cmp_gt_i32 s[62:63], 19, v218
  v_cmp_gt_i32 s[64:65], 24, v218
  v_cmp_gt_i32 s[66:67], 25, v218
  v_cmp_gt_i32 s[68:69], 26, v218
  v_cmp_gt_i32 s[70:71], 27, v218
  s_add_u32 s23, s26, 0
  buffer_load_dwordx4 a[0:3], v1, s[8:11], s23 offen
  s_add_u32 s23, s26, 1024
  buffer_load_dwordx4 a[4:7], v1, s[8:11], s23 offen
  s_add_u32 s23, s26, 2048
  buffer_load_dwordx4 a[8:11], v1, s[8:11], s23 offen
  s_add_u32 s23, s26, 3072
  buffer_load_dwordx4 a[12:15], v1, s[8:11], s23 offen
  s_add_u32 s23, s26, 4096
  buffer_load_dwordx4 a[16:19], v1, s[8:11], s23 offen
  s_add_u32 s23, s26, 5120
  buffer_load_dwordx4 a[20:23], v1, s[8:11], s23 offen
  s_add_u32 s23, s26, 6144
  buffer_load_dwordx4 a[24:27], v1, s[8:11], s23 offen
  v_accvgpr_write_b32 a64, 0
  v_accvgpr_write_b32 a65, 0
  v_accvgpr_write_b32 a66, 0
  v_accvgpr_write_b32 a67, 0
  v_accvgpr_write_b32 a68, 0
  v_accvgpr_write_b32 a69, 0
  v_accvgpr_write_b32 a70, 0
  v_accvgpr_write_b32 a71, 0
  v_accvgpr_write_b32 a72, 0
  v_accvgpr_write_b32 a73, 0
  v_accvgpr_write_b32 a74, 0
  v_accvgpr_write_b32 a75, 0
  v_accvgpr_write_b32 a76, 0
  v_accvgpr_write_b32 a77, 0
  v_accvgpr_write_b32 a78, 0
  v_accvgpr_write_b32 a79, 0
  v_accvgpr_write_b32 a80, 0
  v_accvgpr_write_b32 a81, 0
  v_accvgpr_write_b32 a82, 0
  v_accvgpr_write_b32 a83, 0
  v_accvgpr_write_b32 a84, 0
  v_accvgpr_write_b32 a85, 0
  v_accvgpr_write_b32 a86, 0
  v_accvgpr_write_b32 a87, 0
  v_accvgpr_write_b32 a88, 0
  v_accvgpr_write_b32 a89, 0
  v_accvgpr_write_b32 a90, 0
  v_accvgpr_write_b32 a91, 0
  v_accvgpr_write_b32 a92, 0
  v_accvgpr_write_b32 a93, 0
  v_accvgpr_write_b32 a94, 0
  v_accvgpr_write_b32 a95, 0
  v_accvgpr_write_b32 a96, 0
  v_accvgpr_write_b32 a97, 0
  v_accvgpr_write_b32 a98, 0
  v_accvgpr_write_b32 a99, 0
  v_accvgpr_write_b32 a100, 0
  v_accvgpr_write_b32 a101, 0
  v_accvgpr_write_b32 a102, 0
  v_accvgpr_write_b32 a103, 0
  v_accvgpr_write_b32 a104, 0
  v_accvgpr_write_b32 a105, 0
  v_accvgpr_write_b32 a106, 0
  v_accvgpr_write_b32 a107, 0
  v_accvgpr_write_b32 a108, 0
  v_accvgpr_write_b32 a109, 0
  v_accvgpr_write_b32 a110, 0
  v_accvgpr_write_b32 a111, 0
  v_accvgpr_write_b32 a112, 0
  v_accvgpr_write_b32 a113, 0
  v_accvgpr_write_b32 a114, 0
  v_accvgpr_write_b32 a115, 0
  v_accvgpr_write_b32 a116, 0
  v_accvgpr_write_b32 a117, 0
  v_accvgpr_write_b32 a118, 0
  v_accvgpr_write_b32 a119, 0
  v_accvgpr_write_b32 a120, 0
  v_accvgpr_write_b32 a121, 0
  v_accvgpr_write_b32 a122, 0
  v_accvgpr_write_b32 a123, 0
  v_accvgpr_write_b32 a124, 0
  v_accvgpr_write_b32 a125, 0
  v_accvgpr_write_b32 a126, 0
  v_accvgpr_write_b32 a127, 0
  s_waitcnt vmcnt(7)
  s_barrier
  s_add_u32 s32, s3, 0
  ds_read_b128 v[8:11], v2 offset:0
  ds_read_b128 v[12:15], v2 offset:28672
  ds_read_b128 v[16:19], v7 offset:0
  ds_read_b128 v[20:23], v7 offset:28672
  ds_read_b128 v[24:27], v2 offset:1024
  ds_read_b128 v[28:31], v2 offset:29696
  ds_read_b128 v[32:35], v7 offset:1024
  ds_read_b128 v[36:39], v7 offset:29696
  s_waitcnt vmcnt(6) lgkmcnt(4)
  v_mfma_f32_32x32x16_bf16 v[40:55], a[0:3], v[8:11], 0
  v_mfma_f32_32x32x16_bf16 v[56:71], a[0:3], v[12:15], 0
  v_mfma_f32_32x32x16_bf16 v[72:87], a[0:3], v[16:19], 0
  v_mfma_f32_32x32x16_bf16 v[88:103], a[0:3], v[20:23], 0
  s_add_u32 s23, s26, 7168
  buffer_load_dwordx4 a[0:3], v1, s[8:11], s23 offen
  ds_read_b128 v[8:11], v2 offset:2048
  ds_read_b128 v[12:15], v2 offset:30720
  ds_read_b128 v[16:19], v7 offset:2048
  ds_read_b128 v[20:23], v7 offset:30720
  s_waitcnt vmcnt(6) lgkmcnt(4)
  v_mfma_f32_32x32x16_bf16 v[40:55], a[4:7], v[24:27], v[40:55]
  v_mfma_f32_32x32x16_bf16 v[56:71], a[4:7], v[28:31], v[56:71]
  v_mfma_f32_32x32x16_bf16 v[72:87], a[4:7], v[32:35], v[72:87]
  v_mfma_f32_32x32x16_bf16 v[88:103], a[4:7], v[36:39], v[88:103]
  s_add_u32 s23, s26, 8192
  buffer_load_dwordx4 a[4:7], v1, s[8:11], s23 offen
  ds_read_b128 v[24:27], v2 offset:3072
  ds_read_b128 v[28:31], v2 offset:31744
  ds_read_b128 v[32:35], v7 offset:3072
  ds_read_b128 v[36:39], v7 offset:31744
  s_waitcnt vmcnt(6) lgkmcnt(4)
  v_mfma_f32_32x32x16_bf16 v[40:55], a[8:11], v[8:11], v[40:55]
  v_mfma_f32_32x32x16_bf16 v[56:71], a[8:11], v[12:15], v[56:71]
  v_mfma_f32_32x32x16_bf16 v[72:87], a[8:11], v[16:19], v[72:87]
  v_mfma_f32_32x32x16_bf16 v[88:103], a[8:11], v[20:23], v[88:103]
  s_add_u32 s23, s26, 9216
  buffer_load_dwordx4 a[8:11], v1, s[8:11], s23 offen
  ds_read_b128 v[8:11], v2 offset:4096
  ds_read_b128 v[12:15], v2 offset:32768
  ds_read_b128 v[16:19], v7 offset:4096
  ds_read_b128 v[20:23], v7 offset:32768
  s_waitcnt vmcnt(6) lgkmcnt(4)
  v_mfma_f32_32x32x16_bf16 v[40:55], a[12:15], v[24:27], v[40:55]
  v_mfma_f32_32x32x16_bf16 v[56:71], a[12:15], v[28:31], v[56:71]
  v_mfma_f32_32x32x16_bf16 v[72:87], a[12:15], v[32:35], v[72:87]
  v_mfma_f32_32x32x16_bf16 v[88:103], a[12:15], v[36:39], v[88:103]
  s_add_u32 s23, s26, 10240
  buffer_load_dwordx4 a[12:15], v1, s[8:11], s23 offen
  ds_read_b128 v[24:27], v2 offset:5120
  ds_read_b128 v[28:31], v2 offset:33792
  ds_read_b128 v[32:35], v7 offset:5120
  ds_read_b128 v[36:39], v7 offset:33792
  s_waitcnt vmcnt(6) lgkmcnt(4)
  v_mfma_f32_32x32x16_bf16 v[40:55], a[16:19], v[8:11], v[40:55]
  v_mfma_f32_32x32x16_bf16 v[56:71], a[16:19], v[12:15], v[56:71]
  v_mfma_f32_32x32x16_bf16 v[72:87], a[16:19], v[16:19], v[72:87]
  v_mfma_f32_32x32x16_bf16 v[88:103], a[16:19], v[20:23], v[88:103]
  s_add_u32 s23, s26, 11264
  buffer_load_dwordx4 a[16:19], v1, s[8:11], s23 offen
  s_lshl_b32 s37, s32, 11
  s_add_u32 s37, s37, s35
  s_add_u32 s39, s37, 0
  buffer_load_dwordx4 a[28:31], v1, s[8:11], s39 offen
  s_add_u32 s39, s37, 1024
  buffer_load_dwordx4 a[32:35], v1, s[8:11], s39 offen
  s_add_u32 s39, s37, 28672
  buffer_load_dwordx4 a[36:39], v1, s[8:11], s39 offen
  s_add_u32 s39, s37, 29696
  buffer_load_dwordx4 a[40:43], v1, s[8:11], s39 offen
  s_add_u32 s39, s37, 57344
  buffer_load_dwordx4 a[44:47], v1, s[8:11], s39 offen
  s_add_u32 s39, s37, 58368
  buffer_load_dwordx4 a[48:51], v1, s[8:11], s39 offen
  s_add_u32 s39, s37, 86016
  buffer_load_dwordx4 a[52:55], v1, s[8:11], s39 offen
  s_add_u32 s39, s37, 87040
  buffer_load_dwordx4 a[56:59], v1, s[8:11], s39 offen
  ds_read_b128 v[8:11], v2 offset:6144
  ds_read_b128 v[12:15], v2 offset:34816
  ds_read_b128 v[16:19], v7 offset:6144
  ds_read_b128 v[20:23], v7 offset:34816
  s_waitcnt vmcnt(14) lgkmcnt(4)
  v_mfma_f32_32x32x16_bf16 v[40:55], a[20:23], v[24:27], v[40:55]
  v_mfma_f32_32x32x16_bf16 v[56:71], a[20:23], v[28:31], v[56:71]
  v_mfma_f32_32x32x16_bf16 v[72:87], a[20:23], v[32:35], v[72:87]
  v_mfma_f32_32x32x16_bf16 v[88:103], a[20:23], v[36:39], v[88:103]
  s_add_u32 s23, s26, 12288
  buffer_load_dwordx4 a[20:23], v1, s[8:11], s23 offen
  ds_read_b128 v[24:27], v2 offset:7168
  ds_read_b128 v[28:31], v2 offset:35840
  ds_read_b128 v[32:35], v7 offset:7168
  ds_read_b128 v[36:39], v7 offset:35840
  s_waitcnt vmcnt(14) lgkmcnt(4)
  v_mfma_f32_32x32x16_bf16 v[40:55], a[24:27], v[8:11], v[40:55]
  v_mfma_f32_32x32x16_bf16 v[56:71], a[24:27], v[12:15], v[56:71]
  v_mfma_f32_32x32x16_bf16 v[72:87], a[24:27], v[16:19], v[72:87]
  v_mfma_f32_32x32x16_bf16 v[88:103], a[24:27], v[20:23], v[88:103]
  s_add_u32 s23, s26, 13312
  buffer_load_dwordx4 a[24:27], v1, s[8:11], s23 offen
  ds_read_b128 v[8:11], v2 offset:8192
  ds_read_b128 v[12:15], v2 offset:36864
  ds_read_b128 v[16:19], v7 offset:8192
  ds_read_b128 v[20:23], v7 offset:36864
  s_waitcnt vmcnt(14) lgkmcnt(4)
  v_mfma_f32_32x32x16_bf16 v[40:55], a[0:3], v[24:27], v[40:55]
  v_mfma_f32_32x32x16_bf16 v[56:71], a[0:3], v[28:31], v[56:71]
  v_mfma_f32_32x32x16_bf16 v[72:87], a[0:3], v[32:35], v[72:87]
  v_mfma_f32_32x32x16_bf16 v[88:103], a[0:3], v[36:39], v[88:103]
  s_add_u32 s23, s26, 14336
  buffer_load_dwordx4 a[0:3], v1, s[8:11], s23 offen
  ds_read_b128 v[24:27], v2 offset:9216
  ds_read_b128 v[28:31], v2 offset:37888
  ds_read_b128 v[32:35], v7 offset:9216
  ds_read_b128 v[36:39], v7 offset:37888
  s_waitcnt vmcnt(14) lgkmcnt(4)
  v_mfma_f32_32x32x16_bf16 v[40:55], a[4:7], v[8:11], v[40:55]
  v_mfma_f32_32x32x16_bf16 v[56:71], a[4:7], v[12:15], v[56:71]
  v_mfma_f32_32x32x16_bf16 v[72:87], a[4:7], v[16:19], v[72:87]
  v_mfma_f32_32x32x16_bf16 v[88:103], a[4:7], v[20:23], v[88:103]
  s_add_u32 s23, s26, 15360
  buffer_load_dwordx4 a[4:7], v1, s[8:11], s23 offen
  ds_read_b128 v[8:11], v2 offset:10240
  ds_read_b128 v[12:15], v2 offset:38912
  ds_read_b128 v[16:19], v7 offset:10240
  ds_read_b128 v[20:23], v7 offset:38912
  s_waitcnt vmcnt(14) lgkmcnt(4)
  v_mfma_f32_32x32x16_bf16 v[40:55], a[8:11], v[24:27], v[40:55]
  v_mfma_f32_32x32x16_bf16 v[56:71], a[8:11], v[28:31], v[56:71]
  v_mfma_f32_32x32x16_bf16 v[72:87], a[8:11], v[32:35], v[72:87]
  v_mfma_f32_32x32x16_bf16 v[88:103], a[8:11], v[36:39], v[88:103]
  s_add_u32 s23, s26, 16384
  buffer_load_dwordx4 a[8:11], v1, s[8:11], s23 offen
  ds_read_b128 v[24:27], v2 offset:11264
  ds_read_b128 v[28:31], v2 offset:39936
  ds_read_b128 v[32:35], v7 offset:11264
  ds_read_b128 v[36:39], v7 offset:39936
  s_waitcnt vmcnt(14) lgkmcnt(4)
  v_mfma_f32_32x32x16_bf16 v[40:55], a[12:15], v[8:11], v[40:55]
  v_mfma_f32_32x32x16_bf16 v[56:71], a[12:15], v[12:15], v[56:71]
  v_mfma_f32_32x32x16_bf16 v[72:87], a[12:15], v[16:19], v[72:87]
  v_mfma_f32_32x32x16_bf16 v[88:103], a[12:15], v[20:23], v[88:103]
  s_add_u32 s23, s26, 17408
  buffer_load_dwordx4 a[12:15], v1, s[8:11], s23 offen
  ds_read_b128 v[8:11], v2 offset:12288
  ds_read_b128 v[12:15], v2 offset:40960
  ds_read_b128 v[16:19], v7 offset:12288
  ds_read_b128 v[20:23], v7 offset:40960
  s_waitcnt vmcnt(14) lgkmcnt(4)
  v_mfma_f32_32x32x16_bf16 v[40:55], a[16:19], v[24:27], v[40:55]
  v_mfma_f32_32x32x16_bf16 v[56:71], a[16:19], v[28:31], v[56:71]
  v_mfma_f32_32x32x16_bf16 v[72:87], a[16:19], v[32:35], v[72:87]
  v_mfma_f32_32x32x16_bf16 v[88:103], a[16:19], v[36:39], v[88:103]
  s_add_u32 s23, s26, 18432
  buffer_load_dwordx4 a[16:19], v1, s[8:11], s23 offen
  ds_read_b128 v[24:27], v2 offset:13312
  ds_read_b128 v[28:31], v2 offset:41984
  ds_read_b128 v[32:35], v7 offset:13312
  ds_read_b128 v[36:39], v7 offset:41984
  s_waitcnt vmcnt(6) lgkmcnt(4)
  v_mfma_f32_32x32x16_bf16 v[40:55], a[20:23], v[8:11], v[40:55]
  v_mfma_f32_32x32x16_bf16 v[56:71], a[20:23], v[12:15], v[56:71]
  v_mfma_f32_32x32x16_bf16 v[72:87], a[20:23], v[16:19], v[72:87]
  v_mfma_f32_32x32x16_bf16 v[88:103], a[20:23], v[20:23], v[88:103]
  s_add_u32 s23, s26, 19456
  buffer_load_dwordx4 a[20:23], v1, s[8:11], s23 offen
  ds_read_b128 v[8:11], v2 offset:14336
  ds_read_b128 v[12:15], v2 offset:43008
  ds_read_b128 v[16:19], v7 offset:14336
  ds_read_b128 v[20:23], v7 offset:43008
  s_waitcnt vmcnt(6) lgkmcnt(4)
  v_mfma_f32_32x32x16_bf16 v[40:55], a[24:27], v[24:27], v[40:55]
  v_mfma_f32_32x32x16_bf16 v[56:71], a[24:27], v[28:31], v[56:71]
  v_mfma_f32_32x32x16_bf16 v[72:87], a[24:27], v[32:35], v[72:87]
  v_mfma_f32_32x32x16_bf16 v[88:103], a[24:27], v[36:39], v[88:103]
  s_add_u32 s23, s26, 20480
  buffer_load_dwordx4 a[24:27], v1, s[8:11], s23 offen
  ds_read_b128 v[24:27], v2 offset:15360
  ds_read_b128 v[28:31], v2 offset:44032
  ds_read_b128 v[32:35], v7 offset:15360
  ds_read_b128 v[36:39], v7 offset:44032
  s_waitcnt vmcnt(6) lgkmcnt(4)
  v_mfma_f32_32x32x16_bf16 v[40:55], a[0:3], v[8:11], v[40:55]
  v_mfma_f32_32x32x16_bf16 v[56:71], a[0:3], v[12:15], v[56:71]
  v_mfma_f32_32x32x16_bf16 v[72:87], a[0:3], v[16:19], v[72:87]
  v_mfma_f32_32x32x16_bf16 v[88:103], a[0:3], v[20:23], v[88:103]
  s_add_u32 s23, s26, 21504
  buffer_load_dwordx4 a[0:3], v1, s[8:11], s23 offen
  ds_read_b128 v[8:11], v2 offset:16384
  ds_read_b128 v[12:15], v2 offset:45056
  ds_read_b128 v[16:19], v7 offset:16384
  ds_read_b128 v[20:23], v7 offset:45056
  s_waitcnt vmcnt(6) lgkmcnt(4)
  v_mfma_f32_32x32x16_bf16 v[40:55], a[4:7], v[24:27], v[40:55]
  v_mfma_f32_32x32x16_bf16 v[56:71], a[4:7], v[28:31], v[56:71]
  v_mfma_f32_32x32x16_bf16 v[72:87], a[4:7], v[32:35], v[72:87]
  v_mfma_f32_32x32x16_bf16 v[88:103], a[4:7], v[36:39], v[88:103]
  s_add_u32 s23, s26, 22528
  buffer_load_dwordx4 a[4:7], v1, s[8:11], s23 offen
  ds_read_b128 v[24:27], v2 offset:17408
  ds_read_b128 v[28:31], v2 offset:46080
  ds_read_b128 v[32:35], v7 offset:17408
  ds_read_b128 v[36:39], v7 offset:46080
  s_waitcnt vmcnt(6) lgkmcnt(4)
  v_mfma_f32_32x32x16_bf16 v[40:55], a[8:11], v[8:11], v[40:55]
  v_mfma_f32_32x32x16_bf16 v[56:71], a[8:11], v[12:15], v[56:71]
  v_mfma_f32_32x32x16_bf16 v[72:87], a[8:11], v[16:19], v[72:87]
  v_mfma_f32_32x32x16_bf16 v[88:103], a[8:11], v[20:23], v[88:103]
  s_add_u32 s23, s26, 23552
  buffer_load_dwordx4 a[8:11], v1, s[8:11], s23 offen
  ds_read_b128 v[8:11], v2 offset:18432
  ds_read_b128 v[12:15], v2 offset:47104
  ds_read_b128 v[16:19], v7 offset:18432
  ds_read_b128 v[20:23], v7 offset:47104
  s_waitcnt vmcnt(6) lgkmcnt(4)
  v_mfma_f32_32x32x16_bf16 v[40:55], a[12:15], v[24:27], v[40:55]
  v_mfma_f32_32x32x16_bf16 v[56:71], a[12:15], v[28:31], v[56:71]
  v_mfma_f32_32x32x16_bf16 v[72:87], a[12:15], v[32:35], v[72:87]
  v_mfma_f32_32x32x16_bf16 v[88:103], a[12:15], v[36:39], v[88:103]
  s_add_u32 s23, s26, 24576
  buffer_load_dwordx4 a[12:15], v1, s[8:11], s23 offen
  ds_read_b128 v[24:27], v2 offset:19456
  ds_read_b128 v[28:31], v2 offset:48128
  ds_read_b128 v[32:35], v7 offset:19456
  ds_read_b128 v[36:39], v7 offset:48128
  s_waitcnt vmcnt(6) lgkmcnt(4)
  v_mfma_f32_32x32x16_bf16 v[40:55], a[16:19], v[8:11], v[40:55]
  v_mfma_f32_32x32x16_bf16 v[56:71], a[16:19], v[12:15], v[56:71]
  v_mfma_f32_32x32x16_bf16 v[72:87], a[16:19], v[16:19], v[72:87]
  v_mfma_f32_32x32x16_bf16 v[88:103], a[16:19], v[20:23], v[88:103]
  s_add_u32 s23, s26, 25600
  buffer_load_dwordx4 a[16:19], v1, s[8:11], s23 offen
  ds_read_b128 v[8:11], v2 offset:20480
  ds_read_b128 v[12:15], v2 offset:49152
  ds_read_b128 v[16:19], v7 offset:20480
  ds_read_b128 v[20:23], v7 offset:49152
  s_waitcnt vmcnt(6) lgkmcnt(4)
  v_mfma_f32_32x32x16_bf16 v[40:55], a[20:23], v[24:27], v[40:55]
  v_mfma_f32_32x32x16_bf16 v[56:71], a[20:23], v[28:31], v[56:71]
  v_mfma_f32_32x32x16_bf16 v[72:87], a[20:23], v[32:35], v[72:87]
  v_mfma_f32_32x32x16_bf16 v[88:103], a[20:23], v[36:39], v[88:103]
  s_add_u32 s23, s26, 26624
  buffer_load_dwordx4 a[20:23], v1, s[8:11], s23 offen
  ds_read_b128 v[24:27], v2 offset:21504
  ds_read_b128 v[28:31], v2 offset:50176
  ds_read_b128 v[32:35], v7 offset:21504
  ds_read_b128 v[36:39], v7 offset:50176
  s_waitcnt vmcnt(6) lgkmcnt(4)
  v_mfma_f32_32x32x16_bf16 v[40:55], a[24:27], v[8:11], v[40:55]
  v_mfma_f32_32x32x16_bf16 v[56:71], a[24:27], v[12:15], v[56:71]
  v_mfma_f32_32x32x16_bf16 v[72:87], a[24:27], v[16:19], v[72:87]
  v_mfma_f32_32x32x16_bf16 v[88:103], a[24:27], v[20:23], v[88:103]
  s_add_u32 s23, s26, 27648
  buffer_load_dwordx4 a[24:27], v1, s[8:11], s23 offen
  ds_read_b128 v[8:11], v2 offset:22528
  ds_read_b128 v[12:15], v2 offset:51200
  ds_read_b128 v[16:19], v7 offset:22528
  ds_read_b128 v[20:23], v7 offset:51200
  s_waitcnt vmcnt(6) lgkmcnt(4)
  v_mfma_f32_32x32x16_bf16 v[40:55], a[0:3], v[24:27], v[40:55]
  v_mfma_f32_32x32x16_bf16 v[56:71], a[0:3], v[28:31], v[56:71]
  v_mfma_f32_32x32x16_bf16 v[72:87], a[0:3], v[32:35], v[72:87]
  v_mfma_f32_32x32x16_bf16 v[88:103], a[0:3], v[36:39], v[88:103]
  s_add_u32 s23, s27, 0
  buffer_load_dwordx4 a[0:3], v1, s[8:11], s23 offen
  ds_read_b128 v[24:27], v2 offset:23552
  ds_read_b128 v[28:31], v2 offset:52224
  ds_read_b128 v[32:35], v7 offset:23552
  ds_read_b128 v[36:39], v7 offset:52224
  s_waitcnt vmcnt(6) lgkmcnt(4)
  v_mfma_f32_32x32x16_bf16 v[40:55], a[4:7], v[8:11], v[40:55]
  v_mfma_f32_32x32x16_bf16 v[56:71], a[4:7], v[12:15], v[56:71]
  v_mfma_f32_32x32x16_bf16 v[72:87], a[4:7], v[16:19], v[72:87]
  v_mfma_f32_32x32x16_bf16 v[88:103], a[4:7], v[20:23], v[88:103]
  s_add_u32 s23, s27, 1024
  buffer_load_dwordx4 a[4:7], v1, s[8:11], s23 offen
  ds_read_b128 v[8:11], v2 offset:24576
  ds_read_b128 v[12:15], v2 offset:53248
  ds_read_b128 v[16:19], v7 offset:24576
  ds_read_b128 v[20:23], v7 offset:53248
  s_waitcnt vmcnt(6) lgkmcnt(4)
  v_mfma_f32_32x32x16_bf16 v[40:55], a[8:11], v[24:27], v[40:55]
  v_mfma_f32_32x32x16_bf16 v[56:71], a[8:11], v[28:31], v[56:71]
  v_mfma_f32_32x32x16_bf16 v[72:87], a[8:11], v[32:35], v[72:87]
  v_mfma_f32_32x32x16_bf16 v[88:103], a[8:11], v[36:39], v[88:103]
  s_add_u32 s23, s27, 2048
  buffer_load_dwordx4 a[8:11], v1, s[8:11], s23 offen
  ds_read_b128 v[24:27], v2 offset:25600
  ds_read_b128 v[28:31], v2 offset:54272
  ds_read_b128 v[32:35], v7 offset:25600
  ds_read_b128 v[36:39], v7 offset:54272
  s_waitcnt vmcnt(6) lgkmcnt(4)
  v_mfma_f32_32x32x16_bf16 v[40:55], a[12:15], v[8:11], v[40:55]
  v_mfma_f32_32x32x16_bf16 v[56:71], a[12:15], v[12:15], v[56:71]
  v_mfma_f32_32x32x16_bf16 v[72:87], a[12:15], v[16:19], v[72:87]
  v_mfma_f32_32x32x16_bf16 v[88:103], a[12:15], v[20:23], v[88:103]
  s_add_u32 s23, s27, 3072
  buffer_load_dwordx4 a[12:15], v1, s[8:11], s23 offen
  ds_read_b128 v[8:11], v2 offset:26624
  ds_read_b128 v[12:15], v2 offset:55296
  ds_read_b128 v[16:19], v7 offset:26624
  ds_read_b128 v[20:23], v7 offset:55296
  s_waitcnt vmcnt(6) lgkmcnt(4)
  v_mfma_f32_32x32x16_bf16 v[40:55], a[16:19], v[24:27], v[40:55]
  v_mfma_f32_32x32x16_bf16 v[56:71], a[16:19], v[28:31], v[56:71]
  v_mfma_f32_32x32x16_bf16 v[72:87], a[16:19], v[32:35], v[72:87]
  v_mfma_f32_32x32x16_bf16 v[88:103], a[16:19], v[36:39], v[88:103]
  s_add_u32 s23, s27, 4096
  buffer_load_dwordx4 a[16:19], v1, s[8:11], s23 offen
  ds_read_b128 v[24:27], v2 offset:27648
  ds_read_b128 v[28:31], v2 offset:56320
  ds_read_b128 v[32:35], v7 offset:27648
  ds_read_b128 v[36:39], v7 offset:56320
  s_waitcnt vmcnt(6) lgkmcnt(4)
  v_mfma_f32_32x32x16_bf16 v[40:55], a[20:23], v[8:11], v[40:55]
  v_mfma_f32_32x32x16_bf16 v[56:71], a[20:23], v[12:15], v[56:71]
  v_mfma_f32_32x32x16_bf16 v[72:87], a[20:23], v[16:19], v[72:87]
  v_mfma_f32_32x32x16_bf16 v[88:103], a[20:23], v[20:23], v[88:103]
  s_add_u32 s23, s27, 5120
  buffer_load_dwordx4 a[20:23], v1, s[8:11], s23 offen
  s_waitcnt vmcnt(6) lgkmcnt(0)
  v_mfma_f32_32x32x16_bf16 v[40:55], a[24:27], v[24:27], v[40:55]
  v_mfma_f32_32x32x16_bf16 v[56:71], a[24:27], v[28:31], v[56:71]
  v_mfma_f32_32x32x16_bf16 v[72:87], a[24:27], v[32:35], v[72:87]
  v_mfma_f32_32x32x16_bf16 v[88:103], a[24:27], v[36:39], v[88:103]
  s_add_u32 s23, s27, 6144
  buffer_load_dwordx4 a[24:27], v1, s[8:11], s23 offen
  s_nop 6
  v_cvt_pk_bf16_f32 v104, v40, v41
  v_cvt_pk_bf16_f32 v105, v42, v43
  v_cvt_pk_bf16_f32 v106, v44, v45
  v_cvt_pk_bf16_f32 v107, v46, v47
  v_cvt_pk_bf16_f32 v108, v48, v49
  v_cvt_pk_bf16_f32 v109, v50, v51
  v_cvt_pk_bf16_f32 v110, v52, v53
  v_cvt_pk_bf16_f32 v111, v54, v55
  v_cvt_pk_bf16_f32 v112, v56, v57
  v_cvt_pk_bf16_f32 v113, v58, v59
  v_cvt_pk_bf16_f32 v114, v60, v61
  v_cvt_pk_bf16_f32 v115, v62, v63
  v_cvt_pk_bf16_f32 v116, v64, v65
  v_cvt_pk_bf16_f32 v117, v66, v67
  v_cvt_pk_bf16_f32 v118, v68, v69
  v_cvt_pk_bf16_f32 v119, v70, v71
  v_cvt_pk_bf16_f32 v120, v72, v73
  v_cvt_pk_bf16_f32 v121, v74, v75
  v_cvt_pk_bf16_f32 v122, v76, v77
  v_cvt_pk_bf16_f32 v123, v78, v79
  v_cvt_pk_bf16_f32 v124, v80, v81
  v_cvt_pk_bf16_f32 v125, v82, v83
  v_cvt_pk_bf16_f32 v126, v84, v85
  v_cvt_pk_bf16_f32 v127, v86, v87
  v_cvt_pk_bf16_f32 v128, v88, v89
  v_cvt_pk_bf16_f32 v129, v90, v91
  v_cvt_pk_bf16_f32 v130, v92, v93
  v_cvt_pk_bf16_f32 v131, v94, v95
  v_cvt_pk_bf16_f32 v132, v96, v97
  v_cvt_pk_bf16_f32 v133, v98, v99
  v_cvt_pk_bf16_f32 v134, v100, v101
  v_cvt_pk_bf16_f32 v135, v102, v103
  s_waitcnt vmcnt(7)
  v_mfma_f32_32x32x16_bf16 a[64:79], a[28:31], v[104:107], a[64:79]
  v_mfma_f32_32x32x16_bf16 a[64:79], a[32:35], v[108:111], a[64:79]
  v_mfma_f32_32x32x16_bf16 a[80:95], a[36:39], v[112:115], a[80:95]
  v_mfma_f32_32x32x16_bf16 a[80:95], a[40:43], v[116:119], a[80:95]
  v_mfma_f32_32x32x16_bf16 a[96:111], a[44:47], v[120:123], a[96:111]
  v_mfma_f32_32x32x16_bf16 a[96:111], a[48:51], v[124:127], a[96:111]
  v_mfma_f32_32x32x16_bf16 a[112:127], a[52:55], v[128:131], a[112:127]
  v_mfma_f32_32x32x16_bf16 a[112:127], a[56:59], v[132:135], a[112:127]
  s_add_u32 s32, s3, 4
  ds_read_b128 v[8:11], v2 offset:0
  ds_read_b128 v[12:15], v2 offset:28672
  ds_read_b128 v[16:19], v7 offset:0
  ds_read_b128 v[20:23], v7 offset:28672
  ds_read_b128 v[24:27], v2 offset:1024
  ds_read_b128 v[28:31], v2 offset:29696
  ds_read_b128 v[32:35], v7 offset:1024
  ds_read_b128 v[36:39], v7 offset:29696
  s_waitcnt vmcnt(6) lgkmcnt(4)
  v_mfma_f32_32x32x16_bf16 v[40:55], a[0:3], v[8:11], 0
  v_mfma_f32_32x32x16_bf16 v[56:71], a[0:3], v[12:15], 0
  v_mfma_f32_32x32x16_bf16 v[72:87], a[0:3], v[16:19], 0
  v_mfma_f32_32x32x16_bf16 v[88:103], a[0:3], v[20:23], 0
  s_add_u32 s23, s27, 7168
  buffer_load_dwordx4 a[0:3], v1, s[8:11], s23 offen
  ds_read_b128 v[8:11], v2 offset:2048
  ds_read_b128 v[12:15], v2 offset:30720
  ds_read_b128 v[16:19], v7 offset:2048
  ds_read_b128 v[20:23], v7 offset:30720
  s_waitcnt vmcnt(6) lgkmcnt(4)
  v_mfma_f32_32x32x16_bf16 v[40:55], a[4:7], v[24:27], v[40:55]
  v_mfma_f32_32x32x16_bf16 v[56:71], a[4:7], v[28:31], v[56:71]
  v_mfma_f32_32x32x16_bf16 v[72:87], a[4:7], v[32:35], v[72:87]
  v_mfma_f32_32x32x16_bf16 v[88:103], a[4:7], v[36:39], v[88:103]
  s_add_u32 s23, s27, 8192
  buffer_load_dwordx4 a[4:7], v1, s[8:11], s23 offen
  ds_read_b128 v[24:27], v2 offset:3072
  ds_read_b128 v[28:31], v2 offset:31744
  ds_read_b128 v[32:35], v7 offset:3072
  ds_read_b128 v[36:39], v7 offset:31744
  s_waitcnt vmcnt(6) lgkmcnt(4)
  v_mfma_f32_32x32x16_bf16 v[40:55], a[8:11], v[8:11], v[40:55]
  v_mfma_f32_32x32x16_bf16 v[56:71], a[8:11], v[12:15], v[56:71]
  v_mfma_f32_32x32x16_bf16 v[72:87], a[8:11], v[16:19], v[72:87]
  v_mfma_f32_32x32x16_bf16 v[88:103], a[8:11], v[20:23], v[88:103]
  s_add_u32 s23, s27, 9216
  buffer_load_dwordx4 a[8:11], v1, s[8:11], s23 offen
  ds_read_b128 v[8:11], v2 offset:4096
  ds_read_b128 v[12:15], v2 offset:32768
  ds_read_b128 v[16:19], v7 offset:4096
  ds_read_b128 v[20:23], v7 offset:32768
  s_waitcnt vmcnt(6) lgkmcnt(4)
  v_mfma_f32_32x32x16_bf16 v[40:55], a[12:15], v[24:27], v[40:55]
  v_mfma_f32_32x32x16_bf16 v[56:71], a[12:15], v[28:31], v[56:71]
  v_mfma_f32_32x32x16_bf16 v[72:87], a[12:15], v[32:35], v[72:87]
  v_mfma_f32_32x32x16_bf16 v[88:103], a[12:15], v[36:39], v[88:103]
  s_add_u32 s23, s27, 10240
  buffer_load_dwordx4 a[12:15], v1, s[8:11], s23 offen
  ds_read_b128 v[24:27], v2 offset:5120
  ds_read_b128 v[28:31], v2 offset:33792
  ds_read_b128 v[32:35], v7 offset:5120
  ds_read_b128 v[36:39], v7 offset:33792
  s_waitcnt vmcnt(6) lgkmcnt(4)
  v_mfma_f32_32x32x16_bf16 v[40:55], a[16:19], v[8:11], v[40:55]
  v_mfma_f32_32x32x16_bf16 v[56:71], a[16:19], v[12:15], v[56:71]
  v_mfma_f32_32x32x16_bf16 v[72:87], a[16:19], v[16:19], v[72:87]
  v_mfma_f32_32x32x16_bf16 v[88:103], a[16:19], v[20:23], v[88:103]
  s_add_u32 s23, s27, 11264
  buffer_load_dwordx4 a[16:19], v1, s[8:11], s23 offen
  s_lshl_b32 s37, s32, 11
  s_add_u32 s37, s37, s35
  s_add_u32 s39, s37, 0
  buffer_load_dwordx4 a[28:31], v1, s[8:11], s39 offen
  s_add_u32 s39, s37, 1024
  buffer_load_dwordx4 a[32:35], v1, s[8:11], s39 offen
  s_add_u32 s39, s37, 28672
  buffer_load_dwordx4 a[36:39], v1, s[8:11], s39 offen
  s_add_u32 s39, s37, 29696
  buffer_load_dwordx4 a[40:43], v1, s[8:11], s39 offen
  s_add_u32 s39, s37, 57344
  buffer_load_dwordx4 a[44:47], v1, s[8:11], s39 offen
  s_add_u32 s39, s37, 58368
  buffer_load_dwordx4 a[48:51], v1, s[8:11], s39 offen
  s_add_u32 s39, s37, 86016
  buffer_load_dwordx4 a[52:55], v1, s[8:11], s39 offen
  s_add_u32 s39, s37, 87040
  buffer_load_dwordx4 a[56:59], v1, s[8:11], s39 offen
  ds_read_b128 v[8:11], v2 offset:6144
  ds_read_b128 v[12:15], v2 offset:34816
  ds_read_b128 v[16:19], v7 offset:6144
  ds_read_b128 v[20:23], v7 offset:34816
  s_waitcnt vmcnt(14) lgkmcnt(4)
  v_mfma_f32_32x32x16_bf16 v[40:55], a[20:23], v[24:27], v[40:55]
  v_mfma_f32_32x32x16_bf16 v[56:71], a[20:23], v[28:31], v[56:71]
  v_mfma_f32_32x32x16_bf16 v[72:87], a[20:23], v[32:35], v[72:87]
  v_mfma_f32_32x32x16_bf16 v[88:103], a[20:23], v[36:39], v[88:103]
  s_add_u32 s23, s27, 12288
  buffer_load_dwordx4 a[20:23], v1, s[8:11], s23 offen
  ds_read_b128 v[24:27], v2 offset:7168
  ds_read_b128 v[28:31], v2 offset:35840
  ds_read_b128 v[32:35], v7 offset:7168
  ds_read_b128 v[36:39], v7 offset:35840
  s_waitcnt vmcnt(14) lgkmcnt(4)
  v_mfma_f32_32x32x16_bf16 v[40:55], a[24:27], v[8:11], v[40:55]
  v_mfma_f32_32x32x16_bf16 v[56:71], a[24:27], v[12:15], v[56:71]
  v_mfma_f32_32x32x16_bf16 v[72:87], a[24:27], v[16:19], v[72:87]
  v_mfma_f32_32x32x16_bf16 v[88:103], a[24:27], v[20:23], v[88:103]
  s_add_u32 s23, s27, 13312
  buffer_load_dwordx4 a[24:27], v1, s[8:11], s23 offen
  ds_read_b128 v[8:11], v2 offset:8192
  ds_read_b128 v[12:15], v2 offset:36864
  ds_read_b128 v[16:19], v7 offset:8192
  ds_read_b128 v[20:23], v7 offset:36864
  s_waitcnt vmcnt(14) lgkmcnt(4)
  v_mfma_f32_32x32x16_bf16 v[40:55], a[0:3], v[24:27], v[40:55]
  v_mfma_f32_32x32x16_bf16 v[56:71], a[0:3], v[28:31], v[56:71]
  v_mfma_f32_32x32x16_bf16 v[72:87], a[0:3], v[32:35], v[72:87]
  v_mfma_f32_32x32x16_bf16 v[88:103], a[0:3], v[36:39], v[88:103]
  s_add_u32 s23, s27, 14336
  buffer_load_dwordx4 a[0:3], v1, s[8:11], s23 offen
  ds_read_b128 v[24:27], v2 offset:9216
  ds_read_b128 v[28:31], v2 offset:37888
  ds_read_b128 v[32:35], v7 offset:9216
  ds_read_b128 v[36:39], v7 offset:37888
  s_waitcnt vmcnt(14) lgkmcnt(4)
  v_mfma_f32_32x32x16_bf16 v[40:55], a[4:7], v[8:11], v[40:55]
  v_mfma_f32_32x32x16_bf16 v[56:71], a[4:7], v[12:15], v[56:71]
  v_mfma_f32_32x32x16_bf16 v[72:87], a[4:7], v[16:19], v[72:87]
  v_mfma_f32_32x32x16_bf16 v[88:103], a[4:7], v[20:23], v[88:103]
  s_add_u32 s23, s27, 15360
  buffer_load_dwordx4 a[4:7], v1, s[8:11], s23 offen
  ds_read_b128 v[8:11], v2 offset:10240
  ds_read_b128 v[12:15], v2 offset:38912
  ds_read_b128 v[16:19], v7 offset:10240
  ds_read_b128 v[20:23], v7 offset:38912
  s_waitcnt vmcnt(14) lgkmcnt(4)
  v_mfma_f32_32x32x16_bf16 v[40:55], a[8:11], v[24:27], v[40:55]
  v_mfma_f32_32x32x16_bf16 v[56:71], a[8:11], v[28:31], v[56:71]
  v_mfma_f32_32x32x16_bf16 v[72:87], a[8:11], v[32:35], v[72:87]
  v_mfma_f32_32x32x16_bf16 v[88:103], a[8:11], v[36:39], v[88:103]
  s_add_u32 s23, s27, 16384
  buffer_load_dwordx4 a[8:11], v1, s[8:11], s23 offen
  ds_read_b128 v[24:27], v2 offset:11264
  ds_read_b128 v[28:31], v2 offset:39936
  ds_read_b128 v[32:35], v7 offset:11264
  ds_read_b128 v[36:39], v7 offset:39936
  s_waitcnt vmcnt(14) lgkmcnt(4)
  v_mfma_f32_32x32x16_bf16 v[40:55], a[12:15], v[8:11], v[40:55]
  v_mfma_f32_32x32x16_bf16 v[56:71], a[12:15], v[12:15], v[56:71]
  v_mfma_f32_32x32x16_bf16 v[72:87], a[12:15], v[16:19], v[72:87]
  v_mfma_f32_32x32x16_bf16 v[88:103], a[12:15], v[20:23], v[88:103]
  s_add_u32 s23, s27, 17408
  buffer_load_dwordx4 a[12:15], v1, s[8:11], s23 offen
  ds_read_b128 v[8:11], v2 offset:12288
  ds_read_b128 v[12:15], v2 offset:40960
  ds_read_b128 v[16:19], v7 offset:12288
  ds_read_b128 v[20:23], v7 offset:40960
  s_waitcnt vmcnt(14) lgkmcnt(4)
  v_mfma_f32_32x32x16_bf16 v[40:55], a[16:19], v[24:27], v[40:55]
  v_mfma_f32_32x32x16_bf16 v[56:71], a[16:19], v[28:31], v[56:71]
  v_mfma_f32_32x32x16_bf16 v[72:87], a[16:19], v[32:35], v[72:87]
  v_mfma_f32_32x32x16_bf16 v[88:103], a[16:19], v[36:39], v[88:103]
  s_add_u32 s23, s27, 18432
  buffer_load_dwordx4 a[16:19], v1, s[8:11], s23 offen
  ds_read_b128 v[24:27], v2 offset:13312
  ds_read_b128 v[28:31], v2 offset:41984
  ds_read_b128 v[32:35], v7 offset:13312
  ds_read_b128 v[36:39], v7 offset:41984
  s_waitcnt vmcnt(6) lgkmcnt(4)
  v_mfma_f32_32x32x16_bf16 v[40:55], a[20:23], v[8:11], v[40:55]
  v_mfma_f32_32x32x16_bf16 v[56:71], a[20:23], v[12:15], v[56:71]
  v_mfma_f32_32x32x16_bf16 v[72:87], a[20:23], v[16:19], v[72:87]
  v_mfma_f32_32x32x16_bf16 v[88:103], a[20:23], v[20:23], v[88:103]
  s_add_u32 s23, s27, 19456
  buffer_load_dwordx4 a[20:23], v1, s[8:11], s23 offen
  ds_read_b128 v[8:11], v2 offset:14336
  ds_read_b128 v[12:15], v2 offset:43008
  ds_read_b128 v[16:19], v7 offset:14336
  ds_read_b128 v[20:23], v7 offset:43008
  s_waitcnt vmcnt(6) lgkmcnt(4)
  v_mfma_f32_32x32x16_bf16 v[40:55], a[24:27], v[24:27], v[40:55]
  v_mfma_f32_32x32x16_bf16 v[56:71], a[24:27], v[28:31], v[56:71]
  v_mfma_f32_32x32x16_bf16 v[72:87], a[24:27], v[32:35], v[72:87]
  v_mfma_f32_32x32x16_bf16 v[88:103], a[24:27], v[36:39], v[88:103]
  s_add_u32 s23, s27, 20480
  buffer_load_dwordx4 a[24:27], v1, s[8:11], s23 offen
  ds_read_b128 v[24:27], v2 offset:15360
  ds_read_b128 v[28:31], v2 offset:44032
  ds_read_b128 v[32:35], v7 offset:15360
  ds_read_b128 v[36:39], v7 offset:44032
  s_waitcnt vmcnt(6) lgkmcnt(4)
  v_mfma_f32_32x32x16_bf16 v[40:55], a[0:3], v[8:11], v[40:55]
  v_mfma_f32_32x32x16_bf16 v[56:71], a[0:3], v[12:15], v[56:71]
  v_mfma_f32_32x32x16_bf16 v[72:87], a[0:3], v[16:19], v[72:87]
  v_mfma_f32_32x32x16_bf16 v[88:103], a[0:3], v[20:23], v[88:103]
  s_add_u32 s23, s27, 21504
  buffer_load_dwordx4 a[0:3], v1, s[8:11], s23 offen
  ds_read_b128 v[8:11], v2 offset:16384
  ds_read_b128 v[12:15], v2 offset:45056
  ds_read_b128 v[16:19], v7 offset:16384
  ds_read_b128 v[20:23], v7 offset:45056
  s_waitcnt vmcnt(6) lgkmcnt(4)
  v_mfma_f32_32x32x16_bf16 v[40:55], a[4:7], v[24:27], v[40:55]
  v_mfma_f32_32x32x16_bf16 v[56:71], a[4:7], v[28:31], v[56:71]
  v_mfma_f32_32x32x16_bf16 v[72:87], a[4:7], v[32:35], v[72:87]
  v_mfma_f32_32x32x16_bf16 v[88:103], a[4:7], v[36:39], v[88:103]
  s_add_u32 s23, s27, 22528
  buffer_load_dwordx4 a[4:7], v1, s[8:11], s23 offen
  ds_read_b128 v[24:27], v2 offset:17408
  ds_read_b128 v[28:31], v2 offset:46080
  ds_read_b128 v[32:35], v7 offset:17408
  ds_read_b128 v[36:39], v7 offset:46080
  s_waitcnt vmcnt(6) lgkmcnt(4)
  v_mfma_f32_32x32x16_bf16 v[40:55], a[8:11], v[8:11], v[40:55]
  v_mfma_f32_32x32x16_bf16 v[56:71], a[8:11], v[12:15], v[56:71]
  v_mfma_f32_32x32x16_bf16 v[72:87], a[8:11], v[16:19], v[72:87]
  v_mfma_f32_32x32x16_bf16 v[88:103], a[8:11], v[20:23], v[88:103]
  s_add_u32 s23, s27, 23552
  buffer_load_dwordx4 a[8:11], v1, s[8:11], s23 offen
  ds_read_b128 v[8:11], v2 offset:18432
  ds_read_b128 v[12:15], v2 offset:47104
  ds_read_b128 v[16:19], v7 offset:18432
  ds_read_b128 v[20:23], v7 offset:47104
  s_waitcnt vmcnt(6) lgkmcnt(4)
  v_mfma_f32_32x32x16_bf16 v[40:55], a[12:15], v[24:27], v[40:55]
  v_mfma_f32_32x32x16_bf16 v[56:71], a[12:15], v[28:31], v[56:71]
  v_mfma_f32_32x32x16_bf16 v[72:87], a[12:15], v[32:35], v[72:87]
  v_mfma_f32_32x32x16_bf16 v[88:103], a[12:15], v[36:39], v[88:103]
  s_add_u32 s23, s27, 24576
  buffer_load_dwordx4 a[12:15], v1, s[8:11], s23 offen
  ds_read_b128 v[24:27], v2 offset:19456
  ds_read_b128 v[28:31], v2 offset:48128
  ds_read_b128 v[32:35], v7 offset:19456
  ds_read_b128 v[36:39], v7 offset:48128
  s_waitcnt vmcnt(6) lgkmcnt(4)
  v_mfma_f32_32x32x16_bf16 v[40:55], a[16:19], v[8:11], v[40:55]
  v_mfma_f32_32x32x16_bf16 v[56:71], a[16:19], v[12:15], v[56:71]
  v_mfma_f32_32x32x16_bf16 v[72:87], a[16:19], v[16:19], v[72:87]
  v_mfma_f32_32x32x16_bf16 v[88:103], a[16:19], v[20:23], v[88:103]
  s_add_u32 s23, s27, 25600
  buffer_load_dwordx4 a[16:19], v1, s[8:11], s23 offen
  ds_read_b128 v[8:11], v2 offset:20480
  ds_read_b128 v[12:15], v2 offset:49152
  ds_read_b128 v[16:19], v7 offset:20480
  ds_read_b128 v[20:23], v7 offset:49152
  s_waitcnt vmcnt(6) lgkmcnt(4)
  v_mfma_f32_32x32x16_bf16 v[40:55], a[20:23], v[24:27], v[40:55]
  v_mfma_f32_32x32x16_bf16 v[56:71], a[20:23], v[28:31], v[56:71]
  v_mfma_f32_32x32x16_bf16 v[72:87], a[20:23], v[32:35], v[72:87]
  v_mfma_f32_32x32x16_bf16 v[88:103], a[20:23], v[36:39], v[88:103]
  s_add_u32 s23, s27, 26624
  buffer_load_dwordx4 a[20:23], v1, s[8:11], s23 offen
  ds_read_b128 v[24:27], v2 offset:21504
  ds_read_b128 v[28:31], v2 offset:50176
  ds_read_b128 v[32:35], v7 offset:21504
  ds_read_b128 v[36:39], v7 offset:50176
  s_waitcnt vmcnt(6) lgkmcnt(4)
  v_mfma_f32_32x32x16_bf16 v[40:55], a[24:27], v[8:11], v[40:55]
  v_mfma_f32_32x32x16_bf16 v[56:71], a[24:27], v[12:15], v[56:71]
  v_mfma_f32_32x32x16_bf16 v[72:87], a[24:27], v[16:19], v[72:87]
  v_mfma_f32_32x32x16_bf16 v[88:103], a[24:27], v[20:23], v[88:103]
  s_add_u32 s23, s27, 27648
  buffer_load_dwordx4 a[24:27], v1, s[8:11], s23 offen
  ds_read_b128 v[8:11], v2 offset:22528
  ds_read_b128 v[12:15], v2 offset:51200
  ds_read_b128 v[16:19], v7 offset:22528
  ds_read_b128 v[20:23], v7 offset:51200
  s_waitcnt vmcnt(6) lgkmcnt(4)
  v_mfma_f32_32x32x16_bf16 v[40:55], a[0:3], v[24:27], v[40:55]
  v_mfma_f32_32x32x16_bf16 v[56:71], a[0:3], v[28:31], v[56:71]
  v_mfma_f32_32x32x16_bf16 v[72:87], a[0:3], v[32:35], v[72:87]
  v_mfma_f32_32x32x16_bf16 v[88:103], a[0:3], v[36:39], v[88:103]
  s_add_u32 s23, s28, 0
  buffer_load_dwordx4 a[0:3], v1, s[8:11], s23 offen
  ds_read_b128 v[24:27], v2 offset:23552
  ds_read_b128 v[28:31], v2 offset:52224
  ds_read_b128 v[32:35], v7 offset:23552
  ds_read_b128 v[36:39], v7 offset:52224
  s_waitcnt vmcnt(6) lgkmcnt(4)
  v_mfma_f32_32x32x16_bf16 v[40:55], a[4:7], v[8:11], v[40:55]
  v_mfma_f32_32x32x16_bf16 v[56:71], a[4:7], v[12:15], v[56:71]
  v_mfma_f32_32x32x16_bf16 v[72:87], a[4:7], v[16:19], v[72:87]
  v_mfma_f32_32x32x16_bf16 v[88:103], a[4:7], v[20:23], v[88:103]
  s_add_u32 s23, s28, 1024
  buffer_load_dwordx4 a[4:7], v1, s[8:11], s23 offen
  ds_read_b128 v[8:11], v2 offset:24576
  ds_read_b128 v[12:15], v2 offset:53248
  ds_read_b128 v[16:19], v7 offset:24576
  ds_read_b128 v[20:23], v7 offset:53248
  s_waitcnt vmcnt(6) lgkmcnt(4)
  v_mfma_f32_32x32x16_bf16 v[40:55], a[8:11], v[24:27], v[40:55]
  v_mfma_f32_32x32x16_bf16 v[56:71], a[8:11], v[28:31], v[56:71]
  v_mfma_f32_32x32x16_bf16 v[72:87], a[8:11], v[32:35], v[72:87]
  v_mfma_f32_32x32x16_bf16 v[88:103], a[8:11], v[36:39], v[88:103]
  s_add_u32 s23, s28, 2048
  buffer_load_dwordx4 a[8:11], v1, s[8:11], s23 offen
  ds_read_b128 v[24:27], v2 offset:25600
  ds_read_b128 v[28:31], v2 offset:54272
  ds_read_b128 v[32:35], v7 offset:25600
  ds_read_b128 v[36:39], v7 offset:54272
  s_waitcnt vmcnt(6) lgkmcnt(4)
  v_mfma_f32_32x32x16_bf16 v[40:55], a[12:15], v[8:11], v[40:55]
  v_mfma_f32_32x32x16_bf16 v[56:71], a[12:15], v[12:15], v[56:71]
  v_mfma_f32_32x32x16_bf16 v[72:87], a[12:15], v[16:19], v[72:87]
  v_mfma_f32_32x32x16_bf16 v[88:103], a[12:15], v[20:23], v[88:103]
  s_add_u32 s23, s28, 3072
  buffer_load_dwordx4 a[12:15], v1, s[8:11], s23 offen
  ds_read_b128 v[8:11], v2 offset:26624
  ds_read_b128 v[12:15], v2 offset:55296
  ds_read_b128 v[16:19], v7 offset:26624
  ds_read_b128 v[20:23], v7 offset:55296
  s_waitcnt vmcnt(6) lgkmcnt(4)
  v_mfma_f32_32x32x16_bf16 v[40:55], a[16:19], v[24:27], v[40:55]
  v_mfma_f32_32x32x16_bf16 v[56:71], a[16:19], v[28:31], v[56:71]
  v_mfma_f32_32x32x16_bf16 v[72:87], a[16:19], v[32:35], v[72:87]
  v_mfma_f32_32x32x16_bf16 v[88:103], a[16:19], v[36:39], v[88:103]
  s_add_u32 s23, s28, 4096
  buffer_load_dwordx4 a[16:19], v1, s[8:11], s23 offen
  ds_read_b128 v[24:27], v2 offset:27648
  ds_read_b128 v[28:31], v2 offset:56320
  ds_read_b128 v[32:35], v7 offset:27648
  ds_read_b128 v[36:39], v7 offset:56320
  s_waitcnt vmcnt(6) lgkmcnt(4)
  v_mfma_f32_32x32x16_bf16 v[40:55], a[20:23], v[8:11], v[40:55]
  v_mfma_f32_32x32x16_bf16 v[56:71], a[20:23], v[12:15], v[56:71]
  v_mfma_f32_32x32x16_bf16 v[72:87], a[20:23], v[16:19], v[72:87]
  v_mfma_f32_32x32x16_bf16 v[88:103], a[20:23], v[20:23], v[88:103]
  s_add_u32 s23, s28, 5120
  buffer_load_dwordx4 a[20:23], v1, s[8:11], s23 offen
  s_waitcnt vmcnt(6) lgkmcnt(0)
  v_mfma_f32_32x32x16_bf16 v[40:55], a[24:27], v[24:27], v[40:55]
  v_mfma_f32_32x32x16_bf16 v[56:71], a[24:27], v[28:31], v[56:71]
  v_mfma_f32_32x32x16_bf16 v[72:87], a[24:27], v[32:35], v[72:87]
  v_mfma_f32_32x32x16_bf16 v[88:103], a[24:27], v[36:39], v[88:103]
  s_add_u32 s23, s28, 6144
  buffer_load_dwordx4 a[24:27], v1, s[8:11], s23 offen
  s_nop 6
  v_cvt_pk_bf16_f32 v136, v40, v41
  v_cvt_pk_bf16_f32 v137, v42, v43
  v_cvt_pk_bf16_f32 v138, v44, v45
  v_cvt_pk_bf16_f32 v139, v46, v47
  v_cvt_pk_bf16_f32 v140, v48, v49
  v_cvt_pk_bf16_f32 v141, v50, v51
  v_cvt_pk_bf16_f32 v142, v52, v53
  v_cvt_pk_bf16_f32 v143, v54, v55
  v_cvt_pk_bf16_f32 v144, v56, v57
  v_cvt_pk_bf16_f32 v145, v58, v59
  v_cvt_pk_bf16_f32 v146, v60, v61
  v_cvt_pk_bf16_f32 v147, v62, v63
  v_cvt_pk_bf16_f32 v148, v64, v65
  v_cvt_pk_bf16_f32 v149, v66, v67
  v_cvt_pk_bf16_f32 v150, v68, v69
  v_cvt_pk_bf16_f32 v151, v70, v71
  v_cvt_pk_bf16_f32 v152, v72, v73
  v_cvt_pk_bf16_f32 v153, v74, v75
  v_cvt_pk_bf16_f32 v154, v76, v77
  v_cvt_pk_bf16_f32 v155, v78, v79
  v_cvt_pk_bf16_f32 v156, v80, v81
  v_cvt_pk_bf16_f32 v157, v82, v83
  v_cvt_pk_bf16_f32 v158, v84, v85
  v_cvt_pk_bf16_f32 v159, v86, v87
  v_cvt_pk_bf16_f32 v160, v88, v89
  v_cvt_pk_bf16_f32 v161, v90, v91
  v_cvt_pk_bf16_f32 v162, v92, v93
  v_cvt_pk_bf16_f32 v163, v94, v95
  v_cvt_pk_bf16_f32 v164, v96, v97
  v_cvt_pk_bf16_f32 v165, v98, v99
  v_cvt_pk_bf16_f32 v166, v100, v101
  v_cvt_pk_bf16_f32 v167, v102, v103
  s_waitcnt vmcnt(7)
  v_mfma_f32_32x32x16_bf16 a[64:79], a[28:31], v[136:139], a[64:79]
  v_mfma_f32_32x32x16_bf16 a[64:79], a[32:35], v[140:143], a[64:79]
  v_mfma_f32_32x32x16_bf16 a[80:95], a[36:39], v[144:147], a[80:95]
  v_mfma_f32_32x32x16_bf16 a[80:95], a[40:43], v[148:151], a[80:95]
  v_mfma_f32_32x32x16_bf16 a[96:111], a[44:47], v[152:155], a[96:111]
  v_mfma_f32_32x32x16_bf16 a[96:111], a[48:51], v[156:159], a[96:111]
  v_mfma_f32_32x32x16_bf16 a[112:127], a[52:55], v[160:163], a[112:127]
  v_mfma_f32_32x32x16_bf16 a[112:127], a[56:59], v[164:167], a[112:127]
  s_add_u32 s32, s3, 8
  ds_read_b128 v[8:11], v2 offset:0
  ds_read_b128 v[12:15], v2 offset:28672
  ds_read_b128 v[16:19], v7 offset:0
  ds_read_b128 v[20:23], v7 offset:28672
  ds_read_b128 v[24:27], v2 offset:1024
  ds_read_b128 v[28:31], v2 offset:29696
  ds_read_b128 v[32:35], v7 offset:1024
  ds_read_b128 v[36:39], v7 offset:29696
  s_waitcnt vmcnt(6) lgkmcnt(4)
  v_mfma_f32_32x32x16_bf16 v[40:55], a[0:3], v[8:11], 0
  v_mfma_f32_32x32x16_bf16 v[56:71], a[0:3], v[12:15], 0
  v_mfma_f32_32x32x16_bf16 v[72:87], a[0:3], v[16:19], 0
  v_mfma_f32_32x32x16_bf16 v[88:103], a[0:3], v[20:23], 0
  s_add_u32 s23, s28, 7168
  buffer_load_dwordx4 a[0:3], v1, s[8:11], s23 offen
  ds_read_b128 v[8:11], v2 offset:2048
  ds_read_b128 v[12:15], v2 offset:30720
  ds_read_b128 v[16:19], v7 offset:2048
  ds_read_b128 v[20:23], v7 offset:30720
  s_waitcnt vmcnt(6) lgkmcnt(4)
  v_mfma_f32_32x32x16_bf16 v[40:55], a[4:7], v[24:27], v[40:55]
  v_mfma_f32_32x32x16_bf16 v[56:71], a[4:7], v[28:31], v[56:71]
  v_mfma_f32_32x32x16_bf16 v[72:87], a[4:7], v[32:35], v[72:87]
  v_mfma_f32_32x32x16_bf16 v[88:103], a[4:7], v[36:39], v[88:103]
  s_add_u32 s23, s28, 8192
  buffer_load_dwordx4 a[4:7], v1, s[8:11], s23 offen
  ds_read_b128 v[24:27], v2 offset:3072
  ds_read_b128 v[28:31], v2 offset:31744
  ds_read_b128 v[32:35], v7 offset:3072
  ds_read_b128 v[36:39], v7 offset:31744
  s_waitcnt vmcnt(6) lgkmcnt(4)
  v_mfma_f32_32x32x16_bf16 v[40:55], a[8:11], v[8:11], v[40:55]
  v_mfma_f32_32x32x16_bf16 v[56:71], a[8:11], v[12:15], v[56:71]
  v_mfma_f32_32x32x16_bf16 v[72:87], a[8:11], v[16:19], v[72:87]
  v_mfma_f32_32x32x16_bf16 v[88:103], a[8:11], v[20:23], v[88:103]
  s_add_u32 s23, s28, 9216
  buffer_load_dwordx4 a[8:11], v1, s[8:11], s23 offen
  ds_read_b128 v[8:11], v2 offset:4096
  ds_read_b128 v[12:15], v2 offset:32768
  ds_read_b128 v[16:19], v7 offset:4096
  ds_read_b128 v[20:23], v7 offset:32768
  s_waitcnt vmcnt(6) lgkmcnt(4)
  v_mfma_f32_32x32x16_bf16 v[40:55], a[12:15], v[24:27], v[40:55]
  v_mfma_f32_32x32x16_bf16 v[56:71], a[12:15], v[28:31], v[56:71]
  v_mfma_f32_32x32x16_bf16 v[72:87], a[12:15], v[32:35], v[72:87]
  v_mfma_f32_32x32x16_bf16 v[88:103], a[12:15], v[36:39], v[88:103]
  s_add_u32 s23, s28, 10240
  buffer_load_dwordx4 a[12:15], v1, s[8:11], s23 offen
  ds_read_b128 v[24:27], v2 offset:5120
  ds_read_b128 v[28:31], v2 offset:33792
  ds_read_b128 v[32:35], v7 offset:5120
  ds_read_b128 v[36:39], v7 offset:33792
  s_waitcnt vmcnt(6) lgkmcnt(4)
  v_mfma_f32_32x32x16_bf16 v[40:55], a[16:19], v[8:11], v[40:55]
  v_mfma_f32_32x32x16_bf16 v[56:71], a[16:19], v[12:15], v[56:71]
  v_mfma_f32_32x32x16_bf16 v[72:87], a[16:19], v[16:19], v[72:87]
  v_mfma_f32_32x32x16_bf16 v[88:103], a[16:19], v[20:23], v[88:103]
  s_add_u32 s23, s28, 11264
  buffer_load_dwordx4 a[16:19], v1, s[8:11], s23 offen
  s_lshl_b32 s37, s32, 11
  s_add_u32 s37, s37, s35
  s_add_u32 s39, s37, 0
  buffer_load_dwordx4 a[28:31], v1, s[8:11], s39 offen
  s_add_u32 s39, s37, 1024
  buffer_load_dwordx4 a[32:35], v1, s[8:11], s39 offen
  s_add_u32 s39, s37, 28672
  buffer_load_dwordx4 a[36:39], v1, s[8:11], s39 offen
  s_add_u32 s39, s37, 29696
  buffer_load_dwordx4 a[40:43], v1, s[8:11], s39 offen
  s_add_u32 s39, s37, 57344
  buffer_load_dwordx4 a[44:47], v1, s[8:11], s39 offen
  s_add_u32 s39, s37, 58368
  buffer_load_dwordx4 a[48:51], v1, s[8:11], s39 offen
  s_add_u32 s39, s37, 86016
  buffer_load_dwordx4 a[52:55], v1, s[8:11], s39 offen
  s_add_u32 s39, s37, 87040
  buffer_load_dwordx4 a[56:59], v1, s[8:11], s39 offen
  ds_read_b128 v[8:11], v2 offset:6144
  ds_read_b128 v[12:15], v2 offset:34816
  ds_read_b128 v[16:19], v7 offset:6144
  ds_read_b128 v[20:23], v7 offset:34816
  s_waitcnt vmcnt(14) lgkmcnt(4)
  v_mfma_f32_32x32x16_bf16 v[40:55], a[20:23], v[24:27], v[40:55]
  v_mfma_f32_32x32x16_bf16 v[56:71], a[20:23], v[28:31], v[56:71]
  v_mfma_f32_32x32x16_bf16 v[72:87], a[20:23], v[32:35], v[72:87]
  v_mfma_f32_32x32x16_bf16 v[88:103], a[20:23], v[36:39], v[88:103]
  s_add_u32 s23, s28, 12288
  buffer_load_dwordx4 a[20:23], v1, s[8:11], s23 offen
  ds_read_b128 v[24:27], v2 offset:7168
  ds_read_b128 v[28:31], v2 offset:35840
  ds_read_b128 v[32:35], v7 offset:7168
  ds_read_b128 v[36:39], v7 offset:35840
  s_waitcnt vmcnt(14) lgkmcnt(4)
  v_mfma_f32_32x32x16_bf16 v[40:55], a[24:27], v[8:11], v[40:55]
  v_mfma_f32_32x32x16_bf16 v[56:71], a[24:27], v[12:15], v[56:71]
  v_mfma_f32_32x32x16_bf16 v[72:87], a[24:27], v[16:19], v[72:87]
  v_mfma_f32_32x32x16_bf16 v[88:103], a[24:27], v[20:23], v[88:103]
  s_add_u32 s23, s28, 13312
  buffer_load_dwordx4 a[24:27], v1, s[8:11], s23 offen
  ds_read_b128 v[8:11], v2 offset:8192
  ds_read_b128 v[12:15], v2 offset:36864
  ds_read_b128 v[16:19], v7 offset:8192
  ds_read_b128 v[20:23], v7 offset:36864
  s_waitcnt vmcnt(14) lgkmcnt(4)
  v_mfma_f32_32x32x16_bf16 v[40:55], a[0:3], v[24:27], v[40:55]
  v_mfma_f32_32x32x16_bf16 v[56:71], a[0:3], v[28:31], v[56:71]
  v_mfma_f32_32x32x16_bf16 v[72:87], a[0:3], v[32:35], v[72:87]
  v_mfma_f32_32x32x16_bf16 v[88:103], a[0:3], v[36:39], v[88:103]
  s_add_u32 s23, s28, 14336
  buffer_load_dwordx4 a[0:3], v1, s[8:11], s23 offen
  ds_read_b128 v[24:27], v2 offset:9216
  ds_read_b128 v[28:31], v2 offset:37888
  ds_read_b128 v[32:35], v7 offset:9216
  ds_read_b128 v[36:39], v7 offset:37888
  s_waitcnt vmcnt(14) lgkmcnt(4)
  v_mfma_f32_32x32x16_bf16 v[40:55], a[4:7], v[8:11], v[40:55]
  v_mfma_f32_32x32x16_bf16 v[56:71], a[4:7], v[12:15], v[56:71]
  v_mfma_f32_32x32x16_bf16 v[72:87], a[4:7], v[16:19], v[72:87]
  v_mfma_f32_32x32x16_bf16 v[88:103], a[4:7], v[20:23], v[88:103]
  s_add_u32 s23, s28, 15360
  buffer_load_dwordx4 a[4:7], v1, s[8:11], s23 offen
  ds_read_b128 v[8:11], v2 offset:10240
  ds_read_b128 v[12:15], v2 offset:38912
  ds_read_b128 v[16:19], v7 offset:10240
  ds_read_b128 v[20:23], v7 offset:38912
  s_waitcnt vmcnt(14) lgkmcnt(4)
  v_mfma_f32_32x32x16_bf16 v[40:55], a[8:11], v[24:27], v[40:55]
  v_mfma_f32_32x32x16_bf16 v[56:71], a[8:11], v[28:31], v[56:71]
  v_mfma_f32_32x32x16_bf16 v[72:87], a[8:11], v[32:35], v[72:87]
  v_mfma_f32_32x32x16_bf16 v[88:103], a[8:11], v[36:39], v[88:103]
  s_add_u32 s23, s28, 16384
  buffer_load_dwordx4 a[8:11], v1, s[8:11], s23 offen
  ds_read_b128 v[24:27], v2 offset:11264
  ds_read_b128 v[28:31], v2 offset:39936
  ds_read_b128 v[32:35], v7 offset:11264
  ds_read_b128 v[36:39], v7 offset:39936
  s_waitcnt vmcnt(14) lgkmcnt(4)
  v_mfma_f32_32x32x16_bf16 v[40:55], a[12:15], v[8:11], v[40:55]
  v_mfma_f32_32x32x16_bf16 v[56:71], a[12:15], v[12:15], v[56:71]
  v_mfma_f32_32x32x16_bf16 v[72:87], a[12:15], v[16:19], v[72:87]
  v_mfma_f32_32x32x16_bf16 v[88:103], a[12:15], v[20:23], v[88:103]
  s_add_u32 s23, s28, 17408
  buffer_load_dwordx4 a[12:15], v1, s[8:11], s23 offen
  ds_read_b128 v[8:11], v2 offset:12288
  ds_read_b128 v[12:15], v2 offset:40960
  ds_read_b128 v[16:19], v7 offset:12288
  ds_read_b128 v[20:23], v7 offset:40960
  s_waitcnt vmcnt(14) lgkmcnt(4)
  v_mfma_f32_32x32x16_bf16 v[40:55], a[16:19], v[24:27], v[40:55]
  v_mfma_f32_32x32x16_bf16 v[56:71], a[16:19], v[28:31], v[56:71]
  v_mfma_f32_32x32x16_bf16 v[72:87], a[16:19], v[32:35], v[72:87]
  v_mfma_f32_32x32x16_bf16 v[88:103], a[16:19], v[36:39], v[88:103]
  s_add_u32 s23, s28, 18432
  buffer_load_dwordx4 a[16:19], v1, s[8:11], s23 offen
  ds_read_b128 v[24:27], v2 offset:13312
  ds_read_b128 v[28:31], v2 offset:41984
  ds_read_b128 v[32:35], v7 offset:13312
  ds_read_b128 v[36:39], v7 offset:41984
  s_waitcnt vmcnt(6) lgkmcnt(4)
  v_mfma_f32_32x32x16_bf16 v[40:55], a[20:23], v[8:11], v[40:55]
  v_mfma_f32_32x32x16_bf16 v[56:71], a[20:23], v[12:15], v[56:71]
  v_mfma_f32_32x32x16_bf16 v[72:87], a[20:23], v[16:19], v[72:87]
  v_mfma_f32_32x32x16_bf16 v[88:103], a[20:23], v[20:23], v[88:103]
  s_add_u32 s23, s28, 19456
  buffer_load_dwordx4 a[20:23], v1, s[8:11], s23 offen
  ds_read_b128 v[8:11], v2 offset:14336
  ds_read_b128 v[12:15], v2 offset:43008
  ds_read_b128 v[16:19], v7 offset:14336
  ds_read_b128 v[20:23], v7 offset:43008
  s_waitcnt vmcnt(6) lgkmcnt(4)
  v_mfma_f32_32x32x16_bf16 v[40:55], a[24:27], v[24:27], v[40:55]
  v_mfma_f32_32x32x16_bf16 v[56:71], a[24:27], v[28:31], v[56:71]
  v_mfma_f32_32x32x16_bf16 v[72:87], a[24:27], v[32:35], v[72:87]
  v_mfma_f32_32x32x16_bf16 v[88:103], a[24:27], v[36:39], v[88:103]
  s_add_u32 s23, s28, 20480
  buffer_load_dwordx4 a[24:27], v1, s[8:11], s23 offen
  ds_read_b128 v[24:27], v2 offset:15360
  ds_read_b128 v[28:31], v2 offset:44032
  ds_read_b128 v[32:35], v7 offset:15360
  ds_read_b128 v[36:39], v7 offset:44032
  s_waitcnt vmcnt(6) lgkmcnt(4)
  v_mfma_f32_32x32x16_bf16 v[40:55], a[0:3], v[8:11], v[40:55]
  v_mfma_f32_32x32x16_bf16 v[56:71], a[0:3], v[12:15], v[56:71]
  v_mfma_f32_32x32x16_bf16 v[72:87], a[0:3], v[16:19], v[72:87]
  v_mfma_f32_32x32x16_bf16 v[88:103], a[0:3], v[20:23], v[88:103]
  s_add_u32 s23, s28, 21504
  buffer_load_dwordx4 a[0:3], v1, s[8:11], s23 offen
  ds_read_b128 v[8:11], v2 offset:16384
  ds_read_b128 v[12:15], v2 offset:45056
  ds_read_b128 v[16:19], v7 offset:16384
  ds_read_b128 v[20:23], v7 offset:45056
  s_waitcnt vmcnt(6) lgkmcnt(4)
  v_mfma_f32_32x32x16_bf16 v[40:55], a[4:7], v[24:27], v[40:55]
  v_mfma_f32_32x32x16_bf16 v[56:71], a[4:7], v[28:31], v[56:71]
  v_mfma_f32_32x32x16_bf16 v[72:87], a[4:7], v[32:35], v[72:87]
  v_mfma_f32_32x32x16_bf16 v[88:103], a[4:7], v[36:39], v[88:103]
  s_add_u32 s23, s28, 22528
  buffer_load_dwordx4 a[4:7], v1, s[8:11], s23 offen
  ds_read_b128 v[24:27], v2 offset:17408
  ds_read_b128 v[28:31], v2 offset:46080
  ds_read_b128 v[32:35], v7 offset:17408
  ds_read_b128 v[36:39], v7 offset:46080
  s_waitcnt vmcnt(6) lgkmcnt(4)
  v_mfma_f32_32x32x16_bf16 v[40:55], a[8:11], v[8:11], v[40:55]
  v_mfma_f32_32x32x16_bf16 v[56:71], a[8:11], v[12:15], v[56:71]
  v_mfma_f32_32x32x16_bf16 v[72:87], a[8:11], v[16:19], v[72:87]
  v_mfma_f32_32x32x16_bf16 v[88:103], a[8:11], v[20:23], v[88:103]
  s_add_u32 s23, s28, 23552
  buffer_load_dwordx4 a[8:11], v1, s[8:11], s23 offen
  ds_read_b128 v[8:11], v2 offset:18432
  ds_read_b128 v[12:15], v2 offset:47104
  ds_read_b128 v[16:19], v7 offset:18432
  ds_read_b128 v[20:23], v7 offset:47104
  s_waitcnt vmcnt(6) lgkmcnt(4)
  v_mfma_f32_32x32x16_bf16 v[40:55], a[12:15], v[24:27], v[40:55]
  v_mfma_f32_32x32x16_bf16 v[56:71], a[12:15], v[28:31], v[56:71]
  v_mfma_f32_32x32x16_bf16 v[72:87], a[12:15], v[32:35], v[72:87]
  v_mfma_f32_32x32x16_bf16 v[88:103], a[12:15], v[36:39], v[88:103]
  s_add_u32 s23, s28, 24576
  buffer_load_dwordx4 a[12:15], v1, s[8:11], s23 offen
  ds_read_b128 v[24:27], v2 offset:19456
  ds_read_b128 v[28:31], v2 offset:48128
  ds_read_b128 v[32:35], v7 offset:19456
  ds_read_b128 v[36:39], v7 offset:48128
  s_waitcnt vmcnt(6) lgkmcnt(4)
  v_mfma_f32_32x32x16_bf16 v[40:55], a[16:19], v[8:11], v[40:55]
  v_mfma_f32_32x32x16_bf16 v[56:71], a[16:19], v[12:15], v[56:71]
  v_mfma_f32_32x32x16_bf16 v[72:87], a[16:19], v[16:19], v[72:87]
  v_mfma_f32_32x32x16_bf16 v[88:103], a[16:19], v[20:23], v[88:103]
  s_add_u32 s23, s28, 25600
  buffer_load_dwordx4 a[16:19], v1, s[8:11], s23 offen
  ds_read_b128 v[8:11], v2 offset:20480
  ds_read_b128 v[12:15], v2 offset:49152
  ds_read_b128 v[16:19], v7 offset:20480
  ds_read_b128 v[20:23], v7 offset:49152
  s_waitcnt vmcnt(6) lgkmcnt(4)
  v_mfma_f32_32x32x16_bf16 v[40:55], a[20:23], v[24:27], v[40:55]
  v_mfma_f32_32x32x16_bf16 v[56:71], a[20:23], v[28:31], v[56:71]
  v_mfma_f32_32x32x16_bf16 v[72:87], a[20:23], v[32:35], v[72:87]
  v_mfma_f32_32x32x16_bf16 v[88:103], a[20:23], v[36:39], v[88:103]
  s_add_u32 s23, s28, 26624
  buffer_load_dwordx4 a[20:23], v1, s[8:11], s23 offen
  ds_read_b128 v[24:27], v2 offset:21504
  ds_read_b128 v[28:31], v2 offset:50176
  ds_read_b128 v[32:35], v7 offset:21504
  ds_read_b128 v[36:39], v7 offset:50176
  s_waitcnt vmcnt(6) lgkmcnt(4)
  v_mfma_f32_32x32x16_bf16 v[40:55], a[24:27], v[8:11], v[40:55]
  v_mfma_f32_32x32x16_bf16 v[56:71], a[24:27], v[12:15], v[56:71]
  v_mfma_f32_32x32x16_bf16 v[72:87], a[24:27], v[16:19], v[72:87]
  v_mfma_f32_32x32x16_bf16 v[88:103], a[24:27], v[20:23], v[88:103]
  s_add_u32 s23, s28, 27648
  buffer_load_dwordx4 a[24:27], v1, s[8:11], s23 offen
  ds_read_b128 v[8:11], v2 offset:22528
  ds_read_b128 v[12:15], v2 offset:51200
  ds_read_b128 v[16:19], v7 offset:22528
  ds_read_b128 v[20:23], v7 offset:51200
  s_waitcnt vmcnt(6) lgkmcnt(4)
  v_mfma_f32_32x32x16_bf16 v[40:55], a[0:3], v[24:27], v[40:55]
  v_mfma_f32_32x32x16_bf16 v[56:71], a[0:3], v[28:31], v[56:71]
  v_mfma_f32_32x32x16_bf16 v[72:87], a[0:3], v[32:35], v[72:87]
  v_mfma_f32_32x32x16_bf16 v[88:103], a[0:3], v[36:39], v[88:103]
  s_add_u32 s23, s29, 0
  buffer_load_dwordx4 a[0:3], v1, s[8:11], s23 offen
  ds_read_b128 v[24:27], v2 offset:23552
  ds_read_b128 v[28:31], v2 offset:52224
  ds_read_b128 v[32:35], v7 offset:23552
  ds_read_b128 v[36:39], v7 offset:52224
  s_waitcnt vmcnt(6) lgkmcnt(4)
  v_mfma_f32_32x32x16_bf16 v[40:55], a[4:7], v[8:11], v[40:55]
  v_mfma_f32_32x32x16_bf16 v[56:71], a[4:7], v[12:15], v[56:71]
  v_mfma_f32_32x32x16_bf16 v[72:87], a[4:7], v[16:19], v[72:87]
  v_mfma_f32_32x32x16_bf16 v[88:103], a[4:7], v[20:23], v[88:103]
  s_add_u32 s23, s29, 1024
  buffer_load_dwordx4 a[4:7], v1, s[8:11], s23 offen
  ds_read_b128 v[8:11], v2 offset:24576
  ds_read_b128 v[12:15], v2 offset:53248
  ds_read_b128 v[16:19], v7 offset:24576
  ds_read_b128 v[20:23], v7 offset:53248
  s_waitcnt vmcnt(6) lgkmcnt(4)
  v_mfma_f32_32x32x16_bf16 v[40:55], a[8:11], v[24:27], v[40:55]
  v_mfma_f32_32x32x16_bf16 v[56:71], a[8:11], v[28:31], v[56:71]
  v_mfma_f32_32x32x16_bf16 v[72:87], a[8:11], v[32:35], v[72:87]
  v_mfma_f32_32x32x16_bf16 v[88:103], a[8:11], v[36:39], v[88:103]
  s_add_u32 s23, s29, 2048
  buffer_load_dwordx4 a[8:11], v1, s[8:11], s23 offen
  ds_read_b128 v[24:27], v2 offset:25600
  ds_read_b128 v[28:31], v2 offset:54272
  ds_read_b128 v[32:35], v7 offset:25600
  ds_read_b128 v[36:39], v7 offset:54272
  s_waitcnt vmcnt(6) lgkmcnt(4)
  v_mfma_f32_32x32x16_bf16 v[40:55], a[12:15], v[8:11], v[40:55]
  v_mfma_f32_32x32x16_bf16 v[56:71], a[12:15], v[12:15], v[56:71]
  v_mfma_f32_32x32x16_bf16 v[72:87], a[12:15], v[16:19], v[72:87]
  v_mfma_f32_32x32x16_bf16 v[88:103], a[12:15], v[20:23], v[88:103]
  s_add_u32 s23, s29, 3072
  buffer_load_dwordx4 a[12:15], v1, s[8:11], s23 offen
  ds_read_b128 v[8:11], v2 offset:26624
  ds_read_b128 v[12:15], v2 offset:55296
  ds_read_b128 v[16:19], v7 offset:26624
  ds_read_b128 v[20:23], v7 offset:55296
  s_waitcnt vmcnt(6) lgkmcnt(4)
  v_mfma_f32_32x32x16_bf16 v[40:55], a[16:19], v[24:27], v[40:55]
  v_mfma_f32_32x32x16_bf16 v[56:71], a[16:19], v[28:31], v[56:71]
  v_mfma_f32_32x32x16_bf16 v[72:87], a[16:19], v[32:35], v[72:87]
  v_mfma_f32_32x32x16_bf16 v[88:103], a[16:19], v[36:39], v[88:103]
  s_add_u32 s23, s29, 4096
  buffer_load_dwordx4 a[16:19], v1, s[8:11], s23 offen
  ds_read_b128 v[24:27], v2 offset:27648
  ds_read_b128 v[28:31], v2 offset:56320
  ds_read_b128 v[32:35], v7 offset:27648
  ds_read_b128 v[36:39], v7 offset:56320
  s_waitcnt vmcnt(6) lgkmcnt(4)
  v_mfma_f32_32x32x16_bf16 v[40:55], a[20:23], v[8:11], v[40:55]
  v_mfma_f32_32x32x16_bf16 v[56:71], a[20:23], v[12:15], v[56:71]
  v_mfma_f32_32x32x16_bf16 v[72:87], a[20:23], v[16:19], v[72:87]
  v_mfma_f32_32x32x16_bf16 v[88:103], a[20:23], v[20:23], v[88:103]
  s_add_u32 s23, s29, 5120
  buffer_load_dwordx4 a[20:23], v1, s[8:11], s23 offen
  s_waitcnt vmcnt(6) lgkmcnt(0)
  v_mfma_f32_32x32x16_bf16 v[40:55], a[24:27], v[24:27], v[40:55]
  v_mfma_f32_32x32x16_bf16 v[56:71], a[24:27], v[28:31], v[56:71]
  v_mfma_f32_32x32x16_bf16 v[72:87], a[24:27], v[32:35], v[72:87]
  v_mfma_f32_32x32x16_bf16 v[88:103], a[24:27], v[36:39], v[88:103]
  s_add_u32 s23, s29, 6144
  buffer_load_dwordx4 a[24:27], v1, s[8:11], s23 offen
  s_nop 6
  v_cvt_pk_bf16_f32 v168, v40, v41
  v_cvt_pk_bf16_f32 v169, v42, v43
  v_cvt_pk_bf16_f32 v170, v44, v45
  v_cvt_pk_bf16_f32 v171, v46, v47
  v_cvt_pk_bf16_f32 v172, v48, v49
  v_cvt_pk_bf16_f32 v173, v50, v51
  v_cvt_pk_bf16_f32 v174, v52, v53
  v_cvt_pk_bf16_f32 v175, v54, v55
  v_cvt_pk_bf16_f32 v176, v56, v57
  v_cvt_pk_bf16_f32 v177, v58, v59
  v_cvt_pk_bf16_f32 v178, v60, v61
  v_cvt_pk_bf16_f32 v179, v62, v63
  v_cvt_pk_bf16_f32 v180, v64, v65
  v_cvt_pk_bf16_f32 v181, v66, v67
  v_cvt_pk_bf16_f32 v182, v68, v69
  v_cvt_pk_bf16_f32 v183, v70, v71
  v_cvt_pk_bf16_f32 v184, v72, v73
  v_cvt_pk_bf16_f32 v185, v74, v75
  v_cvt_pk_bf16_f32 v186, v76, v77
  v_cvt_pk_bf16_f32 v187, v78, v79
  v_cvt_pk_bf16_f32 v188, v80, v81
  v_cvt_pk_bf16_f32 v189, v82, v83
  v_cvt_pk_bf16_f32 v190, v84, v85
  v_cvt_pk_bf16_f32 v191, v86, v87
  v_cvt_pk_bf16_f32 v192, v88, v89
  v_cvt_pk_bf16_f32 v193, v90, v91
  v_cvt_pk_bf16_f32 v194, v92, v93
  v_cvt_pk_bf16_f32 v195, v94, v95
  v_cvt_pk_bf16_f32 v196, v96, v97
  v_cvt_pk_bf16_f32 v197, v98, v99
  v_cvt_pk_bf16_f32 v198, v100, v101
  v_cvt_pk_bf16_f32 v199, v102, v103
  s_waitcnt vmcnt(7)
  v_mfma_f32_32x32x16_bf16 a[64:79], a[28:31], v[168:171], a[64:79]
  v_mfma_f32_32x32x16_bf16 a[64:79], a[32:35], v[172:175], a[64:79]
  v_mfma_f32_32x32x16_bf16 a[80:95], a[36:39], v[176:179], a[80:95]
  v_mfma_f32_32x32x16_bf16 a[80:95], a[40:43], v[180:183], a[80:95]
  v_mfma_f32_32x32x16_bf16 a[96:111], a[44:47], v[184:187], a[96:111]
  v_mfma_f32_32x32x16_bf16 a[96:111], a[48:51], v[188:191], a[96:111]
  v_mfma_f32_32x32x16_bf16 a[112:127], a[52:55], v[192:195], a[112:127]
  v_mfma_f32_32x32x16_bf16 a[112:127], a[56:59], v[196:199], a[112:127]
  s_lshr_b32 s32, s3, 1
  s_add_u32 s32, s32, 12
  s_and_b32 s33, s3, 1
  s_lshl_b32 s33, s33, 1
  ds_read_b128 v[8:11], v3 offset:0
  ds_read_b128 v[12:15], v3 offset:28672
  ds_read_b128 v[24:27], v3 offset:1024
  ds_read_b128 v[28:31], v3 offset:29696
  s_waitcnt vmcnt(6) lgkmcnt(2)
  v_mfma_f32_32x32x16_bf16 v[40:55], a[0:3], v[8:11], 0
  v_mfma_f32_32x32x16_bf16 v[56:71], a[0:3], v[12:15], 0
  s_add_u32 s23, s29, 7168
  buffer_load_dwordx4 a[0:3], v1, s[8:11], s23 offen
  ds_read_b128 v[8:11], v3 offset:2048
  ds_read_b128 v[12:15], v3 offset:30720
  s_waitcnt vmcnt(6) lgkmcnt(2)
  v_mfma_f32_32x32x16_bf16 v[40:55], a[4:7], v[24:27], v[40:55]
  v_mfma_f32_32x32x16_bf16 v[56:71], a[4:7], v[28:31], v[56:71]
  s_add_u32 s23, s29, 8192
  buffer_load_dwordx4 a[4:7], v1, s[8:11], s23 offen
  ds_read_b128 v[24:27], v3 offset:3072
  ds_read_b128 v[28:31], v3 offset:31744
  s_waitcnt vmcnt(6) lgkmcnt(2)
  v_mfma_f32_32x32x16_bf16 v[40:55], a[8:11], v[8:11], v[40:55]
  v_mfma_f32_32x32x16_bf16 v[56:71], a[8:11], v[12:15], v[56:71]
  s_add_u32 s23, s29, 9216
  buffer_load_dwordx4 a[8:11], v1, s[8:11], s23 offen
  ds_read_b128 v[8:11], v3 offset:4096
  ds_read_b128 v[12:15], v3 offset:32768
  s_waitcnt vmcnt(6) lgkmcnt(2)
  v_mfma_f32_32x32x16_bf16 v[40:55], a[12:15], v[24:27], v[40:55]
  v_mfma_f32_32x32x16_bf16 v[56:71], a[12:15], v[28:31], v[56:71]
  s_add_u32 s23, s29, 10240
  buffer_load_dwordx4 a[12:15], v1, s[8:11], s23 offen
  ds_read_b128 v[24:27], v3 offset:5120
  ds_read_b128 v[28:31], v3 offset:33792
  s_waitcnt vmcnt(6) lgkmcnt(2)
  v_mfma_f32_32x32x16_bf16 v[40:55], a[16:19], v[8:11], v[40:55]
  v_mfma_f32_32x32x16_bf16 v[56:71], a[16:19], v[12:15], v[56:71]
  s_add_u32 s23, s29, 11264
  buffer_load_dwordx4 a[16:19], v1, s[8:11], s23 offen
  s_lshl_b32 s37, s32, 11
  s_add_u32 s37, s37, s35
  s_mul_i32 s39, s33, 28672
  s_add_u32 s37, s37, s39
  s_add_u32 s39, s37, 0
  buffer_load_dwordx4 a[28:31], v1, s[8:11], s39 offen
  s_add_u32 s39, s37, 1024
  buffer_load_dwordx4 a[32:35], v1, s[8:11], s39 offen
  s_add_u32 s39, s37, 28672
  buffer_load_dwordx4 a[36:39], v1, s[8:11], s39 offen
  s_add_u32 s39, s37, 29696
  buffer_load_dwordx4 a[40:43], v1, s[8:11], s39 offen
  ds_read_b128 v[8:11], v3 offset:6144
  ds_read_b128 v[12:15], v3 offset:34816
  s_waitcnt vmcnt(10) lgkmcnt(2)
  v_mfma_f32_32x32x16_bf16 v[40:55], a[20:23], v[24:27], v[40:55]
  v_mfma_f32_32x32x16_bf16 v[56:71], a[20:23], v[28:31], v[56:71]
  s_add_u32 s23, s29, 12288
  buffer_load_dwordx4 a[20:23], v1, s[8:11], s23 offen
  ds_read_b128 v[24:27], v3 offset:7168
  ds_read_b128 v[28:31], v3 offset:35840
  s_waitcnt vmcnt(10) lgkmcnt(2)
  v_mfma_f32_32x32x16_bf16 v[40:55], a[24:27], v[8:11], v[40:55]
  v_mfma_f32_32x32x16_bf16 v[56:71], a[24:27], v[12:15], v[56:71]
  s_add_u32 s23, s29, 13312
  buffer_load_dwordx4 a[24:27], v1, s[8:11], s23 offen
  ds_read_b128 v[8:11], v3 offset:8192
  ds_read_b128 v[12:15], v3 offset:36864
  s_waitcnt vmcnt(10) lgkmcnt(2)
  v_mfma_f32_32x32x16_bf16 v[40:55], a[0:3], v[24:27], v[40:55]
  v_mfma_f32_32x32x16_bf16 v[56:71], a[0:3], v[28:31], v[56:71]
  s_add_u32 s23, s29, 14336
  buffer_load_dwordx4 a[0:3], v1, s[8:11], s23 offen
  ds_read_b128 v[24:27], v3 offset:9216
  ds_read_b128 v[28:31], v3 offset:37888
  s_waitcnt vmcnt(10) lgkmcnt(2)
  v_mfma_f32_32x32x16_bf16 v[40:55], a[4:7], v[8:11], v[40:55]
  v_mfma_f32_32x32x16_bf16 v[56:71], a[4:7], v[12:15], v[56:71]
  s_add_u32 s23, s29, 15360
  buffer_load_dwordx4 a[4:7], v1, s[8:11], s23 offen
  ds_read_b128 v[8:11], v3 offset:10240
  ds_read_b128 v[12:15], v3 offset:38912
  s_waitcnt vmcnt(10) lgkmcnt(2)
  v_mfma_f32_32x32x16_bf16 v[40:55], a[8:11], v[24:27], v[40:55]
  v_mfma_f32_32x32x16_bf16 v[56:71], a[8:11], v[28:31], v[56:71]
  s_add_u32 s23, s29, 16384
  buffer_load_dwordx4 a[8:11], v1, s[8:11], s23 offen
  ds_read_b128 v[24:27], v3 offset:11264
  ds_read_b128 v[28:31], v3 offset:39936
  s_waitcnt vmcnt(10) lgkmcnt(2)
  v_mfma_f32_32x32x16_bf16 v[40:55], a[12:15], v[8:11], v[40:55]
  v_mfma_f32_32x32x16_bf16 v[56:71], a[12:15], v[12:15], v[56:71]
  s_add_u32 s23, s29, 17408
  buffer_load_dwordx4 a[12:15], v1, s[8:11], s23 offen
  ds_read_b128 v[8:11], v3 offset:12288
  ds_read_b128 v[12:15], v3 offset:40960
  s_waitcnt vmcnt(10) lgkmcnt(2)
  v_mfma_f32_32x32x16_bf16 v[40:55], a[16:19], v[24:27], v[40:55]
  v_mfma_f32_32x32x16_bf16 v[56:71], a[16:19], v[28:31], v[56:71]
  s_add_u32 s23, s29, 18432
  buffer_load_dwordx4 a[16:19], v1, s[8:11], s23 offen
  ds_read_b128 v[24:27], v3 offset:13312
  ds_read_b128 v[28:31], v3 offset:41984
  s_waitcnt vmcnt(6) lgkmcnt(2)
  v_mfma_f32_32x32x16_bf16 v[40:55], a[20:23], v[8:11], v[40:55]
  v_mfma_f32_32x32x16_bf16 v[56:71], a[20:23], v[12:15], v[56:71]
  s_add_u32 s23, s29, 19456
  buffer_load_dwordx4 a[20:23], v1, s[8:11], s23 offen
  ds_read_b128 v[8:11], v3 offset:14336
  ds_read_b128 v[12:15], v3 offset:43008
  s_waitcnt vmcnt(6) lgkmcnt(2)
  v_mfma_f32_32x32x16_bf16 v[40:55], a[24:27], v[24:27], v[40:55]
  v_mfma_f32_32x32x16_bf16 v[56:71], a[24:27], v[28:31], v[56:71]
  s_add_u32 s23, s29, 20480
  buffer_load_dwordx4 a[24:27], v1, s[8:11], s23 offen
  ds_read_b128 v[24:27], v3 offset:15360
  ds_read_b128 v[28:31], v3 offset:44032
  s_waitcnt vmcnt(6) lgkmcnt(2)
  v_mfma_f32_32x32x16_bf16 v[40:55], a[0:3], v[8:11], v[40:55]
  v_mfma_f32_32x32x16_bf16 v[56:71], a[0:3], v[12:15], v[56:71]
  s_add_u32 s23, s29, 21504
  buffer_load_dwordx4 a[0:3], v1, s[8:11], s23 offen
  ds_read_b128 v[8:11], v3 offset:16384
  ds_read_b128 v[12:15], v3 offset:45056
  s_waitcnt vmcnt(6) lgkmcnt(2)
  v_mfma_f32_32x32x16_bf16 v[40:55], a[4:7], v[24:27], v[40:55]
  v_mfma_f32_32x32x16_bf16 v[56:71], a[4:7], v[28:31], v[56:71]
  s_add_u32 s23, s29, 22528
  buffer_load_dwordx4 a[4:7], v1, s[8:11], s23 offen
  ds_read_b128 v[24:27], v3 offset:17408
  ds_read_b128 v[28:31], v3 offset:46080
  s_waitcnt vmcnt(6) lgkmcnt(2)
  v_mfma_f32_32x32x16_bf16 v[40:55], a[8:11], v[8:11], v[40:55]
  v_mfma_f32_32x32x16_bf16 v[56:71], a[8:11], v[12:15], v[56:71]
  s_add_u32 s23, s29, 23552
  buffer_load_dwordx4 a[8:11], v1, s[8:11], s23 offen
  ds_read_b128 v[8:11], v3 offset:18432
  ds_read_b128 v[12:15], v3 offset:47104
  s_waitcnt vmcnt(6) lgkmcnt(2)
  v_mfma_f32_32x32x16_bf16 v[40:55], a[12:15], v[24:27], v[40:55]
  v_mfma_f32_32x32x16_bf16 v[56:71], a[12:15], v[28:31], v[56:71]
  s_add_u32 s23, s29, 24576
  buffer_load_dwordx4 a[12:15], v1, s[8:11], s23 offen
  ds_read_b128 v[24:27], v3 offset:19456
  ds_read_b128 v[28:31], v3 offset:48128
  s_waitcnt vmcnt(6) lgkmcnt(2)
  v_mfma_f32_32x32x16_bf16 v[40:55], a[16:19], v[8:11], v[40:55]
  v_mfma_f32_32x32x16_bf16 v[56:71], a[16:19], v[12:15], v[56:71]
  s_add_u32 s23, s29, 25600
  buffer_load_dwordx4 a[16:19], v1, s[8:11], s23 offen
  ds_read_b128 v[8:11], v3 offset:20480
  ds_read_b128 v[12:15], v3 offset:49152
  s_waitcnt vmcnt(6) lgkmcnt(2)
  v_mfma_f32_32x32x16_bf16 v[40:55], a[20:23], v[24:27], v[40:55]
  v_mfma_f32_32x32x16_bf16 v[56:71], a[20:23], v[28:31], v[56:71]
  s_add_u32 s23, s29, 26624
  buffer_load_dwordx4 a[20:23], v1, s[8:11], s23 offen
  ds_read_b128 v[24:27], v3 offset:21504
  ds_read_b128 v[28:31], v3 offset:50176
  s_waitcnt vmcnt(6) lgkmcnt(2)
  v_mfma_f32_32x32x16_bf16 v[40:55], a[24:27], v[8:11], v[40:55]
  v_mfma_f32_32x32x16_bf16 v[56:71], a[24:27], v[12:15], v[56:71]
  s_add_u32 s23, s29, 27648
  buffer_load_dwordx4 a[24:27], v1, s[8:11], s23 offen
  ds_read_b128 v[8:11], v3 offset:22528
  ds_read_b128 v[12:15], v3 offset:51200
  s_waitcnt vmcnt(6) lgkmcnt(2)
  v_mfma_f32_32x32x16_bf16 v[40:55], a[0:3], v[24:27], v[40:55]
  v_mfma_f32_32x32x16_bf16 v[56:71], a[0:3], v[28:31], v[56:71]
  buffer_load_dwordx4 a[0:3], v1, s[8:11], s29 offen
  ds_read_b128 v[24:27], v3 offset:23552
  ds_read_b128 v[28:31], v3 offset:52224
  s_waitcnt vmcnt(6) lgkmcnt(2)
  v_mfma_f32_32x32x16_bf16 v[40:55], a[4:7], v[8:11], v[40:55]
  v_mfma_f32_32x32x16_bf16 v[56:71], a[4:7], v[12:15], v[56:71]
  buffer_load_dwordx4 a[4:7], v1, s[8:11], s29 offen
  ds_read_b128 v[8:11], v3 offset:24576
  ds_read_b128 v[12:15], v3 offset:53248
  s_waitcnt vmcnt(6) lgkmcnt(2)
  v_mfma_f32_32x32x16_bf16 v[40:55], a[8:11], v[24:27], v[40:55]
  v_mfma_f32_32x32x16_bf16 v[56:71], a[8:11], v[28:31], v[56:71]
  buffer_load_dwordx4 a[8:11], v1, s[8:11], s29 offen
  ds_read_b128 v[24:27], v3 offset:25600
  ds_read_b128 v[28:31], v3 offset:54272
  s_waitcnt vmcnt(6) lgkmcnt(2)
  v_mfma_f32_32x32x16_bf16 v[40:55], a[12:15], v[8:11], v[40:55]
  v_mfma_f32_32x32x16_bf16 v[56:71], a[12:15], v[12:15], v[56:71]
  buffer_load_dwordx4 a[12:15], v1, s[8:11], s29 offen
  ds_read_b128 v[8:11], v3 offset:26624
  ds_read_b128 v[12:15], v3 offset:55296
  s_waitcnt vmcnt(6) lgkmcnt(2)
  v_mfma_f32_32x32x16_bf16 v[40:55], a[16:19], v[24:27], v[40:55]
  v_mfma_f32_32x32x16_bf16 v[56:71], a[16:19], v[28:31], v[56:71]
  buffer_load_dwordx4 a[16:19], v1, s[8:11], s29 offen
  ds_read_b128 v[24:27], v3 offset:27648
  ds_read_b128 v[28:31], v3 offset:56320
  s_waitcnt vmcnt(6) lgkmcnt(2)
  v_mfma_f32_32x32x16_bf16 v[40:55], a[20:23], v[8:11], v[40:55]
  v_mfma_f32_32x32x16_bf16 v[56:71], a[20:23], v[12:15], v[56:71]
  buffer_load_dwordx4 a[20:23], v1, s[8:11], s29 offen
  s_waitcnt vmcnt(6) lgkmcnt(0)
  v_mfma_f32_32x32x16_bf16 v[40:55], a[24:27], v[24:27], v[40:55]
  v_mfma_f32_32x32x16_bf16 v[56:71], a[24:27], v[28:31], v[56:71]
  buffer_load_dwordx4 a[24:27], v1, s[8:11], s29 offen
  s_cmp_eq_u32 s33, 0
  s_nop 7
  s_cbranch_scc0 L_x_hi
  v_cvt_pk_bf16_f32 v200, v40, v41
  v_cvt_pk_bf16_f32 v201, v42, v43
  v_cvt_pk_bf16_f32 v202, v44, v45
  v_cvt_pk_bf16_f32 v203, v46, v47
  v_cvt_pk_bf16_f32 v204, v48, v49
  v_cvt_pk_bf16_f32 v205, v50, v51
  v_cvt_pk_bf16_f32 v206, v52, v53
  v_cvt_pk_bf16_f32 v207, v54, v55
  v_cvt_pk_bf16_f32 v208, v56, v57
  v_cvt_pk_bf16_f32 v209, v58, v59
  v_cvt_pk_bf16_f32 v210, v60, v61
  v_cvt_pk_bf16_f32 v211, v62, v63
  v_cvt_pk_bf16_f32 v212, v64, v65
  v_cvt_pk_bf16_f32 v213, v66, v67
  v_cvt_pk_bf16_f32 v214, v68, v69
  v_cvt_pk_bf16_f32 v215, v70, v71
  s_waitcnt vmcnt(7)
  v_mfma_f32_32x32x16_bf16 a[64:79], a[28:31], v[200:203], a[64:79]
  v_mfma_f32_32x32x16_bf16 a[64:79], a[32:35], v[204:207], a[64:79]
  v_mfma_f32_32x32x16_bf16 a[80:95], a[36:39], v[208:211], a[80:95]
  v_mfma_f32_32x32x16_bf16 a[80:95], a[40:43], v[212:215], a[80:95]
  s_branch L_x_j
L_x_hi:
  v_cvt_pk_bf16_f32 v200, v40, v41
  v_cvt_pk_bf16_f32 v201, v42, v43
  v_cvt_pk_bf16_f32 v202, v44, v45
  v_cvt_pk_bf16_f32 v203, v46, v47
  v_cvt_pk_bf16_f32 v204, v48, v49
  v_cvt_pk_bf16_f32 v205, v50, v51
  v_cvt_pk_bf16_f32 v206, v52, v53
  v_cvt_pk_bf16_f32 v207, v54, v55
  v_cvt_pk_bf16_f32 v208, v56, v57
  v_cvt_pk_bf16_f32 v209, v58, v59
  v_cvt_pk_bf16_f32 v210, v60, v61
  v_cvt_pk_bf16_f32 v211, v62, v63
  v_cvt_pk_bf16_f32 v212, v64, v65
  v_cvt_pk_bf16_f32 v213, v66, v67
  v_cvt_pk_bf16_f32 v214, v68, v69
  v_cvt_pk_bf16_f32 v215, v70, v71
  s_waitcnt vmcnt(7)
  v_mfma_f32_32x32x16_bf16 a[96:111], a[28:31], v[200:203], a[96:111]
  v_mfma_f32_32x32x16_bf16 a[96:111], a[32:35], v[204:207], a[96:111]
  v_mfma_f32_32x32x16_bf16 a[112:127], a[36:39], v[208:211], a[112:127]
  v_mfma_f32_32x32x16_bf16 a[112:127], a[40:43], v[212:215], a[112:127]
L_x_j:
  s_nop 7
  s_nop 7
  s_waitcnt vmcnt(0) lgkmcnt(0)
  s_barrier
  s_mul_i32 s38, s3, 5120
  v_add_u32 v8, s38, v1
  v_add_u32 v9, 40960, v8
  s_cmp_eq_u32 s24, 15
  s_cselect_b32 s78, 1, 6
  s_lshl_b32 s73, s24, 2
  s_add_u32 s73, s73, 1
  s_lshl_b32 s73, s73, 4
  s_cmp_lg_u32 s3, 0
  s_cbranch_scc1 L_fc_xm0_j
  s_mov_b32 s77, 49883136
  s_mov_b32 s23, 0
L_fc_xm0:
  buffer_load_dword v10, off, s[8:11], s77 sc1
  s_add_u32 s23, s23, 1
  s_cmp_gt_u32 s23, 50000
  s_cbranch_scc1 L_w_fail
  s_waitcnt vmcnt(0)
  v_readfirstlane_b32 s22, v10
  s_nop 0
  s_cmp_ge_u32 s22, s73
  s_cbranch_scc1 L_fc_xm0_j
  s_sub_u32 s22, s73, s22
  s_lshr_b32 s22, s22, 4
  s_min_u32 s22, s22, 16
  s_cmp_lt_u32 s22, 2
  s_cbranch_scc1 L_fc_xm0_s
  s_sub_u32 s22, s22, 1
L_fc_xm0_l:
  s_sleep 44
  s_sub_u32 s22, s22, 1
  s_cmp_lg_u32 s22, 0
  s_cbranch_scc1 L_fc_xm0_l
  s_branch L_fc_xm0
L_fc_xm0_s:
  s_mov_b32 s22, s78
L_fc_xm0_r:
  s_sleep 4
  s_sub_u32 s22, s22, 1
  s_cmp_lg_u32 s22, 0
  s_cbranch_scc1 L_fc_xm0_r
  s_branch L_fc_xm0
L_fc_xm0_j:
  s_barrier
  s_lshl_b32 s37, s3, 9
  s_add_u32 s37, s37, s36
  s_add_u32 s37, s37, 0
  s_add_u32 s39, s37, 0
  buffer_load_dwordx4 a[144:147], v5, s[8:11], s39 offen sc1
  s_add_u32 s39, s37, 256
  buffer_load_dwordx4 a[148:151], v5, s[8:11], s39 offen sc1
  s_add_u32 s39, s37, 2048
  buffer_load_dwordx4 a[152:155], v5, s[8:11], s39 offen sc1
  s_add_u32 s39, s37, 2304
  buffer_load_dwordx4 a[156:159], v5, s[8:11], s39 offen sc1
  s_add_u32 s39, s37, 4096
  buffer_load_dwordx4 a[160:163], v5, s[8:11], s39 offen sc1
  s_add_u32 s39, s37, 4352
  buffer_load_dwordx4 a[164:167], v5, s[8:11], s39 offen sc1
  s_lshl_b32 s39, s32, 9
  s_add_u32 s39, s39, s36
  s_add_u32 s39, s39, 0
  buffer_load_dwordx4 a[168:171], v5, s[8:11], s39 offen offset:0 sc1
  buffer_load_dwordx4 a[172:175], v5, s[8:11], s39 offen offset:256 sc1
  s_waitcnt vmcnt(0)
  v_mfma_f32_32x32x16_bf16 a[128:143], a[144:147], v[104:107], 0
  v_mfma_f32_32x32x16_bf16 a[128:143], a[148:151], v[108:111], a[128:143]
  v_mfma_f32_32x32x16_bf16 a[128:143], a[152:155], v[136:139], a[128:143]
  v_mfma_f32_32x32x16_bf16 a[128:143], a[156:159], v[140:143], a[128:143]
  v_mfma_f32_32x32x16_bf16 a[128:143], a[160:163], v[168:171], a[128:143]
  v_mfma_f32_32x32x16_bf16 a[128:143], a[164:167], v[172:175], a[128:143]
  s_cmp_eq_u32 s33, 0
  s_cbranch_scc0 L_x_nh0
  v_mfma_f32_32x32x16_bf16 a[128:143], a[168:171], v[200:203], a[128:143]
  v_mfma_f32_32x32x16_bf16 a[128:143], a[172:175], v[204:207], a[128:143]
L_x_nh0:
  s_nop 7
  s_nop 7
  ds_write_b128 v8, a[64:67] offset:0
  ds_write_b128 v8, a[68:71] offset:1024
  ds_write_b128 v8, a[72:75] offset:2048
  ds_write_b128 v8, a[76:79] offset:3072
  ds_write_b128 v8, a[128:131] offset:4096
  s_waitcnt lgkmcnt(0)
  s_barrier
  s_cmp_lg_u32 s3, 0
  s_nop 0
  s_cbranch_scc1 L_x_nf0
  v_add_u32 v11, 0, v1
  ds_read_b128 v[40:43], v11 offset:0
  ds_read_b128 v[44:47], v11 offset:1024
  ds_read_b128 v[48:51], v11 offset:2048
  ds_read_b128 v[52:55], v11 offset:3072
  ds_read_b128 v[56:59], v11 offset:4096
  ds_read_b128 v[60:63], v11 offset:5120
  ds_read_b128 v[64:67], v11 offset:6144
  ds_read_b128 v[68:71], v11 offset:7168
  ds_read_b128 v[72:75], v11 offset:8192
  ds_read_b128 v[76:79], v11 offset:9216
  s_waitcnt lgkmcnt(0)
  v_add_f32 v40, v40, v60
  v_add_f32 v41, v41, v61
  v_add_f32 v42, v42, v62
  v_add_f32 v43, v43, v63
  v_add_f32 v44, v44, v64
  v_add_f32 v45, v45, v65
  v_add_f32 v46, v46, v66
  v_add_f32 v47, v47, v67
  v_add_f32 v48, v48, v68
  v_add_f32 v49, v49, v69
  v_add_f32 v50, v50, v70
  v_add_f32 v51, v51, v71
  v_add_f32 v52, v52, v72
  v_add_f32 v53, v53, v73
  v_add_f32 v54, v54, v74
  v_add_f32 v55, v55, v75
  v_add_f32 v56, v56, v76
  v_add_f32 v57, v57, v77
  v_add_f32 v58, v58, v78
  v_add_f32 v59, v59, v79
  ds_read_b128 v[60:63], v11 offset:10240
  ds_read_b128 v[64:67], v11 offset:11264
  ds_read_b128 v[68:71], v11 offset:12288
  ds_read_b128 v[72:75], v11 offset:13312
  ds_read_b128 v[76:79], v11 offset:14336
  s_waitcnt lgkmcnt(0)
  v_add_f32 v40, v40, v60
  v_add_f32 v41, v41, v61
  v_add_f32 v42, v42, v62
  v_add_f32 v43, v43, v63
  v_add_f32 v44, v44, v64
  v_add_f32 v45, v45, v65
  v_add_f32 v46, v46, v66
  v_add_f32 v47, v47, v67
  v_add_f32 v48, v48, v68
  v_add_f32 v49, v49, v69
  v_add_f32 v50, v50, v70
  v_add_f32 v51, v51, v71
  v_add_f32 v52, v52, v72
  v_add_f32 v53, v53, v73
  v_add_f32 v54, v54, v74
  v_add_f32 v55, v55, v75
  v_add_f32 v56, v56, v76
  v_add_f32 v57, v57, v77
  v_add_f32 v58, v58, v78
  v_add_f32 v59, v59, v79
  ds_read_b128 v[60:63], v11 offset:15360
  ds_read_b128 v[64:67], v11 offset:16384
  ds_read_b128 v[68:71], v11 offset:17408
  ds_read_b128 v[72:75], v11 offset:18432
  ds_read_b128 v[76:79], v11 offset:19456
  s_waitcnt lgkmcnt(0)
  v_add_f32 v40, v40, v60
  v_add_f32 v41, v41, v61
  v_add_f32 v42, v42, v62
  v_add_f32 v43, v43, v63
  v_add_f32 v44, v44, v64
  v_add_f32 v45, v45, v65
  v_add_f32 v46, v46, v66
  v_add_f32 v47, v47, v67
  v_add_f32 v48, v48, v68
  v_add_f32 v49, v49, v69
  v_add_f32 v50, v50, v70
  v_add_f32 v51, v51, v71
  v_add_f32 v52, v52, v72
  v_add_f32 v53, v53, v73
  v_add_f32 v54, v54, v74
  v_add_f32 v55, v55, v75
  v_add_f32 v56, v56, v76
  v_add_f32 v57, v57, v77
  v_add_f32 v58, v58, v78
  v_add_f32 v59, v59, v79
  v_mov_b32 v12, 0xff800000
  v_cndmask_b32 v40, v40, v12, s[40:41]
  v_cndmask_b32 v41, v41, v12, s[42:43]
  v_cndmask_b32 v42, v42, v12, s[44:45]
  v_cndmask_b32 v43, v43, v12, s[46:47]
  v_cndmask_b32 v44, v44, v12, s[48:49]
  v_cndmask_b32 v45, v45, v12, s[50:51]
  v_cndmask_b32 v46, v46, v12, s[52:53]
  v_cndmask_b32 v47, v47, v12, s[54:55]
  v_cndmask_b32 v48, v48, v12, s[56:57]
  v_cndmask_b32 v49, v49, v12, s[58:59]
  v_cndmask_b32 v50, v50, v12, s[60:61]
  v_cndmask_b32 v51, v51, v12, s[62:63]
  v_cndmask_b32 v52, v52, v12, s[64:65]
  v_cndmask_b32 v53, v53, v12, s[66:67]
  v_cndmask_b32 v54, v54, v12, s[68:69]
  v_cndmask_b32 v55, v55, v12, s[70:71]
  v_max3_f32 v13, v40, v41, v42
  v_max3_f32 v13, v13, v43, v44
  v_max3_f32 v13, v13, v45, v46
  v_max3_f32 v13, v13, v47, v48
  v_max3_f32 v13, v13, v49, v50
  v_max3_f32 v13, v13, v51, v52
  v_max3_f32 v13, v13, v53, v54
  v_max3_f32 v13, v13, v55, v56
  v_max3_f32 v13, v13, v57, v58
  v_max_f32 v13, v13, v59
  v_mov_b32 v14, v13
  s_nop 1
  v_permlane32_swap_b32 v13, v14
  v_max_f32 v13, v13, v14
  v_sub_f32 v40, v40, v13
  v_sub_f32 v41, v41, v13
  v_sub_f32 v42, v42, v13
  v_sub_f32 v43, v43, v13
  v_sub_f32 v44, v44, v13
  v_sub_f32 v45, v45, v13
  v_sub_f32 v46, v46, v13
  v_sub_f32 v47, v47, v13
  v_sub_f32 v48, v48, v13
  v_sub_f32 v49, v49, v13
  v_sub_f32 v50, v50, v13
  v_sub_f32 v51, v51, v13
  v_sub_f32 v52, v52, v13
  v_sub_f32 v53, v53, v13
  v_sub_f32 v54, v54, v13
  v_sub_f32 v55, v55, v13
  v_sub_f32 v56, v56, v13
  v_sub_f32 v57, v57, v13
  v_sub_f32 v58, v58, v13
  v_sub_f32 v59, v59, v13
  v_exp_f32 v40, v40
  v_exp_f32 v41, v41
  v_exp_f32 v42, v42
  v_exp_f32 v43, v43
  v_exp_f32 v44, v44
  v_exp_f32 v45, v45
  v_exp_f32 v46, v46
  v_exp_f32 v47, v47
  v_exp_f32 v48, v48
  v_exp_f32 v49, v49
  v_exp_f32 v50, v50
  v_exp_f32 v51, v51
  v_exp_f32 v52, v52
  v_exp_f32 v53, v53
  v_exp_f32 v54, v54
  v_exp_f32 v55, v55
  v_exp_f32 v56, v56
  v_exp_f32 v57, v57
  v_exp_f32 v58, v58
  v_exp_f32 v59, v59
  v_add_f32 v13, v40, v41
  v_add_f32 v15, v42, v43
  v_add_f32 v13, v13, v44
  v_add_f32 v15, v15, v45
  v_add_f32 v13, v13, v46
  v_add_f32 v15, v15, v47
  v_add_f32 v13, v13, v48
  v_add_f32 v15, v15, v49
  v_add_f32 v13, v13, v50
  v_add_f32 v15, v15, v51
  v_add_f32 v13, v13, v52
  v_add_f32 v15, v15, v53
  v_add_f32 v13, v13, v54
  v_add_f32 v15, v15, v55
  v_add_f32 v13, v13, v56
  v_add_f32 v15, v15, v57
  v_add_f32 v13, v13, v58
  v_add_f32 v15, v15, v59
  v_add_f32 v13, v13, v15
  v_mov_b32 v14, v13
  s_nop 1
  v_permlane32_swap_b32 v13, v14
  v_add_f32 v13, v13, v14
  v_rcp_f32 v13, v13
  s_nop 0
  v_mul_f32 v40, v40, v13
  v_mul_f32 v41, v41, v13
  v_mul_f32 v42, v42, v13
  v_mul_f32 v43, v43, v13
  v_mul_f32 v44, v44, v13
  v_mul_f32 v45, v45, v13
  v_mul_f32 v46, v46, v13
  v_mul_f32 v47, v47, v13
  v_mul_f32 v48, v48, v13
  v_mul_f32 v49, v49, v13
  v_mul_f32 v50, v50, v13
  v_mul_f32 v51, v51, v13
  v_mul_f32 v52, v52, v13
  v_mul_f32 v53, v53, v13
  v_mul_f32 v54, v54, v13
  v_mul_f32 v55, v55, v13
  v_mul_f32 v56, v56, v13
  v_mul_f32 v57, v57, v13
  v_mul_f32 v58, v58, v13
  v_mul_f32 v59, v59, v13
  v_cvt_pk_bf16_f32 v64, v40, v41
  v_cvt_pk_bf16_f32 v65, v42, v43
  v_cvt_pk_bf16_f32 v66, v44, v45
  v_cvt_pk_bf16_f32 v67, v46, v47
  v_cvt_pk_bf16_f32 v68, v48, v49
  v_cvt_pk_bf16_f32 v69, v50, v51
  v_cvt_pk_bf16_f32 v70, v52, v53
  v_cvt_pk_bf16_f32 v71, v54, v55
  v_cvt_pk_bf16_f32 v72, v56, v57
  v_cvt_pk_bf16_f32 v73, v58, v59
  v_permlane32_swap_b32 v64, v66
  v_permlane32_swap_b32 v65, v67
  v_permlane32_swap_b32 v68, v70
  v_permlane32_swap_b32 v69, v71
  s_lshl_b32 s74, s24, 2
  s_add_u32 s74, s74, 0
  s_lshl_b32 s75, s74, 4
  s_add_u32 s75, s75, s20
  s_lshl_b32 s76, s75, 11
  s_add_u32 s76, s76, 57298944
  s_lshl_b32 s75, s75, 9
  s_add_u32 s75, s75, 5963776
  buffer_store_dwordx4 v[64:67], v4, s[8:11], s76 offen sc1
  buffer_store_dwordx4 v[68:71], v4, s[8:11], s76 offen offset:32 sc1
  buffer_store_dwordx2 v[72:73], v6, s[8:11], s75 offen sc1
  s_lshl_b32 s74, s74, 7
  s_add_u32 s74, s74, 49885184
L_x_nf0:
  s_lshl_b32 s73, s24, 2
  s_add_u32 s73, s73, 2
  s_lshl_b32 s73, s73, 4
  s_cmp_lg_u32 s3, 0
  s_cbranch_scc1 L_fc_xm1_j
  s_mov_b32 s77, 49883136
  s_mov_b32 s23, 0
L_fc_xm1:
  buffer_load_dword v10, off, s[8:11], s77 sc1
  s_add_u32 s23, s23, 1
  s_cmp_gt_u32 s23, 50000
  s_cbranch_scc1 L_w_fail
  s_waitcnt vmcnt(0)
  v_readfirstlane_b32 s22, v10
  s_nop 0
  s_cmp_ge_u32 s22, s73
  s_cbranch_scc1 L_fc_xm1_j
  s_sub_u32 s22, s73, s22
  s_lshr_b32 s22, s22, 4
  s_min_u32 s22, s22, 16
  s_cmp_lt_u32 s22, 2
  s_cbranch_scc1 L_fc_xm1_s
  s_sub_u32 s22, s22, 1
L_fc_xm1_l:
  s_sleep 44
  s_sub_u32 s22, s22, 1
  s_cmp_lg_u32 s22, 0
  s_cbranch_scc1 L_fc_xm1_l
  s_branch L_fc_xm1
L_fc_xm1_s:
  s_mov_b32 s22, s78
L_fc_xm1_r:
  s_sleep 4
  s_sub_u32 s22, s22, 1
  s_cmp_lg_u32 s22, 0
  s_cbranch_scc1 L_fc_xm1_r
  s_branch L_fc_xm1
L_fc_xm1_j:
  s_barrier
  s_lshl_b32 s37, s3, 9
  s_add_u32 s37, s37, s36
  s_add_u32 s37, s37, 7168
  s_add_u32 s39, s37, 0
  buffer_load_dwordx4 a[144:147], v5, s[8:11], s39 offen sc1
  s_add_u32 s39, s37, 256
  buffer_load_dwordx4 a[148:151], v5, s[8:11], s39 offen sc1
  s_add_u32 s39, s37, 2048
  buffer_load_dwordx4 a[152:155], v5, s[8:11], s39 offen sc1
  s_add_u32 s39, s37, 2304
  buffer_load_dwordx4 a[156:159], v5, s[8:11], s39 offen sc1
  s_add_u32 s39, s37, 4096
  buffer_load_dwordx4 a[160:163], v5, s[8:11], s39 offen sc1
  s_add_u32 s39, s37, 4352
  buffer_load_dwordx4 a[164:167], v5, s[8:11], s39 offen sc1
  s_lshl_b32 s39, s32, 9
  s_add_u32 s39, s39, s36
  s_add_u32 s39, s39, 7168
  buffer_load_dwordx4 a[168:171], v5, s[8:11], s39 offen offset:0 sc1
  buffer_load_dwordx4 a[172:175], v5, s[8:11], s39 offen offset:256 sc1
  s_waitcnt vmcnt(0)
  s_cmp_lg_u32 s3, 0
  s_cbranch_scc1 L_x_df1
  v_mov_b32 v16, 1
  s_mov_b64 exec, 1
  buffer_atomic_add v16, off, s[8:11], s74
  s_mov_b64 exec, -1
L_x_df1:
  v_mfma_f32_32x32x16_bf16 a[128:143], a[144:147], v[112:115], 0
  v_mfma_f32_32x32x16_bf16 a[128:143], a[148:151], v[116:119], a[128:143]
  v_mfma_f32_32x32x16_bf16 a[128:143], a[152:155], v[144:147], a[128:143]
  v_mfma_f32_32x32x16_bf16 a[128:143], a[156:159], v[148:151], a[128:143]
  v_mfma_f32_32x32x16_bf16 a[128:143], a[160:163], v[176:179], a[128:143]
  v_mfma_f32_32x32x16_bf16 a[128:143], a[164:167], v[180:183], a[128:143]
  s_cmp_eq_u32 s33, 0
  s_cbranch_scc0 L_x_nh1
  v_mfma_f32_32x32x16_bf16 a[128:143], a[168:171], v[208:211], a[128:143]
  v_mfma_f32_32x32x16_bf16 a[128:143], a[172:175], v[212:215], a[128:143]
L_x_nh1:
  s_nop 7
  s_nop 7
  ds_write_b128 v8, a[80:83] offset:20480
  ds_write_b128 v8, a[84:87] offset:21504
  ds_write_b128 v8, a[88:91] offset:22528
  ds_write_b128 v8, a[92:95] offset:23552
  ds_write_b128 v8, a[128:131] offset:24576
  s_waitcnt lgkmcnt(0)
  s_barrier
  s_cmp_lg_u32 s3, 1
  s_nop 0
  s_cbranch_scc1 L_x_nf1
  v_add_u32 v11, 20480, v1
  ds_read_b128 v[40:43], v11 offset:0
  ds_read_b128 v[44:47], v11 offset:1024
  ds_read_b128 v[48:51], v11 offset:2048
  ds_read_b128 v[52:55], v11 offset:3072
  ds_read_b128 v[56:59], v11 offset:4096
  ds_read_b128 v[60:63], v11 offset:5120
  ds_read_b128 v[64:67], v11 offset:6144
  ds_read_b128 v[68:71], v11 offset:7168
  ds_read_b128 v[72:75], v11 offset:8192
  ds_read_b128 v[76:79], v11 offset:9216
  s_waitcnt lgkmcnt(0)
  v_add_f32 v40, v40, v60
  v_add_f32 v41, v41, v61
  v_add_f32 v42, v42, v62
  v_add_f32 v43, v43, v63
  v_add_f32 v44, v44, v64
  v_add_f32 v45, v45, v65
  v_add_f32 v46, v46, v66
  v_add_f32 v47, v47, v67
  v_add_f32 v48, v48, v68
  v_add_f32 v49, v49, v69
  v_add_f32 v50, v50, v70
  v_add_f32 v51, v51, v71
  v_add_f32 v52, v52, v72
  v_add_f32 v53, v53, v73
  v_add_f32 v54, v54, v74
  v_add_f32 v55, v55, v75
  v_add_f32 v56, v56, v76
  v_add_f32 v57, v57, v77
  v_add_f32 v58, v58, v78
  v_add_f32 v59, v59, v79
  ds_read_b128 v[60:63], v11 offset:10240
  ds_read_b128 v[64:67], v11 offset:11264
  ds_read_b128 v[68:71], v11 offset:12288
  ds_read_b128 v[72:75], v11 offset:13312
  ds_read_b128 v[76:79], v11 offset:14336
  s_waitcnt lgkmcnt(0)
  v_add_f32 v40, v40, v60
  v_add_f32 v41, v41, v61
  v_add_f32 v42, v42, v62
  v_add_f32 v43, v43, v63
  v_add_f32 v44, v44, v64
  v_add_f32 v45, v45, v65
  v_add_f32 v46, v46, v66
  v_add_f32 v47, v47, v67
  v_add_f32 v48, v48, v68
  v_add_f32 v49, v49, v69
  v_add_f32 v50, v50, v70
  v_add_f32 v51, v51, v71
  v_add_f32 v52, v52, v72
  v_add_f32 v53, v53, v73
  v_add_f32 v54, v54, v74
  v_add_f32 v55, v55, v75
  v_add_f32 v56, v56, v76
  v_add_f32 v57, v57, v77
  v_add_f32 v58, v58, v78
  v_add_f32 v59, v59, v79
  ds_read_b128 v[60:63], v11 offset:15360
  ds_read_b128 v[64:67], v11 offset:16384
  ds_read_b128 v[68:71], v11 offset:17408
  ds_read_b128 v[72:75], v11 offset:18432
  ds_read_b128 v[76:79], v11 offset:19456
  s_waitcnt lgkmcnt(0)
  v_add_f32 v40, v40, v60
  v_add_f32 v41, v41, v61
  v_add_f32 v42, v42, v62
  v_add_f32 v43, v43, v63
  v_add_f32 v44, v44, v64
  v_add_f32 v45, v45, v65
  v_add_f32 v46, v46, v66
  v_add_f32 v47, v47, v67
  v_add_f32 v48, v48, v68
  v_add_f32 v49, v49, v69
  v_add_f32 v50, v50, v70
  v_add_f32 v51, v51, v71
  v_add_f32 v52, v52, v72
  v_add_f32 v53, v53, v73
  v_add_f32 v54, v54, v74
  v_add_f32 v55, v55, v75
  v_add_f32 v56, v56, v76
  v_add_f32 v57, v57, v77
  v_add_f32 v58, v58, v78
  v_add_f32 v59, v59, v79
  v_mov_b32 v12, 0xff800000
  v_cndmask_b32 v40, v40, v12, s[40:41]
  v_cndmask_b32 v41, v41, v12, s[42:43]
  v_cndmask_b32 v42, v42, v12, s[44:45]
  v_cndmask_b32 v43, v43, v12, s[46:47]
  v_cndmask_b32 v44, v44, v12, s[48:49]
  v_cndmask_b32 v45, v45, v12, s[50:51]
  v_cndmask_b32 v46, v46, v12, s[52:53]
  v_cndmask_b32 v47, v47, v12, s[54:55]
  v_cndmask_b32 v48, v48, v12, s[56:57]
  v_cndmask_b32 v49, v49, v12, s[58:59]
  v_cndmask_b32 v50, v50, v12, s[60:61]
  v_cndmask_b32 v51, v51, v12, s[62:63]
  v_cndmask_b32 v52, v52, v12, s[64:65]
  v_cndmask_b32 v53, v53, v12, s[66:67]
  v_cndmask_b32 v54, v54, v12, s[68:69]
  v_cndmask_b32 v55, v55, v12, s[70:71]
  v_max3_f32 v13, v40, v41, v42
  v_max3_f32 v13, v13, v43, v44
  v_max3_f32 v13, v13, v45, v46
  v_max3_f32 v13, v13, v47, v48
  v_max3_f32 v13, v13, v49, v50
  v_max3_f32 v13, v13, v51, v52
  v_max3_f32 v13, v13, v53, v54
  v_max3_f32 v13, v13, v55, v56
  v_max3_f32 v13, v13, v57, v58
  v_max_f32 v13, v13, v59
  v_mov_b32 v14, v13
  s_nop 1
  v_permlane32_swap_b32 v13, v14
  v_max_f32 v13, v13, v14
  v_sub_f32 v40, v40, v13
  v_sub_f32 v41, v41, v13
  v_sub_f32 v42, v42, v13
  v_sub_f32 v43, v43, v13
  v_sub_f32 v44, v44, v13
  v_sub_f32 v45, v45, v13
  v_sub_f32 v46, v46, v13
  v_sub_f32 v47, v47, v13
  v_sub_f32 v48, v48, v13
  v_sub_f32 v49, v49, v13
  v_sub_f32 v50, v50, v13
  v_sub_f32 v51, v51, v13
  v_sub_f32 v52, v52, v13
  v_sub_f32 v53, v53, v13
  v_sub_f32 v54, v54, v13
  v_sub_f32 v55, v55, v13
  v_sub_f32 v56, v56, v13
  v_sub_f32 v57, v57, v13
  v_sub_f32 v58, v58, v13
  v_sub_f32 v59, v59, v13
  v_exp_f32 v40, v40
  v_exp_f32 v41, v41
  v_exp_f32 v42, v42
  v_exp_f32 v43, v43
  v_exp_f32 v44, v44
  v_exp_f32 v45, v45
  v_exp_f32 v46, v46
  v_exp_f32 v47, v47
  v_exp_f32 v48, v48
  v_exp_f32 v49, v49
  v_exp_f32 v50, v50
  v_exp_f32 v51, v51
  v_exp_f32 v52, v52
  v_exp_f32 v53, v53
  v_exp_f32 v54, v54
  v_exp_f32 v55, v55
  v_exp_f32 v56, v56
  v_exp_f32 v57, v57
  v_exp_f32 v58, v58
  v_exp_f32 v59, v59
  v_add_f32 v13, v40, v41
  v_add_f32 v15, v42, v43
  v_add_f32 v13, v13, v44
  v_add_f32 v15, v15, v45
  v_add_f32 v13, v13, v46
  v_add_f32 v15, v15, v47
  v_add_f32 v13, v13, v48
  v_add_f32 v15, v15, v49
  v_add_f32 v13, v13, v50
  v_add_f32 v15, v15, v51
  v_add_f32 v13, v13, v52
  v_add_f32 v15, v15, v53
  v_add_f32 v13, v13, v54
  v_add_f32 v15, v15, v55
  v_add_f32 v13, v13, v56
  v_add_f32 v15, v15, v57
  v_add_f32 v13, v13, v58
  v_add_f32 v15, v15, v59
  v_add_f32 v13, v13, v15
  v_mov_b32 v14, v13
  s_nop 1
  v_permlane32_swap_b32 v13, v14
  v_add_f32 v13, v13, v14
  v_rcp_f32 v13, v13
  s_nop 0
  v_mul_f32 v40, v40, v13
  v_mul_f32 v41, v41, v13
  v_mul_f32 v42, v42, v13
  v_mul_f32 v43, v43, v13
  v_mul_f32 v44, v44, v13
  v_mul_f32 v45, v45, v13
  v_mul_f32 v46, v46, v13
  v_mul_f32 v47, v47, v13
  v_mul_f32 v48, v48, v13
  v_mul_f32 v49, v49, v13
  v_mul_f32 v50, v50, v13
  v_mul_f32 v51, v51, v13
  v_mul_f32 v52, v52, v13
  v_mul_f32 v53, v53, v13
  v_mul_f32 v54, v54, v13
  v_mul_f32 v55, v55, v13
  v_mul_f32 v56, v56, v13
  v_mul_f32 v57, v57, v13
  v_mul_f32 v58, v58, v13
  v_mul_f32 v59, v59, v13
  v_cvt_pk_bf16_f32 v64, v40, v41
  v_cvt_pk_bf16_f32 v65, v42, v43
  v_cvt_pk_bf16_f32 v66, v44, v45
  v_cvt_pk_bf16_f32 v67, v46, v47
  v_cvt_pk_bf16_f32 v68, v48, v49
  v_cvt_pk_bf16_f32 v69, v50, v51
  v_cvt_pk_bf16_f32 v70, v52, v53
  v_cvt_pk_bf16_f32 v71, v54, v55
  v_cvt_pk_bf16_f32 v72, v56, v57
  v_cvt_pk_bf16_f32 v73, v58, v59
  v_permlane32_swap_b32 v64, v66
  v_permlane32_swap_b32 v65, v67
  v_permlane32_swap_b32 v68, v70
  v_permlane32_swap_b32 v69, v71
  s_lshl_b32 s74, s24, 2
  s_add_u32 s74, s74, 1
  s_lshl_b32 s75, s74, 4
  s_add_u32 s75, s75, s20
  s_lshl_b32 s76, s75, 11
  s_add_u32 s76, s76, 57298944
  s_lshl_b32 s75, s75, 9
  s_add_u32 s75, s75, 5963776
  buffer_store_dwordx4 v[64:67], v4, s[8:11], s76 offen sc1
  buffer_store_dwordx4 v[68:71], v4, s[8:11], s76 offen offset:32 sc1
  buffer_store_dwordx2 v[72:73], v6, s[8:11], s75 offen sc1
  s_lshl_b32 s74, s74, 7
  s_add_u32 s74, s74, 49885184
L_x_nf1:
  s_lshl_b32 s73, s24, 2
  s_add_u32 s73, s73, 3
  s_lshl_b32 s73, s73, 4
  s_cmp_eq_u32 s24, 15
  s_nop 0
  s_cbranch_scc0 L_x_fc2
  s_mov_b32 s72, 49884160
  s_cmp_lg_u32 s3, 0
  s_cbranch_scc1 L_wf_xe2
  s_mov_b32 s23, 0
L_sp_xe2:
  buffer_load_dword v10, off, s[8:11], s72 sc1
  s_add_u32 s23, s23, 1
  s_cmp_gt_u32 s23, 50000
  s_cbranch_scc1 L_w_fail
  s_waitcnt vmcnt(0)
  v_readfirstlane_b32 s22, v10
  s_nop 0
  s_cmp_ge_u32 s22, 16
  s_cbranch_scc1 L_sp_xe2_ok
  s_sleep 1
  s_branch L_sp_xe2
L_sp_xe2_ok:
L_wf_xe2:
  s_barrier
  s_branch L_x_fe2
L_x_fc2:
  s_cmp_lg_u32 s3, 0
  s_cbranch_scc1 L_fc_xm2_j
  s_mov_b32 s77, 49883136
  s_mov_b32 s23, 0
L_fc_xm2:
  buffer_load_dword v10, off, s[8:11], s77 sc1
  s_add_u32 s23, s23, 1
  s_cmp_gt_u32 s23, 50000
  s_cbranch_scc1 L_w_fail
  s_waitcnt vmcnt(0)
  v_readfirstlane_b32 s22, v10
  s_nop 0
  s_cmp_ge_u32 s22, s73
  s_cbranch_scc1 L_fc_xm2_j
  s_sub_u32 s22, s73, s22
  s_lshr_b32 s22, s22, 4
  s_min_u32 s22, s22, 16
  s_cmp_lt_u32 s22, 2
  s_cbranch_scc1 L_fc_xm2_s
  s_sub_u32 s22, s22, 1
L_fc_xm2_l:
  s_sleep 44
  s_sub_u32 s22, s22, 1
  s_cmp_lg_u32 s22, 0
  s_cbranch_scc1 L_fc_xm2_l
  s_branch L_fc_xm2
L_fc_xm2_s:
  s_mov_b32 s22, s78
L_fc_xm2_r:
  s_sleep 4
  s_sub_u32 s22, s22, 1
  s_cmp_lg_u32 s22, 0
  s_cbranch_scc1 L_fc_xm2_r
  s_branch L_fc_xm2
L_fc_xm2_j:
  s_barrier
L_x_fe2:
  s_lshl_b32 s37, s3, 9
  s_add_u32 s37, s37, s36
  s_add_u32 s37, s37, 14336
  s_add_u32 s39, s37, 0
  buffer_load_dwordx4 a[144:147], v5, s[8:11], s39 offen sc1
  s_add_u32 s39, s37, 256
  buffer_load_dwordx4 a[148:151], v5, s[8:11], s39 offen sc1
  s_add_u32 s39, s37, 2048
  buffer_load_dwordx4 a[152:155], v5, s[8:11], s39 offen sc1
  s_add_u32 s39, s37, 2304
  buffer_load_dwordx4 a[156:159], v5, s[8:11], s39 offen sc1
  s_add_u32 s39, s37, 4096
  buffer_load_dwordx4 a[160:163], v5, s[8:11], s39 offen sc1
  s_add_u32 s39, s37, 4352
  buffer_load_dwordx4 a[164:167], v5, s[8:11], s39 offen sc1
  s_lshl_b32 s39, s32, 9
  s_add_u32 s39, s39, s36
  s_add_u32 s39, s39, 14336
  buffer_load_dwordx4 a[168:171], v5, s[8:11], s39 offen offset:0 sc1
  buffer_load_dwordx4 a[172:175], v5, s[8:11], s39 offen offset:256 sc1
  s_waitcnt vmcnt(0)
  s_cmp_lg_u32 s3, 1
  s_cbranch_scc1 L_x_df2
  v_mov_b32 v16, 1
  s_mov_b64 exec, 1
  buffer_atomic_add v16, off, s[8:11], s74
  s_mov_b64 exec, -1
L_x_df2:
  v_mfma_f32_32x32x16_bf16 a[128:143], a[144:147], v[120:123], 0
  v_mfma_f32_32x32x16_bf16 a[128:143], a[148:151], v[124:127], a[128:143]
  v_mfma_f32_32x32x16_bf16 a[128:143], a[152:155], v[152:155], a[128:143]
  v_mfma_f32_32x32x16_bf16 a[128:143], a[156:159], v[156:159], a[128:143]
  v_mfma_f32_32x32x16_bf16 a[128:143], a[160:163], v[184:187], a[128:143]
  v_mfma_f32_32x32x16_bf16 a[128:143], a[164:167], v[188:191], a[128:143]
  s_cmp_eq_u32 s33, 2
  s_cbranch_scc0 L_x_nh2
  v_mfma_f32_32x32x16_bf16 a[128:143], a[168:171], v[200:203], a[128:143]
  v_mfma_f32_32x32x16_bf16 a[128:143], a[172:175], v[204:207], a[128:143]
L_x_nh2:
  s_nop 7
  s_nop 7
  ds_write_b128 v9, a[96:99] offset:0
  ds_write_b128 v9, a[100:103] offset:1024
  ds_write_b128 v9, a[104:107] offset:2048
  ds_write_b128 v9, a[108:111] offset:3072
  ds_write_b128 v9, a[128:131] offset:4096
  s_waitcnt lgkmcnt(0)
  s_barrier
  s_cmp_lg_u32 s3, 2
  s_nop 0
  s_cbranch_scc1 L_x_nf2
  v_add_u32 v11, 40960, v1
  ds_read_b128 v[40:43], v11 offset:0
  ds_read_b128 v[44:47], v11 offset:1024
  ds_read_b128 v[48:51], v11 offset:2048
  ds_read_b128 v[52:55], v11 offset:3072
  ds_read_b128 v[56:59], v11 offset:4096
  ds_read_b128 v[60:63], v11 offset:5120
  ds_read_b128 v[64:67], v11 offset:6144
  ds_read_b128 v[68:71], v11 offset:7168
  ds_read_b128 v[72:75], v11 offset:8192
  ds_read_b128 v[76:79], v11 offset:9216
  s_waitcnt lgkmcnt(0)
  v_add_f32 v40, v40, v60
  v_add_f32 v41, v41, v61
  v_add_f32 v42, v42, v62
  v_add_f32 v43, v43, v63
  v_add_f32 v44, v44, v64
  v_add_f32 v45, v45, v65
  v_add_f32 v46, v46, v66
  v_add_f32 v47, v47, v67
  v_add_f32 v48, v48, v68
  v_add_f32 v49, v49, v69
  v_add_f32 v50, v50, v70
  v_add_f32 v51, v51, v71
  v_add_f32 v52, v52, v72
  v_add_f32 v53, v53, v73
  v_add_f32 v54, v54, v74
  v_add_f32 v55, v55, v75
  v_add_f32 v56, v56, v76
  v_add_f32 v57, v57, v77
  v_add_f32 v58, v58, v78
  v_add_f32 v59, v59, v79
  ds_read_b128 v[60:63], v11 offset:10240
  ds_read_b128 v[64:67], v11 offset:11264
  ds_read_b128 v[68:71], v11 offset:12288
  ds_read_b128 v[72:75], v11 offset:13312
  ds_read_b128 v[76:79], v11 offset:14336
  s_waitcnt lgkmcnt(0)
  v_add_f32 v40, v40, v60
  v_add_f32 v41, v41, v61
  v_add_f32 v42, v42, v62
  v_add_f32 v43, v43, v63
  v_add_f32 v44, v44, v64
  v_add_f32 v45, v45, v65
  v_add_f32 v46, v46, v66
  v_add_f32 v47, v47, v67
  v_add_f32 v48, v48, v68
  v_add_f32 v49, v49, v69
  v_add_f32 v50, v50, v70
  v_add_f32 v51, v51, v71
  v_add_f32 v52, v52, v72
  v_add_f32 v53, v53, v73
  v_add_f32 v54, v54, v74
  v_add_f32 v55, v55, v75
  v_add_f32 v56, v56, v76
  v_add_f32 v57, v57, v77
  v_add_f32 v58, v58, v78
  v_add_f32 v59, v59, v79
  ds_read_b128 v[60:63], v11 offset:15360
  ds_read_b128 v[64:67], v11 offset:16384
  ds_read_b128 v[68:71], v11 offset:17408
  ds_read_b128 v[72:75], v11 offset:18432
  ds_read_b128 v[76:79], v11 offset:19456
  s_waitcnt lgkmcnt(0)
  v_add_f32 v40, v40, v60
  v_add_f32 v41, v41, v61
  v_add_f32 v42, v42, v62
  v_add_f32 v43, v43, v63
  v_add_f32 v44, v44, v64
  v_add_f32 v45, v45, v65
  v_add_f32 v46, v46, v66
  v_add_f32 v47, v47, v67
  v_add_f32 v48, v48, v68
  v_add_f32 v49, v49, v69
  v_add_f32 v50, v50, v70
  v_add_f32 v51, v51, v71
  v_add_f32 v52, v52, v72
  v_add_f32 v53, v53, v73
  v_add_f32 v54, v54, v74
  v_add_f32 v55, v55, v75
  v_add_f32 v56, v56, v76
  v_add_f32 v57, v57, v77
  v_add_f32 v58, v58, v78
  v_add_f32 v59, v59, v79
  v_mov_b32 v12, 0xff800000
  v_cndmask_b32 v40, v40, v12, s[40:41]
  v_cndmask_b32 v41, v41, v12, s[42:43]
  v_cndmask_b32 v42, v42, v12, s[44:45]
  v_cndmask_b32 v43, v43, v12, s[46:47]
  v_cndmask_b32 v44, v44, v12, s[48:49]
  v_cndmask_b32 v45, v45, v12, s[50:51]
  v_cndmask_b32 v46, v46, v12, s[52:53]
  v_cndmask_b32 v47, v47, v12, s[54:55]
  v_cndmask_b32 v48, v48, v12, s[56:57]
  v_cndmask_b32 v49, v49, v12, s[58:59]
  v_cndmask_b32 v50, v50, v12, s[60:61]
  v_cndmask_b32 v51, v51, v12, s[62:63]
  v_cndmask_b32 v52, v52, v12, s[64:65]
  v_cndmask_b32 v53, v53, v12, s[66:67]
  v_cndmask_b32 v54, v54, v12, s[68:69]
  v_cndmask_b32 v55, v55, v12, s[70:71]
  v_max3_f32 v13, v40, v41, v42
  v_max3_f32 v13, v13, v43, v44
  v_max3_f32 v13, v13, v45, v46
  v_max3_f32 v13, v13, v47, v48
  v_max3_f32 v13, v13, v49, v50
  v_max3_f32 v13, v13, v51, v52
  v_max3_f32 v13, v13, v53, v54
  v_max3_f32 v13, v13, v55, v56
  v_max3_f32 v13, v13, v57, v58
  v_max_f32 v13, v13, v59
  v_mov_b32 v14, v13
  s_nop 1
  v_permlane32_swap_b32 v13, v14
  v_max_f32 v13, v13, v14
  v_sub_f32 v40, v40, v13
  v_sub_f32 v41, v41, v13
  v_sub_f32 v42, v42, v13
  v_sub_f32 v43, v43, v13
  v_sub_f32 v44, v44, v13
  v_sub_f32 v45, v45, v13
  v_sub_f32 v46, v46, v13
  v_sub_f32 v47, v47, v13
  v_sub_f32 v48, v48, v13
  v_sub_f32 v49, v49, v13
  v_sub_f32 v50, v50, v13
  v_sub_f32 v51, v51, v13
  v_sub_f32 v52, v52, v13
  v_sub_f32 v53, v53, v13
  v_sub_f32 v54, v54, v13
  v_sub_f32 v55, v55, v13
  v_sub_f32 v56, v56, v13
  v_sub_f32 v57, v57, v13
  v_sub_f32 v58, v58, v13
  v_sub_f32 v59, v59, v13
  v_exp_f32 v40, v40
  v_exp_f32 v41, v41
  v_exp_f32 v42, v42
  v_exp_f32 v43, v43
  v_exp_f32 v44, v44
  v_exp_f32 v45, v45
  v_exp_f32 v46, v46
  v_exp_f32 v47, v47
  v_exp_f32 v48, v48
  v_exp_f32 v49, v49
  v_exp_f32 v50, v50
  v_exp_f32 v51, v51
  v_exp_f32 v52, v52
  v_exp_f32 v53, v53
  v_exp_f32 v54, v54
  v_exp_f32 v55, v55
  v_exp_f32 v56, v56
  v_exp_f32 v57, v57
  v_exp_f32 v58, v58
  v_exp_f32 v59, v59
  v_add_f32 v13, v40, v41
  v_add_f32 v15, v42, v43
  v_add_f32 v13, v13, v44
  v_add_f32 v15, v15, v45
  v_add_f32 v13, v13, v46
  v_add_f32 v15, v15, v47
  v_add_f32 v13, v13, v48
  v_add_f32 v15, v15, v49
  v_add_f32 v13, v13, v50
  v_add_f32 v15, v15, v51
  v_add_f32 v13, v13, v52
  v_add_f32 v15, v15, v53
  v_add_f32 v13, v13, v54
  v_add_f32 v15, v15, v55
  v_add_f32 v13, v13, v56
  v_add_f32 v15, v15, v57
  v_add_f32 v13, v13, v58
  v_add_f32 v15, v15, v59
  v_add_f32 v13, v13, v15
  v_mov_b32 v14, v13
  s_nop 1
  v_permlane32_swap_b32 v13, v14
  v_add_f32 v13, v13, v14
  v_rcp_f32 v13, v13
  s_nop 0
  v_mul_f32 v40, v40, v13
  v_mul_f32 v41, v41, v13
  v_mul_f32 v42, v42, v13
  v_mul_f32 v43, v43, v13
  v_mul_f32 v44, v44, v13
  v_mul_f32 v45, v45, v13
  v_mul_f32 v46, v46, v13
  v_mul_f32 v47, v47, v13
  v_mul_f32 v48, v48, v13
  v_mul_f32 v49, v49, v13
  v_mul_f32 v50, v50, v13
  v_mul_f32 v51, v51, v13
  v_mul_f32 v52, v52, v13
  v_mul_f32 v53, v53, v13
  v_mul_f32 v54, v54, v13
  v_mul_f32 v55, v55, v13
  v_mul_f32 v56, v56, v13
  v_mul_f32 v57, v57, v13
  v_mul_f32 v58, v58, v13
  v_mul_f32 v59, v59, v13
  v_cvt_pk_bf16_f32 v64, v40, v41
  v_cvt_pk_bf16_f32 v65, v42, v43
  v_cvt_pk_bf16_f32 v66, v44, v45
  v_cvt_pk_bf16_f32 v67, v46, v47
  v_cvt_pk_bf16_f32 v68, v48, v49
  v_cvt_pk_bf16_f32 v69, v50, v51
  v_cvt_pk_bf16_f32 v70, v52, v53
  v_cvt_pk_bf16_f32 v71, v54, v55
  v_cvt_pk_bf16_f32 v72, v56, v57
  v_cvt_pk_bf16_f32 v73, v58, v59
  v_permlane32_swap_b32 v64, v66
  v_permlane32_swap_b32 v65, v67
  v_permlane32_swap_b32 v68, v70
  v_permlane32_swap_b32 v69, v71
  s_lshl_b32 s74, s24, 2
  s_add_u32 s74, s74, 2
  s_lshl_b32 s75, s74, 4
  s_add_u32 s75, s75, s20
  s_lshl_b32 s76, s75, 11
  s_add_u32 s76, s76, 57298944
  s_lshl_b32 s75, s75, 9
  s_add_u32 s75, s75, 5963776
  buffer_store_dwordx4 v[64:67], v4, s[8:11], s76 offen sc1
  buffer_store_dwordx4 v[68:71], v4, s[8:11], s76 offen offset:32 sc1
  buffer_store_dwordx2 v[72:73], v6, s[8:11], s75 offen sc1
  s_lshl_b32 s74, s74, 7
  s_add_u32 s74, s74, 49885184
L_x_nf2:
  s_lshl_b32 s73, s24, 2
  s_add_u32 s73, s73, 4
  s_lshl_b32 s73, s73, 4
  s_cmp_eq_u32 s24, 15
  s_nop 0
  s_cbranch_scc0 L_x_fc3
  s_mov_b32 s72, 49884288
  s_cmp_lg_u32 s3, 0
  s_cbranch_scc1 L_wf_xe3
  s_mov_b32 s23, 0
L_sp_xe3:
  buffer_load_dword v10, off, s[8:11], s72 sc1
  s_add_u32 s23, s23, 1
  s_cmp_gt_u32 s23, 50000
  s_cbranch_scc1 L_w_fail
  s_waitcnt vmcnt(0)
  v_readfirstlane_b32 s22, v10
  s_nop 0
  s_cmp_ge_u32 s22, 16
  s_cbranch_scc1 L_sp_xe3_ok
  s_sleep 1
  s_branch L_sp_xe3
L_sp_xe3_ok:
L_wf_xe3:
  s_barrier
  s_branch L_x_fe3
L_x_fc3:
  s_cmp_lg_u32 s3, 0
  s_cbranch_scc1 L_fc_xm3_j
  s_mov_b32 s77, 49883136
  s_mov_b32 s23, 0
L_fc_xm3:
  buffer_load_dword v10, off, s[8:11], s77 sc1
  s_add_u32 s23, s23, 1
  s_cmp_gt_u32 s23, 50000
  s_cbranch_scc1 L_w_fail
  s_waitcnt vmcnt(0)
  v_readfirstlane_b32 s22, v10
  s_nop 0
  s_cmp_ge_u32 s22, s73
  s_cbranch_scc1 L_fc_xm3_j
  s_sub_u32 s22, s73, s22
  s_lshr_b32 s22, s22, 4
  s_min_u32 s22, s22, 16
  s_cmp_lt_u32 s22, 2
  s_cbranch_scc1 L_fc_xm3_s
  s_sub_u32 s22, s22, 1
L_fc_xm3_l:
  s_sleep 44
  s_sub_u32 s22, s22, 1
  s_cmp_lg_u32 s22, 0
  s_cbranch_scc1 L_fc_xm3_l
  s_branch L_fc_xm3
L_fc_xm3_s:
  s_mov_b32 s22, s78
L_fc_xm3_r:
  s_sleep 4
  s_sub_u32 s22, s22, 1
  s_cmp_lg_u32 s22, 0
  s_cbranch_scc1 L_fc_xm3_r
  s_branch L_fc_xm3
L_fc_xm3_j:
  s_barrier
L_x_fe3:
  s_lshl_b32 s37, s3, 9
  s_add_u32 s37, s37, s36
  s_add_u32 s37, s37, 21504
  s_add_u32 s39, s37, 0
  buffer_load_dwordx4 a[144:147], v5, s[8:11], s39 offen sc1
  s_add_u32 s39, s37, 256
  buffer_load_dwordx4 a[148:151], v5, s[8:11], s39 offen sc1
  s_add_u32 s39, s37, 2048
  buffer_load_dwordx4 a[152:155], v5, s[8:11], s39 offen sc1
  s_add_u32 s39, s37, 2304
  buffer_load_dwordx4 a[156:159], v5, s[8:11], s39 offen sc1
  s_add_u32 s39, s37, 4096
  buffer_load_dwordx4 a[160:163], v5, s[8:11], s39 offen sc1
  s_add_u32 s39, s37, 4352
  buffer_load_dwordx4 a[164:167], v5, s[8:11], s39 offen sc1
  s_lshl_b32 s39, s32, 9
  s_add_u32 s39, s39, s36
  s_add_u32 s39, s39, 21504
  buffer_load_dwordx4 a[168:171], v5, s[8:11], s39 offen offset:0 sc1
  buffer_load_dwordx4 a[172:175], v5, s[8:11], s39 offen offset:256 sc1
  s_waitcnt vmcnt(0)
  s_cmp_lg_u32 s3, 2
  s_cbranch_scc1 L_x_df3
  v_mov_b32 v16, 1
  s_mov_b64 exec, 1
  buffer_atomic_add v16, off, s[8:11], s74
  s_mov_b64 exec, -1
L_x_df3:
  v_mfma_f32_32x32x16_bf16 a[128:143], a[144:147], v[128:131], 0
  v_mfma_f32_32x32x16_bf16 a[128:143], a[148:151], v[132:135], a[128:143]
  v_mfma_f32_32x32x16_bf16 a[128:143], a[152:155], v[160:163], a[128:143]
  v_mfma_f32_32x32x16_bf16 a[128:143], a[156:159], v[164:167], a[128:143]
  v_mfma_f32_32x32x16_bf16 a[128:143], a[160:163], v[192:195], a[128:143]
  v_mfma_f32_32x32x16_bf16 a[128:143], a[164:167], v[196:199], a[128:143]
  s_cmp_eq_u32 s33, 2
  s_cbranch_scc0 L_x_nh3
  v_mfma_f32_32x32x16_bf16 a[128:143], a[168:171], v[208:211], a[128:143]
  v_mfma_f32_32x32x16_bf16 a[128:143], a[172:175], v[212:215], a[128:143]
L_x_nh3:
  s_nop 7
  s_nop 7
  ds_write_b128 v9, a[112:115] offset:20480
  ds_write_b128 v9, a[116:119] offset:21504
  ds_write_b128 v9, a[120:123] offset:22528
  ds_write_b128 v9, a[124:127] offset:23552
  ds_write_b128 v9, a[128:131] offset:24576
  s_waitcnt lgkmcnt(0)
  s_barrier
  s_cmp_lg_u32 s3, 3
  s_cbranch_scc1 L_x_nf3
  v_add_u32 v11, 61440, v1
  ds_read_b128 v[40:43], v11 offset:0
  ds_read_b128 v[44:47], v11 offset:1024
  ds_read_b128 v[48:51], v11 offset:2048
  ds_read_b128 v[52:55], v11 offset:3072
  ds_read_b128 v[56:59], v11 offset:4096
  ds_read_b128 v[60:63], v11 offset:5120
  ds_read_b128 v[64:67], v11 offset:6144
  ds_read_b128 v[68:71], v11 offset:7168
  ds_read_b128 v[72:75], v11 offset:8192
  ds_read_b128 v[76:79], v11 offset:9216
  s_waitcnt lgkmcnt(0)
  v_add_f32 v40, v40, v60
  v_add_f32 v41, v41, v61
  v_add_f32 v42, v42, v62
  v_add_f32 v43, v43, v63
  v_add_f32 v44, v44, v64
  v_add_f32 v45, v45, v65
  v_add_f32 v46, v46, v66
  v_add_f32 v47, v47, v67
  v_add_f32 v48, v48, v68
  v_add_f32 v49, v49, v69
  v_add_f32 v50, v50, v70
  v_add_f32 v51, v51, v71
  v_add_f32 v52, v52, v72
  v_add_f32 v53, v53, v73
  v_add_f32 v54, v54, v74
  v_add_f32 v55, v55, v75
  v_add_f32 v56, v56, v76
  v_add_f32 v57, v57, v77
  v_add_f32 v58, v58, v78
  v_add_f32 v59, v59, v79
  ds_read_b128 v[60:63], v11 offset:10240
  ds_read_b128 v[64:67], v11 offset:11264
  ds_read_b128 v[68:71], v11 offset:12288
  ds_read_b128 v[72:75], v11 offset:13312
  ds_read_b128 v[76:79], v11 offset:14336
  s_waitcnt lgkmcnt(0)
  v_add_f32 v40, v40, v60
  v_add_f32 v41, v41, v61
  v_add_f32 v42, v42, v62
  v_add_f32 v43, v43, v63
  v_add_f32 v44, v44, v64
  v_add_f32 v45, v45, v65
  v_add_f32 v46, v46, v66
  v_add_f32 v47, v47, v67
  v_add_f32 v48, v48, v68
  v_add_f32 v49, v49, v69
  v_add_f32 v50, v50, v70
  v_add_f32 v51, v51, v71
  v_add_f32 v52, v52, v72
  v_add_f32 v53, v53, v73
  v_add_f32 v54, v54, v74
  v_add_f32 v55, v55, v75
  v_add_f32 v56, v56, v76
  v_add_f32 v57, v57, v77
  v_add_f32 v58, v58, v78
  v_add_f32 v59, v59, v79
  ds_read_b128 v[60:63], v11 offset:15360
  ds_read_b128 v[64:67], v11 offset:16384
  ds_read_b128 v[68:71], v11 offset:17408
  ds_read_b128 v[72:75], v11 offset:18432
  ds_read_b128 v[76:79], v11 offset:19456
  s_waitcnt lgkmcnt(0)
  v_add_f32 v40, v40, v60
  v_add_f32 v41, v41, v61
  v_add_f32 v42, v42, v62
  v_add_f32 v43, v43, v63
  v_add_f32 v44, v44, v64
  v_add_f32 v45, v45, v65
  v_add_f32 v46, v46, v66
  v_add_f32 v47, v47, v67
  v_add_f32 v48, v48, v68
  v_add_f32 v49, v49, v69
  v_add_f32 v50, v50, v70
  v_add_f32 v51, v51, v71
  v_add_f32 v52, v52, v72
  v_add_f32 v53, v53, v73
  v_add_f32 v54, v54, v74
  v_add_f32 v55, v55, v75
  v_add_f32 v56, v56, v76
  v_add_f32 v57, v57, v77
  v_add_f32 v58, v58, v78
  v_add_f32 v59, v59, v79
  v_mov_b32 v12, 0xff800000
  v_cndmask_b32 v40, v40, v12, s[40:41]
  v_cndmask_b32 v41, v41, v12, s[42:43]
  v_cndmask_b32 v42, v42, v12, s[44:45]
  v_cndmask_b32 v43, v43, v12, s[46:47]
  v_cndmask_b32 v44, v44, v12, s[48:49]
  v_cndmask_b32 v45, v45, v12, s[50:51]
  v_cndmask_b32 v46, v46, v12, s[52:53]
  v_cndmask_b32 v47, v47, v12, s[54:55]
  v_cndmask_b32 v48, v48, v12, s[56:57]
  v_cndmask_b32 v49, v49, v12, s[58:59]
  v_cndmask_b32 v50, v50, v12, s[60:61]
  v_cndmask_b32 v51, v51, v12, s[62:63]
  v_cndmask_b32 v52, v52, v12, s[64:65]
  v_cndmask_b32 v53, v53, v12, s[66:67]
  v_cndmask_b32 v54, v54, v12, s[68:69]
  v_cndmask_b32 v55, v55, v12, s[70:71]
  v_max3_f32 v13, v40, v41, v42
  v_max3_f32 v13, v13, v43, v44
  v_max3_f32 v13, v13, v45, v46
  v_max3_f32 v13, v13, v47, v48
  v_max3_f32 v13, v13, v49, v50
  v_max3_f32 v13, v13, v51, v52
  v_max3_f32 v13, v13, v53, v54
  v_max3_f32 v13, v13, v55, v56
  v_max3_f32 v13, v13, v57, v58
  v_max_f32 v13, v13, v59
  v_mov_b32 v14, v13
  s_nop 1
  v_permlane32_swap_b32 v13, v14
  v_max_f32 v13, v13, v14
  v_sub_f32 v40, v40, v13
  v_sub_f32 v41, v41, v13
  v_sub_f32 v42, v42, v13
  v_sub_f32 v43, v43, v13
  v_sub_f32 v44, v44, v13
  v_sub_f32 v45, v45, v13
  v_sub_f32 v46, v46, v13
  v_sub_f32 v47, v47, v13
  v_sub_f32 v48, v48, v13
  v_sub_f32 v49, v49, v13
  v_sub_f32 v50, v50, v13
  v_sub_f32 v51, v51, v13
  v_sub_f32 v52, v52, v13
  v_sub_f32 v53, v53, v13
  v_sub_f32 v54, v54, v13
  v_sub_f32 v55, v55, v13
  v_sub_f32 v56, v56, v13
  v_sub_f32 v57, v57, v13
  v_sub_f32 v58, v58, v13
  v_sub_f32 v59, v59, v13
  v_exp_f32 v40, v40
  v_exp_f32 v41, v41
  v_exp_f32 v42, v42
  v_exp_f32 v43, v43
  v_exp_f32 v44, v44
  v_exp_f32 v45, v45
  v_exp_f32 v46, v46
  v_exp_f32 v47, v47
  v_exp_f32 v48, v48
  v_exp_f32 v49, v49
  v_exp_f32 v50, v50
  v_exp_f32 v51, v51
  v_exp_f32 v52, v52
  v_exp_f32 v53, v53
  v_exp_f32 v54, v54
  v_exp_f32 v55, v55
  v_exp_f32 v56, v56
  v_exp_f32 v57, v57
  v_exp_f32 v58, v58
  v_exp_f32 v59, v59
  v_add_f32 v13, v40, v41
  v_add_f32 v15, v42, v43
  v_add_f32 v13, v13, v44
  v_add_f32 v15, v15, v45
  v_add_f32 v13, v13, v46
  v_add_f32 v15, v15, v47
  v_add_f32 v13, v13, v48
  v_add_f32 v15, v15, v49
  v_add_f32 v13, v13, v50
  v_add_f32 v15, v15, v51
  v_add_f32 v13, v13, v52
  v_add_f32 v15, v15, v53
  v_add_f32 v13, v13, v54
  v_add_f32 v15, v15, v55
  v_add_f32 v13, v13, v56
  v_add_f32 v15, v15, v57
  v_add_f32 v13, v13, v58
  v_add_f32 v15, v15, v59
  v_add_f32 v13, v13, v15
  v_mov_b32 v14, v13
  s_nop 1
  v_permlane32_swap_b32 v13, v14
  v_add_f32 v13, v13, v14
  v_rcp_f32 v13, v13
  s_nop 0
  v_mul_f32 v40, v40, v13
  v_mul_f32 v41, v41, v13
  v_mul_f32 v42, v42, v13
  v_mul_f32 v43, v43, v13
  v_mul_f32 v44, v44, v13
  v_mul_f32 v45, v45, v13
  v_mul_f32 v46, v46, v13
  v_mul_f32 v47, v47, v13
  v_mul_f32 v48, v48, v13
  v_mul_f32 v49, v49, v13
  v_mul_f32 v50, v50, v13
  v_mul_f32 v51, v51, v13
  v_mul_f32 v52, v52, v13
  v_mul_f32 v53, v53, v13
  v_mul_f32 v54, v54, v13
  v_mul_f32 v55, v55, v13
  v_mul_f32 v56, v56, v13
  v_mul_f32 v57, v57, v13
  v_mul_f32 v58, v58, v13
  v_mul_f32 v59, v59, v13
  v_cvt_pk_bf16_f32 v64, v40, v41
  v_cvt_pk_bf16_f32 v65, v42, v43
  v_cvt_pk_bf16_f32 v66, v44, v45
  v_cvt_pk_bf16_f32 v67, v46, v47
  v_cvt_pk_bf16_f32 v68, v48, v49
  v_cvt_pk_bf16_f32 v69, v50, v51
  v_cvt_pk_bf16_f32 v70, v52, v53
  v_cvt_pk_bf16_f32 v71, v54, v55
  v_cvt_pk_bf16_f32 v72, v56, v57
  v_cvt_pk_bf16_f32 v73, v58, v59
  v_permlane32_swap_b32 v64, v66
  v_permlane32_swap_b32 v65, v67
  v_permlane32_swap_b32 v68, v70
  v_permlane32_swap_b32 v69, v71
  s_lshl_b32 s74, s24, 2
  s_add_u32 s74, s74, 3
  s_lshl_b32 s75, s74, 4
  s_add_u32 s75, s75, s20
  s_lshl_b32 s76, s75, 11
  s_add_u32 s76, s76, 57298944
  s_lshl_b32 s75, s75, 9
  s_add_u32 s75, s75, 5963776
  buffer_store_dwordx4 v[64:67], v4, s[8:11], s76 offen sc1
  buffer_store_dwordx4 v[68:71], v4, s[8:11], s76 offen offset:32 sc1
  buffer_store_dwordx2 v[72:73], v6, s[8:11], s75 offen sc1
  s_lshl_b32 s74, s74, 7
  s_add_u32 s74, s74, 49885184
  v_mov_b32 v16, 1
  s_waitcnt vmcnt(0)
  s_mov_b64 exec, 1
  buffer_atomic_add v16, off, s[8:11], s74
  s_mov_b64 exec, -1
L_x_nf3:
  s_barrier
  s_add_u32 s92, s92, 3
  s_cmp_lt_u32 s92, 16
  s_cbranch_scc1 L_w_x
  s_branch L_w_g2pre
L_w_v:
  s_mov_b32 s73, 16
  s_cmp_lg_u32 s3, 0
  s_cbranch_scc1 L_fc_vs0_j
  s_mov_b32 s77, 49883136
  s_mov_b32 s23, 0
L_fc_vs0:
  buffer_load_dword v10, off, s[8:11], s77 sc1
  s_add_u32 s23, s23, 1
  s_cmp_gt_u32 s23, 50000
  s_cbranch_scc1 L_w_fail
  s_waitcnt vmcnt(0)
  v_readfirstlane_b32 s22, v10
  s_nop 0
  s_cmp_ge_u32 s22, s73
  s_cbranch_scc1 L_fc_vs0_j
  s_sub_u32 s22, s73, s22
  s_lshr_b32 s22, s22, 4
  s_min_u32 s22, s22, 16
  s_cmp_lt_u32 s22, 2
  s_cbranch_scc1 L_fc_vs0_s
  s_sub_u32 s22, s22, 1
L_fc_vs0_l:
  s_sleep 44
  s_sub_u32 s22, s22, 1
  s_cmp_lg_u32 s22, 0
  s_cbranch_scc1 L_fc_vs0_l
  s_branch L_fc_vs0
L_fc_vs0_s:
  s_sleep 40
  s_branch L_fc_vs0
L_fc_vs0_j:
  s_barrier
  s_sub_u32 s91, s90, 160
L_w_t:
  s_mov_b32 s20, s91
  s_cmp_ge_u32 s91, 224
  s_cbranch_scc1 L_w_t2
  s_load_dwordx2 s[16:17], s[0:1], 64
  s_waitcnt lgkmcnt(0)
  s_mov_b32 s12, s16
  s_mov_b32 s13, s17
  s_mov_b32 s14, 7340032
  s_mov_b32 s15, 0x00020000
  s_mul_hi_u32 s26, s20, 613566757
  s_mul_i32 s21, s26, 7
  s_sub_u32 s27, s20, s21
  v_lshrrev_b32 v1, 5, v0
  v_and_b32 v2, 31, v0
  s_lshl_b32 s21, s3, 4
  v_add_u32 v1, s21, v1
  v_mul_u32_u24 v3, 3584, v1
  v_lshl_add_u32 v3, v2, 4, v3
  s_mul_i32 s21, s26, 229376
  s_lshl_b32 s22, s27, 9
  s_add_u32 s21, s21, s22
  s_add_u32 s22, s21, 0
  buffer_load_dwordx4 v[8:11], v3, s[12:15], s22 offen
  s_add_u32 s22, s21, 7168
  buffer_load_dwordx4 v[12:15], v3, s[12:15], s22 offen
  s_add_u32 s22, s21, 14336
  buffer_load_dwordx4 v[16:19], v3, s[12:15], s22 offen
  s_add_u32 s22, s21, 21504
  buffer_load_dwordx4 v[20:23], v3, s[12:15], s22 offen
  s_add_u32 s22, s21, 28672
  buffer_load_dwordx4 v[24:27], v3, s[12:15], s22 offen
  s_add_u32 s22, s21, 35840
  buffer_load_dwordx4 v[28:31], v3, s[12:15], s22 offen
  s_add_u32 s22, s21, 43008
  buffer_load_dwordx4 v[32:35], v3, s[12:15], s22 offen
  s_add_u32 s22, s21, 50176
  buffer_load_dwordx4 v[36:39], v3, s[12:15], s22 offen
  v_mul_u32_u24 v1, 528, v1
  v_lshl_add_u32 v1, v2, 4, v1
  s_waitcnt vmcnt(0)
  ds_write_b128 v1, v[8:11] offset:0
  ds_write_b128 v1, v[12:15] offset:1056
  ds_write_b128 v1, v[16:19] offset:2112
  ds_write_b128 v1, v[20:23] offset:3168
  ds_write_b128 v1, v[24:27] offset:4224
  ds_write_b128 v1, v[28:31] offset:5280
  ds_write_b128 v1, v[32:35] offset:6336
  ds_write_b128 v1, v[36:39] offset:7392
  s_waitcnt lgkmcnt(0)
  s_barrier
  v_lshrrev_b32 v4, 4, v0
  v_and_b32 v5, 15, v0
  v_lshrrev_b32 v6, 1, v4
  v_lshlrev_b32 v6, 3, v6
  v_lshrrev_b32 v7, 2, v5
  v_add_u32 v6, v6, v7
  v_mul_u32_u24 v6, 528, v6
  v_and_b32 v7, 1, v4
  v_lshl_add_u32 v6, v7, 5, v6
  v_and_b32 v7, 3, v5
  v_lshl_add_u32 v6, v7, 3, v6
  s_lshl_b32 s21, s3, 7
  v_add_u32 v6, s21, v6
  v_lshlrev_b32 v7, 4, v0
  s_lshl_b32 s21, s27, 3
  s_lshl_b32 s22, s3, 1
  s_add_u32 s21, s21, s22
  s_mul_i32 s21, s21, 131072
  s_lshl_b32 s22, s26, 12
  s_add_u32 s21, s21, s22
  s_add_u32 s21, s21, 66768896
  ds_read_b64_tr_b16 v[8:9], v6 offset:0
  ds_read_b64_tr_b16 v[10:11], v6 offset:2112
  s_waitcnt lgkmcnt(0)
  s_add_u32 s22, s21, 0
  buffer_store_dwordx4 v[8:11], v7, s[8:11], s22 offen sc1
  ds_read_b64_tr_b16 v[12:13], v6 offset:8448
  ds_read_b64_tr_b16 v[14:15], v6 offset:10560
  s_waitcnt lgkmcnt(0)
  s_add_u32 s22, s21, 1024
  buffer_store_dwordx4 v[12:15], v7, s[8:11], s22 offen sc1
  ds_read_b64_tr_b16 v[16:17], v6 offset:16896
  ds_read_b64_tr_b16 v[18:19], v6 offset:19008
  s_waitcnt lgkmcnt(0)
  s_add_u32 s22, s21, 2048
  buffer_store_dwordx4 v[16:19], v7, s[8:11], s22 offen sc1
  ds_read_b64_tr_b16 v[20:21], v6 offset:25344
  ds_read_b64_tr_b16 v[22:23], v6 offset:27456
  s_waitcnt lgkmcnt(0)
  s_add_u32 s22, s21, 3072
  buffer_store_dwordx4 v[20:23], v7, s[8:11], s22 offen sc1
  ds_read_b64_tr_b16 v[24:25], v6 offset:64
  ds_read_b64_tr_b16 v[26:27], v6 offset:2176
  s_waitcnt lgkmcnt(0)
  s_add_u32 s22, s21, 131072
  buffer_store_dwordx4 v[24:27], v7, s[8:11], s22 offen sc1
  ds_read_b64_tr_b16 v[28:29], v6 offset:8512
  ds_read_b64_tr_b16 v[30:31], v6 offset:10624
  s_waitcnt lgkmcnt(0)
  s_add_u32 s22, s21, 132096
  buffer_store_dwordx4 v[28:31], v7, s[8:11], s22 offen sc1
  ds_read_b64_tr_b16 v[32:33], v6 offset:16960
  ds_read_b64_tr_b16 v[34:35], v6 offset:19072
  s_waitcnt lgkmcnt(0)
  s_add_u32 s22, s21, 133120
  buffer_store_dwordx4 v[32:35], v7, s[8:11], s22 offen sc1
  ds_read_b64_tr_b16 v[36:37], v6 offset:25408
  ds_read_b64_tr_b16 v[38:39], v6 offset:27520
  s_waitcnt lgkmcnt(0)
  s_add_u32 s22, s21, 134144
  buffer_store_dwordx4 v[36:39], v7, s[8:11], s22 offen sc1
  s_mov_b32 s72, 49883776
  s_waitcnt vmcnt(0)
  s_barrier
  s_cmp_lg_u32 s3, 0
  s_cbranch_scc1 L_fa_t1
  v_mov_b32 v40, 1
  s_mov_b64 exec, 1
  buffer_atomic_add v40, off, s[8:11], s72
  s_mov_b64 exec, -1
L_fa_t1:
  s_branch L_w_tn
L_w_t2:
  s_sub_u32 s20, s91, 224
  s_load_dwordx2 s[16:17], s[0:1], 80
  s_waitcnt lgkmcnt(0)
  s_mov_b32 s12, s16
  s_mov_b32 s13, s17
  s_mov_b32 s14, 7340032
  s_mov_b32 s15, 0x00020000
  s_mul_hi_u32 s26, s20, 536870912
  s_mul_i32 s21, s26, 8
  s_sub_u32 s27, s20, s21
  v_lshrrev_b32 v1, 5, v0
  v_and_b32 v2, 31, v0
  s_lshl_b32 s21, s3, 4
  v_add_u32 v1, s21, v1
  v_mul_u32_u24 v3, 4096, v1
  v_lshl_add_u32 v3, v2, 4, v3
  s_mul_i32 s21, s26, 262144
  s_lshl_b32 s22, s27, 9
  s_add_u32 s21, s21, s22
  s_add_u32 s22, s21, 0
  buffer_load_dwordx4 v[8:11], v3, s[12:15], s22 offen
  s_add_u32 s22, s21, 8192
  buffer_load_dwordx4 v[12:15], v3, s[12:15], s22 offen
  s_add_u32 s22, s21, 16384
  buffer_load_dwordx4 v[16:19], v3, s[12:15], s22 offen
  s_add_u32 s22, s21, 24576
  buffer_load_dwordx4 v[20:23], v3, s[12:15], s22 offen
  s_add_u32 s22, s21, 32768
  buffer_load_dwordx4 v[24:27], v3, s[12:15], s22 offen
  s_add_u32 s22, s21, 40960
  buffer_load_dwordx4 v[28:31], v3, s[12:15], s22 offen
  s_add_u32 s22, s21, 49152
  buffer_load_dwordx4 v[32:35], v3, s[12:15], s22 offen
  s_add_u32 s22, s21, 57344
  buffer_load_dwordx4 v[36:39], v3, s[12:15], s22 offen
  v_mul_u32_u24 v1, 528, v1
  v_lshl_add_u32 v1, v2, 4, v1
  s_waitcnt vmcnt(0)
  ds_write_b128 v1, v[8:11] offset:0
  ds_write_b128 v1, v[12:15] offset:1056
  ds_write_b128 v1, v[16:19] offset:2112
  ds_write_b128 v1, v[20:23] offset:3168
  ds_write_b128 v1, v[24:27] offset:4224
  ds_write_b128 v1, v[28:31] offset:5280
  ds_write_b128 v1, v[32:35] offset:6336
  ds_write_b128 v1, v[36:39] offset:7392
  s_waitcnt lgkmcnt(0)
  s_barrier
  v_lshrrev_b32 v4, 4, v0
  v_and_b32 v5, 15, v0
  v_lshrrev_b32 v6, 1, v4
  v_lshlrev_b32 v6, 3, v6
  v_lshrrev_b32 v7, 2, v5
  v_add_u32 v6, v6, v7
  v_mul_u32_u24 v6, 528, v6
  v_and_b32 v7, 1, v4
  v_lshl_add_u32 v6, v7, 5, v6
  v_and_b32 v7, 3, v5
  v_lshl_add_u32 v6, v7, 3, v6
  s_lshl_b32 s21, s3, 7
  v_add_u32 v6, s21, v6
  v_lshlrev_b32 v7, 4, v0
  s_lshl_b32 s21, s27, 3
  s_lshl_b32 s22, s3, 1
  s_add_u32 s21, s21, s22
  s_mul_i32 s21, s21, 114688
  s_lshl_b32 s22, s26, 12
  s_add_u32 s21, s21, s22
  s_add_u32 s21, s21, 74108928
  ds_read_b64_tr_b16 v[8:9], v6 offset:0
  ds_read_b64_tr_b16 v[10:11], v6 offset:2112
  s_waitcnt lgkmcnt(0)
  s_add_u32 s22, s21, 0
  buffer_store_dwordx4 v[8:11], v7, s[8:11], s22 offen sc1
  ds_read_b64_tr_b16 v[12:13], v6 offset:8448
  ds_read_b64_tr_b16 v[14:15], v6 offset:10560
  s_waitcnt lgkmcnt(0)
  s_add_u32 s22, s21, 1024
  buffer_store_dwordx4 v[12:15], v7, s[8:11], s22 offen sc1
  ds_read_b64_tr_b16 v[16:17], v6 offset:16896
  ds_read_b64_tr_b16 v[18:19], v6 offset:19008
  s_waitcnt lgkmcnt(0)
  s_add_u32 s22, s21, 2048
  buffer_store_dwordx4 v[16:19], v7, s[8:11], s22 offen sc1
  ds_read_b64_tr_b16 v[20:21], v6 offset:25344
  ds_read_b64_tr_b16 v[22:23], v6 offset:27456
  s_waitcnt lgkmcnt(0)
  s_add_u32 s22, s21, 3072
  buffer_store_dwordx4 v[20:23], v7, s[8:11], s22 offen sc1
  ds_read_b64_tr_b16 v[24:25], v6 offset:64
  ds_read_b64_tr_b16 v[26:27], v6 offset:2176
  s_waitcnt lgkmcnt(0)
  s_add_u32 s22, s21, 114688
  buffer_store_dwordx4 v[24:27], v7, s[8:11], s22 offen sc1
  ds_read_b64_tr_b16 v[28:29], v6 offset:8512
  ds_read_b64_tr_b16 v[30:31], v6 offset:10624
  s_waitcnt lgkmcnt(0)
  s_add_u32 s22, s21, 115712
  buffer_store_dwordx4 v[28:31], v7, s[8:11], s22 offen sc1
  ds_read_b64_tr_b16 v[32:33], v6 offset:16960
  ds_read_b64_tr_b16 v[34:35], v6 offset:19072
  s_waitcnt lgkmcnt(0)
  s_add_u32 s22, s21, 116736
  buffer_store_dwordx4 v[32:35], v7, s[8:11], s22 offen sc1
  ds_read_b64_tr_b16 v[36:37], v6 offset:25408
  ds_read_b64_tr_b16 v[38:39], v6 offset:27520
  s_waitcnt lgkmcnt(0)
  s_add_u32 s22, s21, 117760
  buffer_store_dwordx4 v[36:39], v7, s[8:11], s22 offen sc1
  s_mov_b32 s72, 49883904
  s_waitcnt vmcnt(0)
  s_barrier
  s_cmp_lg_u32 s3, 0
  s_cbranch_scc1 L_fa_t2
  v_mov_b32 v40, 1
  s_mov_b64 exec, 1
  buffer_atomic_add v40, off, s[8:11], s72
  s_mov_b64 exec, -1
L_fa_t2:
L_w_tn:
  s_add_u32 s91, s91, 32
  s_cmp_lt_u32 s91, 448
  s_cbranch_scc1 L_w_t
  s_sub_u32 s92, s90, 160
  s_and_b32 s93, s92, 15
  s_lshr_b32 s92, s92, 4
L_w_v2:
  s_lshl_b32 s20, s92, 2
  s_lshr_b32 s21, s93, 2
  s_add_u32 s20, s20, s21
  s_and_b32 s21, s93, 3
  s_load_dwordx2 s[16:17], s[0:1], 0
  s_waitcnt lgkmcnt(0)
  s_mov_b32 s12, s16
  s_mov_b32 s13, s17
  s_mov_b32 s14, 1835008
  s_mov_b32 s15, 0x00020000
  s_lshl_b32 s24, s21, 2
  s_add_u32 s24, s24, s3
  v_lshlrev_b32 v1, 4, v0
  v_and_b32 v200, 15, v0
  v_lshrrev_b32 v201, 4, v0
  v_lshlrev_b32 v2, 6, v200
  v_lshl_add_u32 v2, v201, 4, v2
  v_lshlrev_b32 v3, 9, v201
  v_lshl_add_u32 v3, v200, 4, v3
  s_lshl_b32 s27, s20, 4
  s_add_u32 s27, s27, s24
  s_mul_i32 s28, s27, 28672
  s_add_u32 s28, s28, 19398656
  s_mul_i32 s29, s27, 7168
  s_add_u32 s29, s29, 49954816
  v_mul_u32_u24 v4, 28, v201
  v_add_u32 v4, v4, v200
  v_lshlrev_b32 v4, 4, v4
  s_mov_b32 s62, 0x0fff0fff
  s_mov_b32 s63, 0x0fff0fff
  s_lshr_b32 s72, s20, 2
  s_lshl_b32 s72, s72, 4
  s_add_u32 s72, s72, s24
  s_lshl_b32 s72, s72, 7
  s_add_u32 s72, s72, 49913856
  s_min_u32 s73, s20, 60
  s_lshl_b32 s73, s73, 4
  s_cmp_lg_u32 s3, 0
  s_nop 0
  s_cbranch_scc1 L_fc_vp_j
  s_mov_b32 s77, 49883136
  s_mov_b32 s23, 0
L_fc_vp:
  buffer_load_dword v207, off, s[8:11], s77 sc1
  s_add_u32 s23, s23, 1
  s_cmp_gt_u32 s23, 50000
  s_cbranch_scc1 L_w_fail
  s_waitcnt vmcnt(0)
  v_readfirstlane_b32 s22, v207
  s_nop 0
  s_cmp_ge_u32 s22, s73
  s_nop 0
  s_cbranch_scc1 L_fc_vp_j
  s_sub_u32 s22, s73, s22
  s_lshr_b32 s22, s22, 4
  s_min_u32 s22, s22, 16
  s_cmp_lt_u32 s22, 2
  s_cbranch_scc1 L_fc_vp_s
  s_sub_u32 s22, s22, 1
L_fc_vp_l:
  s_sleep 44
  s_sub_u32 s22, s22, 1
  s_cmp_lg_u32 s22, 0
  s_cbranch_scc1 L_fc_vp_l
  s_branch L_fc_vp
L_fc_vp_s:
  s_sleep 32
  s_branch L_fc_vp
L_fc_vp_j:
  s_barrier
  s_mov_b32 s23, 0
L_sp_vu:
  buffer_load_dword v207, off, s[8:11], s72 sc1
  s_add_u32 s23, s23, 1
  s_cmp_gt_u32 s23, 50000
  s_cbranch_scc1 L_w_fail
  s_waitcnt vmcnt(0)
  v_readfirstlane_b32 s22, v207
  s_nop 0
  s_cmp_ge_u32 s22, 7
  s_cbranch_scc1 L_sp_vu_ok
  s_sleep 8
  s_branch L_sp_vu
L_sp_vu_ok:
  s_add_u32 s33, s28, 0
  buffer_load_dwordx4 v[40:43], v2, s[8:11], s33 offen sc1
  s_add_u32 s33, s28, 1792
  buffer_load_dwordx4 v[48:51], v2, s[8:11], s33 offen sc1
  s_add_u32 s33, s28, 3584
  buffer_load_dwordx4 v[56:59], v2, s[8:11], s33 offen sc1
  s_add_u32 s33, s28, 5376
  buffer_load_dwordx4 v[64:67], v2, s[8:11], s33 offen sc1
  s_add_u32 s33, s28, 7168
  buffer_load_dwordx4 v[72:75], v2, s[8:11], s33 offen sc1
  s_add_u32 s33, s28, 8960
  buffer_load_dwordx4 v[80:83], v2, s[8:11], s33 offen sc1
  s_add_u32 s33, s28, 10752
  buffer_load_dwordx4 v[88:91], v2, s[8:11], s33 offen sc1
  s_add_u32 s33, s28, 12544
  buffer_load_dwordx4 v[96:99], v2, s[8:11], s33 offen sc1
  s_add_u32 s33, s28, 14336
  buffer_load_dwordx4 v[104:107], v2, s[8:11], s33 offen sc1
  s_add_u32 s33, s28, 16128
  buffer_load_dwordx4 v[112:115], v2, s[8:11], s33 offen sc1
  s_add_u32 s33, s28, 17920
  buffer_load_dwordx4 v[120:123], v2, s[8:11], s33 offen sc1
  s_add_u32 s33, s28, 19712
  buffer_load_dwordx4 v[128:131], v2, s[8:11], s33 offen sc1
  s_add_u32 s33, s28, 21504
  buffer_load_dwordx4 v[136:139], v2, s[8:11], s33 offen sc1
  s_add_u32 s33, s28, 23296
  buffer_load_dwordx4 v[144:147], v2, s[8:11], s33 offen sc1
  s_add_u32 s33, s28, 25088
  buffer_load_dwordx4 v[152:155], v2, s[8:11], s33 offen sc1
  s_add_u32 s33, s28, 26880
  buffer_load_dwordx4 v[160:163], v2, s[8:11], s33 offen sc1
  s_mov_b64 exec, s[62:63]
  s_add_u32 s33, s28, 1024
  buffer_load_dwordx4 v[44:47], v2, s[8:11], s33 offen sc1
  s_add_u32 s33, s28, 2816
  buffer_load_dwordx4 v[52:55], v2, s[8:11], s33 offen sc1
  s_add_u32 s33, s28, 4608
  buffer_load_dwordx4 v[60:63], v2, s[8:11], s33 offen sc1
  s_add_u32 s33, s28, 6400
  buffer_load_dwordx4 v[68:71], v2, s[8:11], s33 offen sc1
  s_add_u32 s33, s28, 8192
  buffer_load_dwordx4 v[76:79], v2, s[8:11], s33 offen sc1
  s_add_u32 s33, s28, 9984
  buffer_load_dwordx4 v[84:87], v2, s[8:11], s33 offen sc1
  s_add_u32 s33, s28, 11776
  buffer_load_dwordx4 v[92:95], v2, s[8:11], s33 offen sc1
  s_add_u32 s33, s28, 13568
  buffer_load_dwordx4 v[100:103], v2, s[8:11], s33 offen sc1
  s_add_u32 s33, s28, 15360
  buffer_load_dwordx4 v[108:111], v2, s[8:11], s33 offen sc1
  s_add_u32 s33, s28, 17152
  buffer_load_dwordx4 v[116:119], v2, s[8:11], s33 offen sc1
  s_add_u32 s33, s28, 18944
  buffer_load_dwordx4 v[124:127], v2, s[8:11], s33 offen sc1
  s_add_u32 s33, s28, 20736
  buffer_load_dwordx4 v[132:135], v2, s[8:11], s33 offen sc1
  s_add_u32 s33, s28, 22528
  buffer_load_dwordx4 v[140:143], v2, s[8:11], s33 offen sc1
  s_add_u32 s33, s28, 24320
  buffer_load_dwordx4 v[148:151], v2, s[8:11], s33 offen sc1
  s_add_u32 s33, s28, 26112
  buffer_load_dwordx4 v[156:159], v2, s[8:11], s33 offen sc1
  s_add_u32 s33, s28, 27904
  buffer_load_dwordx4 v[164:167], v2, s[8:11], s33 offen sc1
  s_mov_b64 exec, -1
  s_lshl_b32 s27, s3, 3
  v_lshrrev_b32 v202, 3, v0
  v_add_u32 v202, s27, v202
  s_lshl_b32 s27, s20, 5
  v_add_u32 v202, s27, v202
  v_mul_u32_u24 v202, 896, v202
  v_and_b32 v203, 7, v0
  v_mul_u32_u24 v203, 28, v203
  v_add_u32 v202, v202, v203
  s_mul_i32 s27, s21, 224
  v_add_u32 v202, s27, v202
  buffer_load_dwordx4 v[208:211], v202, s[12:15], 0 offen
  buffer_load_dwordx3 v[212:214], v202, s[12:15], 0 offen offset:16
  s_mul_i32 s27, s24, 28
  s_mul_i32 s30, s21, 112
  v_add_u32 v202, 0, v200
  v_min_u32 v202, 27, v202
  v_add_u32 v202, s27, v202
  v_and_b32 v203, 15, v202
  v_sub_u32 v202, v202, v203
  v_lshrrev_b32 v204, 3, v203
  v_and_b32 v205, 7, v203
  v_lshrrev_b32 v206, 1, v205
  v_lshl_add_u32 v202, v206, 2, v202
  v_lshl_add_u32 v202, v204, 1, v202
  v_and_b32 v205, 1, v205
  v_add_u32 v202, v202, v205
  v_subrev_u32 v202, s30, v202
  v_lshlrev_b32 v202, 2, v202
  v_mul_u32_u24 v203, 1856, v201
  v_add_u32 v5, v202, v203
  v_add_u32 v5, 40960, v5
  v_add_u32 v202, 16, v200
  v_min_u32 v202, 27, v202
  v_add_u32 v202, s27, v202
  v_and_b32 v203, 15, v202
  v_sub_u32 v202, v202, v203
  v_lshrrev_b32 v204, 3, v203
  v_and_b32 v205, 7, v203
  v_lshrrev_b32 v206, 1, v205
  v_lshl_add_u32 v202, v206, 2, v202
  v_lshl_add_u32 v202, v204, 1, v202
  v_and_b32 v205, 1, v205
  v_add_u32 v202, v202, v205
  v_subrev_u32 v202, s30, v202
  v_lshlrev_b32 v202, 2, v202
  v_mul_u32_u24 v203, 1856, v201
  v_add_u32 v6, v202, v203
  v_add_u32 v6, 40960, v6
  v_mov_b32 v8, 0
  v_mov_b32 v9, 0
  v_mov_b32 v10, 0
  v_mov_b32 v11, 0
  v_mov_b32 v12, 0
  v_mov_b32 v13, 0
  v_mov_b32 v14, 0
  v_mov_b32 v15, 0
  v_mov_b32 v16, 0
  v_mov_b32 v17, 0
  v_mov_b32 v18, 0
  v_mov_b32 v19, 0
  v_mov_b32 v20, 0
  v_mov_b32 v21, 0
  v_mov_b32 v22, 0
  v_mov_b32 v23, 0
  s_add_u32 s73, s20, 2
  s_lshl_b32 s73, s73, 4
  s_cmp_ge_u32 s20, 58
  s_cselect_b32 s78, 1, 6
  s_cmp_ge_u32 s20, 61
  s_nop 0
  s_cbranch_scc0 L_v_fc
  s_mov_b32 s72, 49883648
  s_cmp_eq_u32 s20, 61
  s_cselect_b32 s72, 49884160, s72
  s_cmp_lg_u32 s3, 0
  s_cbranch_scc1 L_wf_ve
  s_mov_b32 s23, 0
L_sp_ve:
  buffer_load_dword v207, off, s[8:11], s72 sc1
  s_add_u32 s23, s23, 1
  s_cmp_gt_u32 s23, 50000
  s_cbranch_scc1 L_w_fail
  s_waitcnt vmcnt(0)
  v_readfirstlane_b32 s22, v207
  s_nop 0
  s_cmp_ge_u32 s22, 16
  s_cbranch_scc1 L_sp_ve_ok
  s_sleep 2
  s_branch L_sp_ve
L_sp_ve_ok:
L_wf_ve:
  s_barrier
  s_branch L_v_fe
L_v_fc:
  s_cmp_lg_u32 s3, 0
  s_cbranch_scc1 L_fc_vy_j
  s_mov_b32 s77, 49883136
  s_mov_b32 s23, 0
L_fc_vy:
  buffer_load_dword v207, off, s[8:11], s77 sc1
  s_add_u32 s23, s23, 1
  s_cmp_gt_u32 s23, 50000
  s_cbranch_scc1 L_w_fail
  s_waitcnt vmcnt(0)
  v_readfirstlane_b32 s22, v207
  s_nop 0
  s_cmp_ge_u32 s22, s73
  s_cbranch_scc1 L_fc_vy_j
  s_sub_u32 s22, s73, s22
  s_lshr_b32 s22, s22, 4
  s_min_u32 s22, s22, 16
  s_cmp_lt_u32 s22, 2
  s_cbranch_scc1 L_fc_vy_s
  s_sub_u32 s22, s22, 1
L_fc_vy_l:
  s_sleep 44
  s_sub_u32 s22, s22, 1
  s_cmp_lg_u32 s22, 0
  s_cbranch_scc1 L_fc_vy_l
  s_branch L_fc_vy
L_fc_vy_s:
  s_mov_b32 s22, s78
L_fc_vy_r:
  s_sleep 4
  s_sub_u32 s22, s22, 1
  s_cmp_lg_u32 s22, 0
  s_cbranch_scc1 L_fc_vy_r
  s_branch L_fc_vy
L_fc_vy_j:
  s_barrier
L_v_fe:
  s_add_u32 s33, s29, 0
  buffer_load_dwordx4 v[168:171], v4, s[8:11], s33 offen sc1
  s_add_u32 s33, s29, 1792
  buffer_load_dwordx4 v[176:179], v4, s[8:11], s33 offen sc1
  s_add_u32 s33, s29, 3584
  buffer_load_dwordx4 v[184:187], v4, s[8:11], s33 offen sc1
  s_add_u32 s33, s29, 5376
  buffer_load_dwordx4 v[192:195], v4, s[8:11], s33 offen sc1
  s_mov_b64 exec, s[62:63]
  s_add_u32 s33, s29, 256
  buffer_load_dwordx4 v[172:175], v4, s[8:11], s33 offen sc1
  s_add_u32 s33, s29, 2048
  buffer_load_dwordx4 v[180:183], v4, s[8:11], s33 offen sc1
  s_add_u32 s33, s29, 3840
  buffer_load_dwordx4 v[188:191], v4, s[8:11], s33 offen sc1
  s_add_u32 s33, s29, 5632
  buffer_load_dwordx4 v[196:199], v4, s[8:11], s33 offen sc1
  s_mov_b64 exec, -1
  s_lshl_b32 s72, s20, 7
  s_add_u32 s72, s72, 49885184
  s_cmp_ge_u32 s20, 60
  s_nop 0
  s_cbranch_scc1 L_v_fxq
  s_cmp_lg_u32 s3, 0
  s_cbranch_scc1 L_wf_vx
  s_mov_b32 s23, 0
L_sp_vx:
  buffer_load_dword v207, off, s[8:11], s72 sc1
  s_add_u32 s23, s23, 1
  s_cmp_gt_u32 s23, 50000
  s_cbranch_scc1 L_w_fail
  s_waitcnt vmcnt(0)
  v_readfirstlane_b32 s22, v207
  s_nop 0
  s_cmp_ge_u32 s22, 16
  s_cbranch_scc1 L_sp_vx_ok
  s_sleep 8
  s_branch L_sp_vx
L_sp_vx_ok:
L_wf_vx:
  s_barrier
  s_branch L_v_fxj
L_v_fxq:
  s_cmp_lg_u32 s3, 0
  s_cbranch_scc1 L_wf_vxq
  s_mov_b32 s23, 0
L_sp_vxq:
  buffer_load_dword v207, off, s[8:11], s72 sc1
  s_add_u32 s23, s23, 1
  s_cmp_gt_u32 s23, 50000
  s_cbranch_scc1 L_w_fail
  s_waitcnt vmcnt(0)
  v_readfirstlane_b32 s22, v207
  s_nop 0
  s_cmp_ge_u32 s22, 16
  s_cbranch_scc1 L_sp_vxq_ok
  s_sleep 1
  s_branch L_sp_vxq
L_sp_vxq_ok:
L_wf_vxq:
  s_barrier
L_v_fxj:
  s_lshl_b32 s25, s20, 15
  s_add_u32 s25, s25, 57298944
  s_lshl_b32 s26, s20, 13
  s_add_u32 s26, s26, 5963776
  s_lshl_b32 s27, s3, 13
  s_add_u32 s27, s27, s25
  s_lshl_b32 s31, s3, 13
  s_add_u32 m0, s31, 0
  s_add_u32 s33, s27, 0
  buffer_load_dwordx4 v2, s[8:11], s33 offen sc1 lds
  s_add_u32 m0, s31, 1024
  s_add_u32 s33, s27, 1024
  buffer_load_dwordx4 v2, s[8:11], s33 offen sc1 lds
  s_add_u32 m0, s31, 2048
  s_add_u32 s33, s27, 2048
  buffer_load_dwordx4 v2, s[8:11], s33 offen sc1 lds
  s_add_u32 m0, s31, 3072
  s_add_u32 s33, s27, 3072
  buffer_load_dwordx4 v2, s[8:11], s33 offen sc1 lds
  s_add_u32 m0, s31, 4096
  s_add_u32 s33, s27, 4096
  buffer_load_dwordx4 v2, s[8:11], s33 offen sc1 lds
  s_add_u32 m0, s31, 5120
  s_add_u32 s33, s27, 5120
  buffer_load_dwordx4 v2, s[8:11], s33 offen sc1 lds
  s_add_u32 m0, s31, 6144
  s_add_u32 s33, s27, 6144
  buffer_load_dwordx4 v2, s[8:11], s33 offen sc1 lds
  s_add_u32 m0, s31, 7168
  s_add_u32 s33, s27, 7168
  buffer_load_dwordx4 v2, s[8:11], s33 offen sc1 lds
  s_lshl_b32 s27, s3, 11
  s_add_u32 s27, s27, s26
  s_lshl_b32 s31, s3, 11
  s_add_u32 s31, s31, 32768
  s_add_u32 m0, s31, 0
  s_add_u32 s33, s27, 0
  buffer_load_dwordx4 v3, s[8:11], s33 offen sc1 lds
  s_add_u32 m0, s31, 1024
  s_add_u32 s33, s27, 256
  buffer_load_dwordx4 v3, s[8:11], s33 offen sc1 lds
  s_waitcnt vmcnt(0)
  s_barrier
  ds_read_b128 v[24:27], v1 offset:0
  ds_read_b128 v[28:31], v1 offset:1024
  ds_read_b128 v[32:35], v1 offset:2048
  ds_read_b128 v[36:39], v1 offset:3072
  s_waitcnt lgkmcnt(2)
  v_mfma_f32_16x16x32_bf16 v[8:11], v[24:27], v[40:43], v[8:11]
  v_mfma_f32_16x16x32_bf16 v[12:15], v[24:27], v[44:47], v[12:15]
  v_mfma_f32_16x16x32_bf16 v[16:19], v[28:31], v[40:43], v[16:19]
  v_mfma_f32_16x16x32_bf16 v[20:23], v[28:31], v[44:47], v[20:23]
  ds_read_b128 v[24:27], v1 offset:4096
  ds_read_b128 v[28:31], v1 offset:5120
  s_waitcnt lgkmcnt(2)
  v_mfma_f32_16x16x32_bf16 v[8:11], v[32:35], v[48:51], v[8:11]
  v_mfma_f32_16x16x32_bf16 v[12:15], v[32:35], v[52:55], v[12:15]
  v_mfma_f32_16x16x32_bf16 v[16:19], v[36:39], v[48:51], v[16:19]
  v_mfma_f32_16x16x32_bf16 v[20:23], v[36:39], v[52:55], v[20:23]
  ds_read_b128 v[32:35], v1 offset:6144
  ds_read_b128 v[36:39], v1 offset:7168
  s_waitcnt lgkmcnt(2)
  v_mfma_f32_16x16x32_bf16 v[8:11], v[24:27], v[56:59], v[8:11]
  v_mfma_f32_16x16x32_bf16 v[12:15], v[24:27], v[60:63], v[12:15]
  v_mfma_f32_16x16x32_bf16 v[16:19], v[28:31], v[56:59], v[16:19]
  v_mfma_f32_16x16x32_bf16 v[20:23], v[28:31], v[60:63], v[20:23]
  ds_read_b128 v[24:27], v1 offset:8192
  ds_read_b128 v[28:31], v1 offset:9216
  s_waitcnt lgkmcnt(2)
  v_mfma_f32_16x16x32_bf16 v[8:11], v[32:35], v[64:67], v[8:11]
  v_mfma_f32_16x16x32_bf16 v[12:15], v[32:35], v[68:71], v[12:15]
  v_mfma_f32_16x16x32_bf16 v[16:19], v[36:39], v[64:67], v[16:19]
  v_mfma_f32_16x16x32_bf16 v[20:23], v[36:39], v[68:71], v[20:23]
  ds_read_b128 v[32:35], v1 offset:10240
  ds_read_b128 v[36:39], v1 offset:11264
  s_waitcnt lgkmcnt(2)
  v_mfma_f32_16x16x32_bf16 v[8:11], v[24:27], v[72:75], v[8:11]
  v_mfma_f32_16x16x32_bf16 v[12:15], v[24:27], v[76:79], v[12:15]
  v_mfma_f32_16x16x32_bf16 v[16:19], v[28:31], v[72:75], v[16:19]
  v_mfma_f32_16x16x32_bf16 v[20:23], v[28:31], v[76:79], v[20:23]
  ds_read_b128 v[24:27], v1 offset:12288
  ds_read_b128 v[28:31], v1 offset:13312
  s_waitcnt lgkmcnt(2)
  v_mfma_f32_16x16x32_bf16 v[8:11], v[32:35], v[80:83], v[8:11]
  v_mfma_f32_16x16x32_bf16 v[12:15], v[32:35], v[84:87], v[12:15]
  v_mfma_f32_16x16x32_bf16 v[16:19], v[36:39], v[80:83], v[16:19]
  v_mfma_f32_16x16x32_bf16 v[20:23], v[36:39], v[84:87], v[20:23]
  ds_read_b128 v[32:35], v1 offset:14336
  ds_read_b128 v[36:39], v1 offset:15360
  s_waitcnt lgkmcnt(2)
  v_mfma_f32_16x16x32_bf16 v[8:11], v[24:27], v[88:91], v[8:11]
  v_mfma_f32_16x16x32_bf16 v[12:15], v[24:27], v[92:95], v[12:15]
  v_mfma_f32_16x16x32_bf16 v[16:19], v[28:31], v[88:91], v[16:19]
  v_mfma_f32_16x16x32_bf16 v[20:23], v[28:31], v[92:95], v[20:23]
  ds_read_b128 v[24:27], v1 offset:16384
  ds_read_b128 v[28:31], v1 offset:17408
  s_waitcnt lgkmcnt(2)
  v_mfma_f32_16x16x32_bf16 v[8:11], v[32:35], v[96:99], v[8:11]
  v_mfma_f32_16x16x32_bf16 v[12:15], v[32:35], v[100:103], v[12:15]
  v_mfma_f32_16x16x32_bf16 v[16:19], v[36:39], v[96:99], v[16:19]
  v_mfma_f32_16x16x32_bf16 v[20:23], v[36:39], v[100:103], v[20:23]
  ds_read_b128 v[32:35], v1 offset:18432
  ds_read_b128 v[36:39], v1 offset:19456
  s_waitcnt lgkmcnt(2)
  v_mfma_f32_16x16x32_bf16 v[8:11], v[24:27], v[104:107], v[8:11]
  v_mfma_f32_16x16x32_bf16 v[12:15], v[24:27], v[108:111], v[12:15]
  v_mfma_f32_16x16x32_bf16 v[16:19], v[28:31], v[104:107], v[16:19]
  v_mfma_f32_16x16x32_bf16 v[20:23], v[28:31], v[108:111], v[20:23]
  ds_read_b128 v[24:27], v1 offset:20480
  ds_read_b128 v[28:31], v1 offset:21504
  s_waitcnt lgkmcnt(2)
  v_mfma_f32_16x16x32_bf16 v[8:11], v[32:35], v[112:115], v[8:11]
  v_mfma_f32_16x16x32_bf16 v[12:15], v[32:35], v[116:119], v[12:15]
  v_mfma_f32_16x16x32_bf16 v[16:19], v[36:39], v[112:115], v[16:19]
  v_mfma_f32_16x16x32_bf16 v[20:23], v[36:39], v[116:119], v[20:23]
  ds_read_b128 v[32:35], v1 offset:22528
  ds_read_b128 v[36:39], v1 offset:23552
  s_waitcnt lgkmcnt(2)
  v_mfma_f32_16x16x32_bf16 v[8:11], v[24:27], v[120:123], v[8:11]
  v_mfma_f32_16x16x32_bf16 v[12:15], v[24:27], v[124:127], v[12:15]
  v_mfma_f32_16x16x32_bf16 v[16:19], v[28:31], v[120:123], v[16:19]
  v_mfma_f32_16x16x32_bf16 v[20:23], v[28:31], v[124:127], v[20:23]
  ds_read_b128 v[24:27], v1 offset:24576
  ds_read_b128 v[28:31], v1 offset:25600
  s_waitcnt lgkmcnt(2)
  v_mfma_f32_16x16x32_bf16 v[8:11], v[32:35], v[128:131], v[8:11]
  v_mfma_f32_16x16x32_bf16 v[12:15], v[32:35], v[132:135], v[12:15]
  v_mfma_f32_16x16x32_bf16 v[16:19], v[36:39], v[128:131], v[16:19]
  v_mfma_f32_16x16x32_bf16 v[20:23], v[36:39], v[132:135], v[20:23]
  ds_read_b128 v[32:35], v1 offset:26624
  ds_read_b128 v[36:39], v1 offset:27648
  s_waitcnt lgkmcnt(2)
  v_mfma_f32_16x16x32_bf16 v[8:11], v[24:27], v[136:139], v[8:11]
  v_mfma_f32_16x16x32_bf16 v[12:15], v[24:27], v[140:143], v[12:15]
  v_mfma_f32_16x16x32_bf16 v[16:19], v[28:31], v[136:139], v[16:19]
  v_mfma_f32_16x16x32_bf16 v[20:23], v[28:31], v[140:143], v[20:23]
  ds_read_b128 v[24:27], v1 offset:28672
  ds_read_b128 v[28:31], v1 offset:29696
  s_waitcnt lgkmcnt(2)
  v_mfma_f32_16x16x32_bf16 v[8:11], v[32:35], v[144:147], v[8:11]
  v_mfma_f32_16x16x32_bf16 v[12:15], v[32:35], v[148:151], v[12:15]
  v_mfma_f32_16x16x32_bf16 v[16:19], v[36:39], v[144:147], v[16:19]
  v_mfma_f32_16x16x32_bf16 v[20:23], v[36:39], v[148:151], v[20:23]
  ds_read_b128 v[32:35], v1 offset:30720
  ds_read_b128 v[36:39], v1 offset:31744
  s_waitcnt lgkmcnt(2)
  v_mfma_f32_16x16x32_bf16 v[8:11], v[24:27], v[152:155], v[8:11]
  v_mfma_f32_16x16x32_bf16 v[12:15], v[24:27], v[156:159], v[12:15]
  v_mfma_f32_16x16x32_bf16 v[16:19], v[28:31], v[152:155], v[16:19]
  v_mfma_f32_16x16x32_bf16 v[20:23], v[28:31], v[156:159], v[20:23]
  ds_read_b128 v[24:27], v1 offset:32768
  ds_read_b128 v[28:31], v1 offset:33792
  s_waitcnt lgkmcnt(2)
  v_mfma_f32_16x16x32_bf16 v[8:11], v[32:35], v[160:163], v[8:11]
  v_mfma_f32_16x16x32_bf16 v[12:15], v[32:35], v[164:167], v[12:15]
  v_mfma_f32_16x16x32_bf16 v[16:19], v[36:39], v[160:163], v[16:19]
  v_mfma_f32_16x16x32_bf16 v[20:23], v[36:39], v[164:167], v[20:23]
  ds_read_b128 v[32:35], v1 offset:34816
  ds_read_b128 v[36:39], v1 offset:35840
  s_waitcnt lgkmcnt(2)
  v_mfma_f32_16x16x32_bf16 v[8:11], v[24:27], v[168:171], v[8:11]
  v_mfma_f32_16x16x32_bf16 v[12:15], v[24:27], v[172:175], v[12:15]
  v_mfma_f32_16x16x32_bf16 v[16:19], v[28:31], v[168:171], v[16:19]
  v_mfma_f32_16x16x32_bf16 v[20:23], v[28:31], v[172:175], v[20:23]
  ds_read_b128 v[24:27], v1 offset:36864
  ds_read_b128 v[28:31], v1 offset:37888
  s_waitcnt lgkmcnt(2)
  v_mfma_f32_16x16x32_bf16 v[8:11], v[32:35], v[176:179], v[8:11]
  v_mfma_f32_16x16x32_bf16 v[12:15], v[32:35], v[180:183], v[12:15]
  v_mfma_f32_16x16x32_bf16 v[16:19], v[36:39], v[176:179], v[16:19]
  v_mfma_f32_16x16x32_bf16 v[20:23], v[36:39], v[180:183], v[20:23]
  ds_read_b128 v[32:35], v1 offset:38912
  ds_read_b128 v[36:39], v1 offset:39936
  s_waitcnt lgkmcnt(2)
  v_mfma_f32_16x16x32_bf16 v[8:11], v[24:27], v[184:187], v[8:11]
  v_mfma_f32_16x16x32_bf16 v[12:15], v[24:27], v[188:191], v[12:15]
  v_mfma_f32_16x16x32_bf16 v[16:19], v[28:31], v[184:187], v[16:19]
  v_mfma_f32_16x16x32_bf16 v[20:23], v[28:31], v[188:191], v[20:23]
  s_waitcnt lgkmcnt(0)
  v_mfma_f32_16x16x32_bf16 v[8:11], v[32:35], v[192:195], v[8:11]
  v_mfma_f32_16x16x32_bf16 v[12:15], v[32:35], v[196:199], v[12:15]
  v_mfma_f32_16x16x32_bf16 v[16:19], v[36:39], v[192:195], v[16:19]
  v_mfma_f32_16x16x32_bf16 v[20:23], v[36:39], v[196:199], v[20:23]
  s_nop 4
  ds_write_b32 v5, v8 offset:0
  ds_write_b32 v5, v9 offset:464
  ds_write_b32 v5, v10 offset:928
  ds_write_b32 v5, v11 offset:1392
  ds_write_b32 v5, v16 offset:7424
  ds_write_b32 v5, v17 offset:7888
  ds_write_b32 v5, v18 offset:8352
  ds_write_b32 v5, v19 offset:8816
  v_cmp_gt_u32 vcc, 12, v200
  s_nop 0
  s_and_saveexec_b64 s[30:31], vcc
  ds_write_b32 v6, v12 offset:0
  ds_write_b32 v6, v13 offset:464
  ds_write_b32 v6, v14 offset:928
  ds_write_b32 v6, v15 offset:1392
  ds_write_b32 v6, v20 offset:7424
  ds_write_b32 v6, v21 offset:7888
  ds_write_b32 v6, v22 offset:8352
  ds_write_b32 v6, v23 offset:8816
  s_mov_b64 exec, s[30:31]
  s_lshl_b32 s27, s3, 3
  v_lshrrev_b32 v40, 3, v0
  v_add_u32 v40, s27, v40
  v_and_b32 v41, 7, v0
  v_mul_u32_u24 v43, 464, v40
  v_mul_u32_u24 v51, 56, v41
  v_add_u32 v43, v43, v51
  v_add_u32 v43, 40960, v43
  s_waitcnt lgkmcnt(0)
  s_barrier
  ds_read_b64 v[52:53], v43 offset:0
  ds_read_b64 v[54:55], v43 offset:8
  ds_read_b64 v[56:57], v43 offset:16
  ds_read_b64 v[58:59], v43 offset:24
  ds_read_b64 v[60:61], v43 offset:32
  ds_read_b64 v[62:63], v43 offset:40
  ds_read_b64 v[64:65], v43 offset:48
  s_waitcnt vmcnt(0) lgkmcnt(0)
  v_lshlrev_b32 v70, 16, v208
  v_and_b32 v71, 0xffff0000, v208
  v_add_f32 v52, v52, v70
  v_add_f32 v53, v53, v71
  v_cvt_pk_bf16_f32 v72, v52, v53
  v_lshlrev_b32 v70, 16, v209
  v_and_b32 v71, 0xffff0000, v209
  v_add_f32 v54, v54, v70
  v_add_f32 v55, v55, v71
  v_cvt_pk_bf16_f32 v73, v54, v55
  v_lshlrev_b32 v70, 16, v210
  v_and_b32 v71, 0xffff0000, v210
  v_add_f32 v56, v56, v70
  v_add_f32 v57, v57, v71
  v_cvt_pk_bf16_f32 v74, v56, v57
  v_lshlrev_b32 v70, 16, v211
  v_and_b32 v71, 0xffff0000, v211
  v_add_f32 v58, v58, v70
  v_add_f32 v59, v59, v71
  v_cvt_pk_bf16_f32 v75, v58, v59
  v_lshlrev_b32 v70, 16, v212
  v_and_b32 v71, 0xffff0000, v212
  v_add_f32 v60, v60, v70
  v_add_f32 v61, v61, v71
  v_cvt_pk_bf16_f32 v76, v60, v61
  v_lshlrev_b32 v70, 16, v213
  v_and_b32 v71, 0xffff0000, v213
  v_add_f32 v62, v62, v70
  v_add_f32 v63, v63, v71
  v_cvt_pk_bf16_f32 v77, v62, v63
  v_lshlrev_b32 v70, 16, v214
  v_and_b32 v71, 0xffff0000, v214
  v_add_f32 v64, v64, v70
  v_add_f32 v65, v65, v71
  v_cvt_pk_bf16_f32 v78, v64, v65
  v_mul_u32_u24 v46, 224, v40
  v_mul_u32_u24 v47, 28, v41
  v_add_u32 v46, v46, v47
  v_add_u32 v46, 65536, v46
  ds_write_b32 v46, v72 offset:0
  ds_write_b32 v46, v73 offset:4
  ds_write_b32 v46, v74 offset:8
  ds_write_b32 v46, v75 offset:12
  ds_write_b32 v46, v76 offset:16
  ds_write_b32 v46, v77 offset:20
  ds_write_b32 v46, v78 offset:24
  v_mov_b32 v80, 0
  v_mov_b32 v81, 0
  v_lshlrev_b32 v52, 16, v72
  v_and_b32 v53, 0xffff0000, v72
  v_add_f32 v80, v80, v52
  v_fmac_f32 v81, v52, v52
  v_add_f32 v80, v80, v53
  v_fmac_f32 v81, v53, v53
  v_lshlrev_b32 v54, 16, v73
  v_and_b32 v55, 0xffff0000, v73
  v_add_f32 v80, v80, v54
  v_fmac_f32 v81, v54, v54
  v_add_f32 v80, v80, v55
  v_fmac_f32 v81, v55, v55
  v_lshlrev_b32 v56, 16, v74
  v_and_b32 v57, 0xffff0000, v74
  v_add_f32 v80, v80, v56
  v_fmac_f32 v81, v56, v56
  v_add_f32 v80, v80, v57
  v_fmac_f32 v81, v57, v57
  v_lshlrev_b32 v58, 16, v75
  v_and_b32 v59, 0xffff0000, v75
  v_add_f32 v80, v80, v58
  v_fmac_f32 v81, v58, v58
  v_add_f32 v80, v80, v59
  v_fmac_f32 v81, v59, v59
  v_lshlrev_b32 v60, 16, v76
  v_and_b32 v61, 0xffff0000, v76
  v_add_f32 v80, v80, v60
  v_fmac_f32 v81, v60, v60
  v_add_f32 v80, v80, v61
  v_fmac_f32 v81, v61, v61
  v_lshlrev_b32 v62, 16, v77
  v_and_b32 v63, 0xffff0000, v77
  v_add_f32 v80, v80, v62
  v_fmac_f32 v81, v62, v62
  v_add_f32 v80, v80, v63
  v_fmac_f32 v81, v63, v63
  v_lshlrev_b32 v64, 16, v78
  v_and_b32 v65, 0xffff0000, v78
  v_add_f32 v80, v80, v64
  v_fmac_f32 v81, v64, v64
  v_add_f32 v80, v80, v65
  v_fmac_f32 v81, v65, v65
  s_nop 0
  v_add_f32_dpp v80, v80, v80 quad_perm:[1,0,3,2] row_mask:0xf bank_mask:0xf
  s_nop 1
  v_add_f32_dpp v80, v80, v80 quad_perm:[2,3,0,1] row_mask:0xf bank_mask:0xf
  s_nop 1
  v_add_f32_dpp v80, v80, v80 row_half_mirror row_mask:0xf bank_mask:0xf
  v_add_f32_dpp v81, v81, v81 quad_perm:[1,0,3,2] row_mask:0xf bank_mask:0xf
  s_nop 1
  v_add_f32_dpp v81, v81, v81 quad_perm:[2,3,0,1] row_mask:0xf bank_mask:0xf
  s_nop 1
  v_add_f32_dpp v81, v81, v81 row_half_mirror row_mask:0xf bank_mask:0xf
  s_lshl_b32 s27, s20, 2
  s_add_u32 s27, s27, s21
  s_lshl_b32 s27, s27, 8
  s_add_u32 s27, s27, 6488064
  v_lshlrev_b32 v82, 3, v40
  v_cmp_eq_u32 vcc, 0, v41
  s_nop 0
  s_and_saveexec_b64 s[30:31], vcc
  buffer_store_dwordx2 v[80:81], v82, s[8:11], s27 offen sc1
  s_mov_b64 exec, s[30:31]
  s_lshl_b32 s72, s20, 7
  s_add_u32 s72, s72, 49897472
  s_waitcnt lgkmcnt(0)
  s_waitcnt vmcnt(0)
  s_barrier
  s_cmp_lg_u32 s3, 0
  s_nop 0
  s_cbranch_scc1 L_fa_vs
  v_mov_b32 v83, 1
  s_mov_b64 exec, 1
  buffer_atomic_add v83, off, s[8:11], s72
  s_mov_b64 exec, -1
L_fa_vs:
  s_lshl_b32 s27, s3, 6
  v_add_u32 v46, s27, v0
  v_lshlrev_b32 v46, 4, v46
  v_add_u32 v47, 65536, v46
  ds_read_b128 v[92:95], v47
  ds_read_b128 v[96:99], v47 offset:4096
  s_lshl_b32 s27, s20, 2
  s_add_u32 s27, s27, s21
  s_mul_i32 s27, s27, 7168
  s_add_u32 s27, s27, 61493248
  s_waitcnt lgkmcnt(0)
  buffer_store_dwordx4 v[92:95], v46, s[8:11], s27 offen sc1
  v_add_u32 v46, 4096, v46
  v_cmp_gt_u32 vcc, 7168, v46
  s_nop 0
  s_and_saveexec_b64 s[30:31], vcc
  buffer_store_dwordx4 v[96:99], v46, s[8:11], s27 offen sc1
  s_mov_b64 exec, s[30:31]
  s_cmp_lg_u32 s3, 0
  s_cbranch_scc1 L_wf_vs
  s_mov_b32 s23, 0
L_sp_vs:
  buffer_load_dword v83, off, s[8:11], s72 sc1
  s_add_u32 s23, s23, 1
  s_cmp_gt_u32 s23, 50000
  s_cbranch_scc1 L_w_fail
  s_waitcnt vmcnt(0)
  v_readfirstlane_b32 s22, v83
  s_nop 0
  s_cmp_ge_u32 s22, 4
  s_cbranch_scc1 L_sp_vs_ok
  s_sleep 1
  s_branch L_sp_vs
L_sp_vs_ok:
L_wf_vs:
  s_barrier
  s_lshl_b32 s27, s20, 10
  s_add_u32 s27, s27, 6488064
  buffer_load_dwordx2 v[84:85], v82, s[8:11], s27 offen offset:0 sc1
  buffer_load_dwordx2 v[86:87], v82, s[8:11], s27 offen offset:256 sc1
  buffer_load_dwordx2 v[88:89], v82, s[8:11], s27 offen offset:512 sc1
  buffer_load_dwordx2 v[90:91], v82, s[8:11], s27 offen offset:768 sc1
  s_waitcnt vmcnt(0)
  v_add_f32 v84, v84, v86
  v_add_f32 v88, v88, v90
  v_add_f32 v85, v85, v87
  v_add_f32 v89, v89, v91
  v_add_f32 v84, v84, v88
  v_add_f32 v85, v85, v89
  v_mul_f32 v84, 0x3b124925, v84
  v_mul_f32 v85, 0x3b124925, v85
  v_fma_f32 v85, -v84, v84, v85
  v_max_f32 v85, 0, v85
  v_add_f32 v85, 0x3727c5ac, v85
  v_rsq_f32 v85, v85
  v_sub_f32 v52, v52, v84
  v_sub_f32 v53, v53, v84
  v_sub_f32 v54, v54, v84
  v_sub_f32 v55, v55, v84
  v_sub_f32 v56, v56, v84
  v_sub_f32 v57, v57, v84
  v_sub_f32 v58, v58, v84
  v_sub_f32 v59, v59, v84
  v_sub_f32 v60, v60, v84
  v_sub_f32 v61, v61, v84
  v_sub_f32 v62, v62, v84
  v_sub_f32 v63, v63, v84
  v_sub_f32 v64, v64, v84
  v_sub_f32 v65, v65, v84
  v_mul_f32 v52, v52, v85
  v_mul_f32 v53, v53, v85
  v_mul_f32 v54, v54, v85
  v_mul_f32 v55, v55, v85
  v_mul_f32 v56, v56, v85
  v_mul_f32 v57, v57, v85
  v_mul_f32 v58, v58, v85
  v_mul_f32 v59, v59, v85
  v_mul_f32 v60, v60, v85
  v_mul_f32 v61, v61, v85
  v_mul_f32 v62, v62, v85
  v_mul_f32 v63, v63, v85
  v_mul_f32 v64, v64, v85
  v_mul_f32 v65, v65, v85
  v_cvt_pk_bf16_f32 v72, v52, v53
  v_cvt_pk_bf16_f32 v73, v54, v55
  v_cvt_pk_bf16_f32 v74, v56, v57
  v_cvt_pk_bf16_f32 v75, v58, v59
  v_cvt_pk_bf16_f32 v76, v60, v61
  v_cvt_pk_bf16_f32 v77, v62, v63
  v_cvt_pk_bf16_f32 v78, v64, v65
  v_mul_u32_u24 v43, 232, v40
  v_mul_u32_u24 v51, 28, v41
  v_add_u32 v43, v43, v51
  v_add_u32 v43, 57344, v43
  ds_write_b32 v43, v72 offset:0
  ds_write_b32 v43, v73 offset:4
  ds_write_b32 v43, v74 offset:8
  ds_write_b32 v43, v75 offset:12
  ds_write_b32 v43, v76 offset:16
  ds_write_b32 v43, v77 offset:20
  ds_write_b32 v43, v78 offset:24
  s_waitcnt lgkmcnt(0)
  s_barrier
  v_lshrrev_b32 v44, 2, v200
  v_lshl_add_u32 v44, v201, 3, v44
  v_mul_u32_u24 v44, 232, v44
  v_and_b32 v45, 3, v200
  v_lshl_add_u32 v44, v45, 3, v44
  v_add_u32 v44, 57344, v44
  s_lshl_b32 s27, s3, 5
  v_add_u32 v44, s27, v44
  v_lshlrev_b32 v45, 9, v201
  v_lshl_add_u32 v45, v200, 4, v45
  ds_read_b64_tr_b16 v[48:49], v44 offset:0
  ds_read_b64_tr_b16 v[50:51], v44 offset:928
  s_add_u32 s27, s3, 0
  s_lshl_b32 s27, s27, 4
  s_mul_i32 s30, s21, 112
  s_add_u32 s27, s27, s30
  s_lshr_b32 s30, s27, 5
  s_mul_i32 s30, s30, 131072
  s_and_b32 s27, s27, 31
  s_lshl_b32 s27, s27, 4
  s_add_u32 s30, s30, s27
  s_lshl_b32 s27, s20, 11
  s_add_u32 s30, s30, s27
  s_add_u32 s30, s30, 63328256
  s_waitcnt lgkmcnt(0)
  buffer_store_dwordx4 v[48:51], v45, s[8:11], s30 offen sc1
  s_nop 1
  s_cmp_ge_u32 s3, 3
  s_cbranch_scc1 L_v_end
  ds_read_b64_tr_b16 v[48:49], v44 offset:128
  ds_read_b64_tr_b16 v[50:51], v44 offset:1056
  s_add_u32 s27, s3, 4
  s_lshl_b32 s27, s27, 4
  s_mul_i32 s30, s21, 112
  s_add_u32 s27, s27, s30
  s_lshr_b32 s30, s27, 5
  s_mul_i32 s30, s30, 131072
  s_and_b32 s27, s27, 31
  s_lshl_b32 s27, s27, 4
  s_add_u32 s30, s30, s27
  s_lshl_b32 s27, s20, 11
  s_add_u32 s30, s30, s27
  s_add_u32 s30, s30, 63328256
  s_waitcnt lgkmcnt(0)
  buffer_store_dwordx4 v[48:51], v45, s[8:11], s30 offen sc1
  s_nop 1
L_v_end:
  s_lshl_b32 s72, s20, 7
  s_add_u32 s72, s72, 49905664
  s_waitcnt vmcnt(0)
  s_barrier
  s_cmp_lg_u32 s3, 0
  s_cbranch_scc1 L_fa_vh
  v_mov_b32 v83, 1
  s_mov_b64 exec, 1
  buffer_atomic_add v83, off, s[8:11], s72
  s_mov_b64 exec, -1
L_fa_vh:
  s_add_u32 s92, s92, 2
  s_cmp_lt_u32 s92, 16
  s_cbranch_scc1 L_w_v2
  s_branch L_w_g2pre
L_w_g2late:
  s_mov_b32 s73, 800
  s_cmp_lg_u32 s3, 0
  s_cbranch_scc1 L_fc_idle_j
  s_mov_b32 s77, 49883136
  s_mov_b32 s23, 0
L_fc_idle:
  buffer_load_dword v10, off, s[8:11], s77 sc1
  s_add_u32 s23, s23, 1
  s_cmp_gt_u32 s23, 50000
  s_cbranch_scc1 L_w_fail
  s_waitcnt vmcnt(0)
  v_readfirstlane_b32 s22, v10
  s_nop 0
  s_cmp_ge_u32 s22, s73
  s_cbranch_scc1 L_fc_idle_j
  s_sub_u32 s22, s73, s22
  s_lshr_b32 s22, s22, 4
  s_min_u32 s22, s22, 16
  s_cmp_lt_u32 s22, 2
  s_cbranch_scc1 L_fc_idle_s
  s_sub_u32 s22, s22, 1
L_fc_idle_l:
  s_sleep 44
  s_sub_u32 s22, s22, 1
  s_cmp_lg_u32 s22, 0
  s_cbranch_scc1 L_fc_idle_l
  s_branch L_fc_idle
L_fc_idle_s:
  s_sleep 56
  s_branch L_fc_idle
L_fc_idle_j:
  s_barrier
L_w_g2pre:
  s_mov_b32 s85, s86
  s_mov_b32 s88, 0
L_q_b:
  s_cmp_lg_u32 s3, 0
  s_cbranch_scc1 L_qp_b
  s_lshl_b32 s16, s85, 7
  s_add_u32 s16, s16, 49950720
  v_mov_b32 v1, 1
  s_mov_b64 exec, 1
  buffer_atomic_add v1, off, s[8:11], s16 sc0
  s_waitcnt vmcnt(0)
  v_mov_b32 v2, 20488
  ds_write_b32 v2, v1
  s_waitcnt lgkmcnt(0)
  s_mov_b64 exec, -1
L_qp_b:
  s_barrier
  v_mov_b32 v2, 20488
  ds_read_b32 v1, v2
  s_waitcnt lgkmcnt(0)
  v_readfirstlane_b32 s84, v1
  s_barrier
  s_cmp_lt_u32 s84, 32
  s_nop 0
  s_cbranch_scc1 L_qh_b
  s_add_u32 s88, s88, 1
  s_cmp_ge_u32 s88, 7
  s_cbranch_scc1 L_w_end
  s_add_u32 s85, s85, 1
  s_cmp_ge_u32 s85, 7
  s_cselect_b32 s85, 0, s85
  s_branch L_q_b
L_qh_b:
  s_mov_b32 s72, 49883904
  s_cmp_lg_u32 s3, 0
  s_cbranch_scc1 L_wf_w2b
  s_mov_b32 s23, 0
L_sp_w2b:
  buffer_load_dword v2, off, s[8:11], s72 sc1
  s_add_u32 s23, s23, 1
  s_cmp_gt_u32 s23, 50000
  s_cbranch_scc1 L_w_fail
  s_waitcnt vmcnt(0)
  v_readfirstlane_b32 s22, v2
  s_nop 0
  s_cmp_ge_u32 s22, 224
  s_cbranch_scc1 L_sp_w2b_ok
  s_sleep 16
  s_branch L_sp_w2b
L_sp_w2b_ok:
L_wf_w2b:
  s_barrier
  v_lshlrev_b32 v1, 4, v0
  s_mul_i32 s27, s84, 229376
  s_mul_i32 s21, s3, 28672
  s_add_u32 s27, s27, s21
  s_add_u32 s27, s27, 74108928
  s_add_u32 s23, s27, 0
  buffer_load_dwordx4 a[0:3], v1, s[8:11], s23 offen sc1
  s_add_u32 s23, s27, 1024
  buffer_load_dwordx4 a[4:7], v1, s[8:11], s23 offen sc1
  s_add_u32 s23, s27, 2048
  buffer_load_dwordx4 a[8:11], v1, s[8:11], s23 offen sc1
  s_add_u32 s23, s27, 3072
  buffer_load_dwordx4 a[12:15], v1, s[8:11], s23 offen sc1
  s_add_u32 s23, s27, 4096
  buffer_load_dwordx4 a[16:19], v1, s[8:11], s23 offen sc1
  s_add_u32 s23, s27, 5120
  buffer_load_dwordx4 a[20:23], v1, s[8:11], s23 offen sc1
  s_add_u32 s23, s27, 6144
  buffer_load_dwordx4 a[24:27], v1, s[8:11], s23 offen sc1
  s_add_u32 s23, s27, 7168
  buffer_load_dwordx4 a[28:31], v1, s[8:11], s23 offen sc1
  s_add_u32 s23, s27, 8192
  buffer_load_dwordx4 a[32:35], v1, s[8:11], s23 offen sc1
  s_add_u32 s23, s27, 9216
  buffer_load_dwordx4 a[36:39], v1, s[8:11], s23 offen sc1
  s_add_u32 s23, s27, 10240
  buffer_load_dwordx4 a[40:43], v1, s[8:11], s23 offen sc1
  s_add_u32 s23, s27, 11264
  buffer_load_dwordx4 a[44:47], v1, s[8:11], s23 offen sc1
  s_add_u32 s23, s27, 12288
  buffer_load_dwordx4 a[48:51], v1, s[8:11], s23 offen sc1
  s_add_u32 s23, s27, 13312
  buffer_load_dwordx4 a[52:55], v1, s[8:11], s23 offen sc1
  s_add_u32 s23, s27, 14336
  buffer_load_dwordx4 a[56:59], v1, s[8:11], s23 offen sc1
  s_add_u32 s23, s27, 15360
  buffer_load_dwordx4 a[60:63], v1, s[8:11], s23 offen sc1
  s_add_u32 s23, s27, 16384
  buffer_load_dwordx4 a[64:67], v1, s[8:11], s23 offen sc1
  s_add_u32 s23, s27, 17408
  buffer_load_dwordx4 a[68:71], v1, s[8:11], s23 offen sc1
  s_add_u32 s23, s27, 18432
  buffer_load_dwordx4 a[72:75], v1, s[8:11], s23 offen sc1
  s_add_u32 s23, s27, 19456
  buffer_load_dwordx4 a[76:79], v1, s[8:11], s23 offen sc1
  s_add_u32 s23, s27, 20480
  buffer_load_dwordx4 a[80:83], v1, s[8:11], s23 offen sc1
  s_add_u32 s23, s27, 21504
  buffer_load_dwordx4 a[84:87], v1, s[8:11], s23 offen sc1
  s_add_u32 s23, s27, 22528
  buffer_load_dwordx4 a[88:91], v1, s[8:11], s23 offen sc1
  s_add_u32 s23, s27, 23552
  buffer_load_dwordx4 a[92:95], v1, s[8:11], s23 offen sc1
  s_add_u32 s23, s27, 24576
  buffer_load_dwordx4 a[96:99], v1, s[8:11], s23 offen sc1
  s_add_u32 s23, s27, 25600
  buffer_load_dwordx4 a[100:103], v1, s[8:11], s23 offen sc1
  s_add_u32 s23, s27, 26624
  buffer_load_dwordx4 a[104:107], v1, s[8:11], s23 offen sc1
  s_add_u32 s23, s27, 27648
  buffer_load_dwordx4 a[108:111], v1, s[8:11], s23 offen sc1
  s_waitcnt vmcnt(24)
  s_add_u32 s23, s27, 114688
  buffer_load_dwordx4 a[112:115], v1, s[8:11], s23 offen sc1
  s_add_u32 s23, s27, 115712
  buffer_load_dwordx4 a[116:119], v1, s[8:11], s23 offen sc1
  s_add_u32 s23, s27, 116736
  buffer_load_dwordx4 a[120:123], v1, s[8:11], s23 offen sc1
  s_add_u32 s23, s27, 117760
  buffer_load_dwordx4 a[124:127], v1, s[8:11], s23 offen sc1
  s_add_u32 s23, s27, 118784
  buffer_load_dwordx4 a[128:131], v1, s[8:11], s23 offen sc1
  s_add_u32 s23, s27, 119808
  buffer_load_dwordx4 a[132:135], v1, s[8:11], s23 offen sc1
  s_add_u32 s23, s27, 120832
  buffer_load_dwordx4 a[136:139], v1, s[8:11], s23 offen sc1
  s_add_u32 s23, s27, 121856
  buffer_load_dwordx4 a[140:143], v1, s[8:11], s23 offen sc1
  s_add_u32 s23, s27, 122880
  buffer_load_dwordx4 a[144:147], v1, s[8:11], s23 offen sc1
  s_add_u32 s23, s27, 123904
  buffer_load_dwordx4 a[148:151], v1, s[8:11], s23 offen sc1
  s_add_u32 s23, s27, 124928
  buffer_load_dwordx4 a[152:155], v1, s[8:11], s23 offen sc1
  s_add_u32 s23, s27, 125952
  buffer_load_dwordx4 a[156:159], v1, s[8:11], s23 offen sc1
  s_add_u32 s23, s27, 126976
  buffer_load_dwordx4 a[160:163], v1, s[8:11], s23 offen sc1
  s_add_u32 s23, s27, 128000
  buffer_load_dwordx4 a[164:167], v1, s[8:11], s23 offen sc1
  s_add_u32 s23, s27, 129024
  buffer_load_dwordx4 a[168:171], v1, s[8:11], s23 offen sc1
  s_add_u32 s23, s27, 130048
  buffer_load_dwordx4 a[172:175], v1, s[8:11], s23 offen sc1
  s_add_u32 s23, s27, 131072
  buffer_load_dwordx4 a[176:179], v1, s[8:11], s23 offen sc1
  s_add_u32 s23, s27, 132096
  buffer_load_dwordx4 a[180:183], v1, s[8:11], s23 offen sc1
  s_add_u32 s23, s27, 133120
  buffer_load_dwordx4 a[184:187], v1, s[8:11], s23 offen sc1
  s_add_u32 s23, s27, 134144
  buffer_load_dwordx4 a[188:191], v1, s[8:11], s23 offen sc1
  s_add_u32 s23, s27, 135168
  buffer_load_dwordx4 a[192:195], v1, s[8:11], s23 offen sc1
  s_add_u32 s23, s27, 136192
  buffer_load_dwordx4 a[196:199], v1, s[8:11], s23 offen sc1
  s_add_u32 s23, s27, 137216
  buffer_load_dwordx4 a[200:203], v1, s[8:11], s23 offen sc1
  s_add_u32 s23, s27, 138240
  buffer_load_dwordx4 a[204:207], v1, s[8:11], s23 offen sc1
  s_add_u32 s23, s27, 139264
  buffer_load_dwordx4 a[208:211], v1, s[8:11], s23 offen sc1
  s_add_u32 s23, s27, 140288
  buffer_load_dwordx4 a[212:215], v1, s[8:11], s23 offen sc1
  s_add_u32 s23, s27, 141312
  buffer_load_dwordx4 a[216:219], v1, s[8:11], s23 offen sc1
  s_add_u32 s23, s27, 142336
  buffer_load_dwordx4 a[220:223], v1, s[8:11], s23 offen sc1
L_w_g2:
  s_load_dwordx2 s[16:17], s[0:1], 88
  s_waitcnt lgkmcnt(0)
  s_mov_b32 s12, s16
  s_mov_b32 s13, s17
  s_mov_b32 s14, 4096
  s_mov_b32 s15, 0x00020000
  s_load_dwordx2 s[22:23], s[0:1], 96
  s_waitcnt lgkmcnt(0)
  s_mov_b32 s16, s22
  s_mov_b32 s17, s23
  s_mov_b32 s18, 1835008
  s_mov_b32 s19, 0x00020000
  v_lshlrev_b32 v1, 4, v0
  s_mov_b32 s24, s84
  s_mov_b32 s25, s85
  s_mul_i32 s21, s3, 28672
  s_mul_i32 s26, s25, 229376
  s_add_u32 s26, s26, s21
  s_add_u32 s26, s26, 65163264
  v_and_b32 v2, 31, v0
  v_lshrrev_b32 v3, 5, v0
  s_and_b32 s21, s3, 1
  s_lshl_b32 s21, s21, 5
  s_lshl_b32 s22, s24, 6
  s_add_u32 s21, s21, s22
  v_add_u32 v4, s21, v2
  v_lshlrev_b32 v5, 1, v4
  buffer_load_ushort v6, v5, s[12:15], 0 offen
  s_lshr_b32 s27, s3, 1
  s_lshl_b32 s27, s27, 5
  s_lshl_b32 s22, s25, 6
  s_add_u32 s27, s27, s22
  v_mul_u32_u24 v4, 896, v4
  v_lshl_add_u32 v4, v3, 4, v4
  s_lshr_b32 s21, s21, 5
  s_mul_i32 s21, s21, 28672
  s_add_u32 s21, s21, 61493248
  s_mov_b32 s22, 38347923
  v_lshlrev_b32 v7, 3, v3
  v_add_u32 v7, s27, v7
  v_add_u32 v7, 0, v7
  v_mul_hi_u32 v8, v7, s22
  v_mul_u32_u24 v9, 112, v8
  v_sub_u32 v7, v7, v9
  v_lshlrev_b32 v7, 1, v7
  v_mul_u32_u24 v8, 7168, v8
  v_add_u32 v7, v7, v8
  v_mul_u32_u24 v8, 224, v2
  v_add_u32 v10, v7, v8
  v_lshlrev_b32 v7, 3, v3
  v_add_u32 v7, s27, v7
  v_add_u32 v7, 16, v7
  v_mul_hi_u32 v8, v7, s22
  v_mul_u32_u24 v9, 112, v8
  v_sub_u32 v7, v7, v9
  v_lshlrev_b32 v7, 1, v7
  v_mul_u32_u24 v8, 7168, v8
  v_add_u32 v7, v7, v8
  v_mul_u32_u24 v8, 224, v2
  v_add_u32 v11, v7, v8
  s_mov_b32 s72, 49883648
  s_cmp_lg_u32 s3, 0
  s_nop 0
  s_cbranch_scc1 L_wf_fe
  s_mov_b32 s23, 0
L_sp_fe:
  buffer_load_dword v12, off, s[8:11], s72 sc1
  s_add_u32 s23, s23, 1
  s_cmp_gt_u32 s23, 50000
  s_cbranch_scc1 L_w_fail
  s_waitcnt vmcnt(0)
  v_readfirstlane_b32 s22, v12
  s_nop 0
  s_cmp_ge_u32 s22, 16
  s_nop 0
  s_cbranch_scc1 L_sp_fe_ok
  s_sleep 40
  s_branch L_sp_fe
L_sp_fe_ok:
L_wf_fe:
  s_barrier
  s_mul_i32 s72, s3, 7
  s_add_u32 s72, s72, s25
  s_lshl_b32 s72, s72, 7
  s_add_u32 s72, s72, 49946624
  s_mov_b32 s23, 0
L_sp_fg:
  buffer_load_dword v12, off, s[8:11], s72 sc1
  s_add_u32 s23, s23, 1
  s_cmp_gt_u32 s23, 50000
  s_cbranch_scc1 L_w_fail
  s_waitcnt vmcnt(0)
  v_readfirstlane_b32 s22, v12
  s_nop 0
  s_cmp_ge_u32 s22, 14
  s_cbranch_scc1 L_sp_fg_ok
  s_sleep 1
  s_branch L_sp_fg
L_sp_fg_ok:
  buffer_load_dwordx4 v[12:15], v10, s[8:11], s21 offen sc1
  buffer_load_dwordx4 v[16:19], v11, s[8:11], s21 offen sc1
  s_add_u32 s23, s26, 0
  buffer_load_dwordx4 v[20:23], v1, s[8:11], s23 offen sc1
  s_add_u32 s23, s26, 114688
  buffer_load_dwordx4 v[24:27], v1, s[8:11], s23 offen sc1
  s_add_u32 s23, s26, 1024
  buffer_load_dwordx4 v[28:31], v1, s[8:11], s23 offen sc1
  s_add_u32 s23, s26, 115712
  buffer_load_dwordx4 v[32:35], v1, s[8:11], s23 offen sc1
  s_add_u32 s23, s26, 2048
  buffer_load_dwordx4 v[36:39], v1, s[8:11], s23 offen sc1
  s_add_u32 s23, s26, 116736
  buffer_load_dwordx4 v[40:43], v1, s[8:11], s23 offen sc1
  s_add_u32 s23, s26, 3072
  buffer_load_dwordx4 v[44:47], v1, s[8:11], s23 offen sc1
  s_add_u32 s23, s26, 117760
  buffer_load_dwordx4 v[48:51], v1, s[8:11], s23 offen sc1
  s_add_u32 s23, s26, 4096
  buffer_load_dwordx4 v[52:55], v1, s[8:11], s23 offen sc1
  s_add_u32 s23, s26, 118784
  buffer_load_dwordx4 v[56:59], v1, s[8:11], s23 offen sc1
  s_add_u32 s23, s26, 5120
  buffer_load_dwordx4 v[60:63], v1, s[8:11], s23 offen sc1
  s_add_u32 s23, s26, 119808
  buffer_load_dwordx4 v[64:67], v1, s[8:11], s23 offen sc1
  s_add_u32 s23, s26, 6144
  buffer_load_dwordx4 v[68:71], v1, s[8:11], s23 offen sc1
  s_add_u32 s23, s26, 120832
  buffer_load_dwordx4 v[72:75], v1, s[8:11], s23 offen sc1
  s_add_u32 s23, s26, 7168
  buffer_load_dwordx4 v[76:79], v1, s[8:11], s23 offen sc1
  s_add_u32 s23, s26, 121856
  buffer_load_dwordx4 v[80:83], v1, s[8:11], s23 offen sc1
  s_add_u32 s23, s26, 8192
  buffer_load_dwordx4 v[84:87], v1, s[8:11], s23 offen sc1
  s_add_u32 s23, s26, 122880
  buffer_load_dwordx4 v[88:91], v1, s[8:11], s23 offen sc1
  s_waitcnt vmcnt(16)
  v_mfma_f32_32x32x16_bf16 v[188:203], v[20:23], a[0:3], 0
  v_mfma_f32_32x32x16_bf16 v[204:219], v[20:23], a[112:115], 0
  v_mfma_f32_32x32x16_bf16 v[220:235], v[24:27], a[0:3], 0
  v_mfma_f32_32x32x16_bf16 v[236:251], v[24:27], a[112:115], 0
  s_add_u32 s23, s26, 9216
  buffer_load_dwordx4 v[20:23], v1, s[8:11], s23 offen sc1
  s_add_u32 s23, s26, 123904
  buffer_load_dwordx4 v[24:27], v1, s[8:11], s23 offen sc1
  s_waitcnt vmcnt(16)
  v_mfma_f32_32x32x16_bf16 v[188:203], v[28:31], a[4:7], v[188:203]
  v_mfma_f32_32x32x16_bf16 v[204:219], v[28:31], a[116:119], v[204:219]
  v_mfma_f32_32x32x16_bf16 v[220:235], v[32:35], a[4:7], v[220:235]
  v_mfma_f32_32x32x16_bf16 v[236:251], v[32:35], a[116:119], v[236:251]
  s_add_u32 s23, s26, 10240
  buffer_load_dwordx4 v[28:31], v1, s[8:11], s23 offen sc1
  s_add_u32 s23, s26, 124928
  buffer_load_dwordx4 v[32:35], v1, s[8:11], s23 offen sc1
  s_waitcnt vmcnt(16)
  v_mfma_f32_32x32x16_bf16 v[188:203], v[36:39], a[8:11], v[188:203]
  v_mfma_f32_32x32x16_bf16 v[204:219], v[36:39], a[120:123], v[204:219]
  v_mfma_f32_32x32x16_bf16 v[220:235], v[40:43], a[8:11], v[220:235]
  v_mfma_f32_32x32x16_bf16 v[236:251], v[40:43], a[120:123], v[236:251]
  s_add_u32 s23, s26, 11264
  buffer_load_dwordx4 v[36:39], v1, s[8:11], s23 offen sc1
  s_add_u32 s23, s26, 125952
  buffer_load_dwordx4 v[40:43], v1, s[8:11], s23 offen sc1
  s_waitcnt vmcnt(16)
  v_mfma_f32_32x32x16_bf16 v[188:203], v[44:47], a[12:15], v[188:203]
  v_mfma_f32_32x32x16_bf16 v[204:219], v[44:47], a[124:127], v[204:219]
  v_mfma_f32_32x32x16_bf16 v[220:235], v[48:51], a[12:15], v[220:235]
  v_mfma_f32_32x32x16_bf16 v[236:251], v[48:51], a[124:127], v[236:251]
  s_add_u32 s23, s26, 12288
  buffer_load_dwordx4 v[44:47], v1, s[8:11], s23 offen sc1
  s_add_u32 s23, s26, 126976
  buffer_load_dwordx4 v[48:51], v1, s[8:11], s23 offen sc1
  s_waitcnt vmcnt(16)
  v_mfma_f32_32x32x16_bf16 v[188:203], v[52:55], a[16:19], v[188:203]
  v_mfma_f32_32x32x16_bf16 v[204:219], v[52:55], a[128:131], v[204:219]
  v_mfma_f32_32x32x16_bf16 v[220:235], v[56:59], a[16:19], v[220:235]
  v_mfma_f32_32x32x16_bf16 v[236:251], v[56:59], a[128:131], v[236:251]
  s_add_u32 s23, s26, 13312
  buffer_load_dwordx4 v[52:55], v1, s[8:11], s23 offen sc1
  s_add_u32 s23, s26, 128000
  buffer_load_dwordx4 v[56:59], v1, s[8:11], s23 offen sc1
  s_waitcnt vmcnt(16)
  v_mfma_f32_32x32x16_bf16 v[188:203], v[60:63], a[20:23], v[188:203]
  v_mfma_f32_32x32x16_bf16 v[204:219], v[60:63], a[132:135], v[204:219]
  v_mfma_f32_32x32x16_bf16 v[220:235], v[64:67], a[20:23], v[220:235]
  v_mfma_f32_32x32x16_bf16 v[236:251], v[64:67], a[132:135], v[236:251]
  s_add_u32 s23, s26, 14336
  buffer_load_dwordx4 v[60:63], v1, s[8:11], s23 offen sc1
  s_add_u32 s23, s26, 129024
  buffer_load_dwordx4 v[64:67], v1, s[8:11], s23 offen sc1
  s_waitcnt vmcnt(16)
  v_mfma_f32_32x32x16_bf16 v[188:203], v[68:71], a[24:27], v[188:203]
  v_mfma_f32_32x32x16_bf16 v[204:219], v[68:71], a[136:139], v[204:219]
  v_mfma_f32_32x32x16_bf16 v[220:235], v[72:75], a[24:27], v[220:235]
  v_mfma_f32_32x32x16_bf16 v[236:251], v[72:75], a[136:139], v[236:251]
  s_add_u32 s23, s26, 15360
  buffer_load_dwordx4 v[68:71], v1, s[8:11], s23 offen sc1
  s_add_u32 s23, s26, 130048
  buffer_load_dwordx4 v[72:75], v1, s[8:11], s23 offen sc1
  s_waitcnt vmcnt(16)
  v_mfma_f32_32x32x16_bf16 v[188:203], v[76:79], a[28:31], v[188:203]
  v_mfma_f32_32x32x16_bf16 v[204:219], v[76:79], a[140:143], v[204:219]
  v_mfma_f32_32x32x16_bf16 v[220:235], v[80:83], a[28:31], v[220:235]
  v_mfma_f32_32x32x16_bf16 v[236:251], v[80:83], a[140:143], v[236:251]
  s_add_u32 s23, s26, 16384
  buffer_load_dwordx4 v[76:79], v1, s[8:11], s23 offen sc1
  s_add_u32 s23, s26, 131072
  buffer_load_dwordx4 v[80:83], v1, s[8:11], s23 offen sc1
  s_waitcnt vmcnt(16)
  v_mfma_f32_32x32x16_bf16 v[188:203], v[84:87], a[32:35], v[188:203]
  v_mfma_f32_32x32x16_bf16 v[204:219], v[84:87], a[144:147], v[204:219]
  v_mfma_f32_32x32x16_bf16 v[220:235], v[88:91], a[32:35], v[220:235]
  v_mfma_f32_32x32x16_bf16 v[236:251], v[88:91], a[144:147], v[236:251]
  s_add_u32 s23, s26, 17408
  buffer_load_dwordx4 v[84:87], v1, s[8:11], s23 offen sc1
  s_add_u32 s23, s26, 132096
  buffer_load_dwordx4 v[88:91], v1, s[8:11], s23 offen sc1
  s_waitcnt vmcnt(16)
  v_mfma_f32_32x32x16_bf16 v[188:203], v[20:23], a[36:39], v[188:203]
  v_mfma_f32_32x32x16_bf16 v[204:219], v[20:23], a[148:151], v[204:219]
  v_mfma_f32_32x32x16_bf16 v[220:235], v[24:27], a[36:39], v[220:235]
  v_mfma_f32_32x32x16_bf16 v[236:251], v[24:27], a[148:151], v[236:251]
  s_add_u32 s23, s26, 18432
  buffer_load_dwordx4 v[20:23], v1, s[8:11], s23 offen sc1
  s_add_u32 s23, s26, 133120
  buffer_load_dwordx4 v[24:27], v1, s[8:11], s23 offen sc1
  s_waitcnt vmcnt(16)
  v_mfma_f32_32x32x16_bf16 v[188:203], v[28:31], a[40:43], v[188:203]
  v_mfma_f32_32x32x16_bf16 v[204:219], v[28:31], a[152:155], v[204:219]
  v_mfma_f32_32x32x16_bf16 v[220:235], v[32:35], a[40:43], v[220:235]
  v_mfma_f32_32x32x16_bf16 v[236:251], v[32:35], a[152:155], v[236:251]
  s_add_u32 s23, s26, 19456
  buffer_load_dwordx4 v[28:31], v1, s[8:11], s23 offen sc1
  s_add_u32 s23, s26, 134144
  buffer_load_dwordx4 v[32:35], v1, s[8:11], s23 offen sc1
  s_waitcnt vmcnt(16)
  v_mfma_f32_32x32x16_bf16 v[188:203], v[36:39], a[44:47], v[188:203]
  v_mfma_f32_32x32x16_bf16 v[204:219], v[36:39], a[156:159], v[204:219]
  v_mfma_f32_32x32x16_bf16 v[220:235], v[40:43], a[44:47], v[220:235]
  v_mfma_f32_32x32x16_bf16 v[236:251], v[40:43], a[156:159], v[236:251]
  s_add_u32 s23, s26, 20480
  buffer_load_dwordx4 v[36:39], v1, s[8:11], s23 offen sc1
  s_add_u32 s23, s26, 135168
  buffer_load_dwordx4 v[40:43], v1, s[8:11], s23 offen sc1
  s_waitcnt vmcnt(16)
  v_mfma_f32_32x32x16_bf16 v[188:203], v[44:47], a[48:51], v[188:203]
  v_mfma_f32_32x32x16_bf16 v[204:219], v[44:47], a[160:163], v[204:219]
  v_mfma_f32_32x32x16_bf16 v[220:235], v[48:51], a[48:51], v[220:235]
  v_mfma_f32_32x32x16_bf16 v[236:251], v[48:51], a[160:163], v[236:251]
  s_add_u32 s23, s26, 21504
  buffer_load_dwordx4 v[44:47], v1, s[8:11], s23 offen sc1
  s_add_u32 s23, s26, 136192
  buffer_load_dwordx4 v[48:51], v1, s[8:11], s23 offen sc1
  s_waitcnt vmcnt(16)
  v_mfma_f32_32x32x16_bf16 v[188:203], v[52:55], a[52:55], v[188:203]
  v_mfma_f32_32x32x16_bf16 v[204:219], v[52:55], a[164:167], v[204:219]
  v_mfma_f32_32x32x16_bf16 v[220:235], v[56:59], a[52:55], v[220:235]
  v_mfma_f32_32x32x16_bf16 v[236:251], v[56:59], a[164:167], v[236:251]
  s_add_u32 s23, s26, 22528
  buffer_load_dwordx4 v[52:55], v1, s[8:11], s23 offen sc1
  s_add_u32 s23, s26, 137216
  buffer_load_dwordx4 v[56:59], v1, s[8:11], s23 offen sc1
  s_waitcnt vmcnt(16)
  v_mfma_f32_32x32x16_bf16 v[188:203], v[60:63], a[56:59], v[188:203]
  v_mfma_f32_32x32x16_bf16 v[204:219], v[60:63], a[168:171], v[204:219]
  v_mfma_f32_32x32x16_bf16 v[220:235], v[64:67], a[56:59], v[220:235]
  v_mfma_f32_32x32x16_bf16 v[236:251], v[64:67], a[168:171], v[236:251]
  s_add_u32 s23, s26, 23552
  buffer_load_dwordx4 v[60:63], v1, s[8:11], s23 offen sc1
  s_add_u32 s23, s26, 138240
  buffer_load_dwordx4 v[64:67], v1, s[8:11], s23 offen sc1
  s_waitcnt vmcnt(16)
  v_mfma_f32_32x32x16_bf16 v[188:203], v[68:71], a[60:63], v[188:203]
  v_mfma_f32_32x32x16_bf16 v[204:219], v[68:71], a[172:175], v[204:219]
  v_mfma_f32_32x32x16_bf16 v[220:235], v[72:75], a[60:63], v[220:235]
  v_mfma_f32_32x32x16_bf16 v[236:251], v[72:75], a[172:175], v[236:251]
  s_add_u32 s23, s26, 24576
  buffer_load_dwordx4 v[68:71], v1, s[8:11], s23 offen sc1
  s_add_u32 s23, s26, 139264
  buffer_load_dwordx4 v[72:75], v1, s[8:11], s23 offen sc1
  s_waitcnt vmcnt(16)
  v_mfma_f32_32x32x16_bf16 v[188:203], v[76:79], a[64:67], v[188:203]
  v_mfma_f32_32x32x16_bf16 v[204:219], v[76:79], a[176:179], v[204:219]
  v_mfma_f32_32x32x16_bf16 v[220:235], v[80:83], a[64:67], v[220:235]
  v_mfma_f32_32x32x16_bf16 v[236:251], v[80:83], a[176:179], v[236:251]
  s_add_u32 s23, s26, 25600
  buffer_load_dwordx4 v[76:79], v1, s[8:11], s23 offen sc1
  s_add_u32 s23, s26, 140288
  buffer_load_dwordx4 v[80:83], v1, s[8:11], s23 offen sc1
  s_waitcnt vmcnt(16)
  v_mfma_f32_32x32x16_bf16 v[188:203], v[84:87], a[68:71], v[188:203]
  v_mfma_f32_32x32x16_bf16 v[204:219], v[84:87], a[180:183], v[204:219]
  v_mfma_f32_32x32x16_bf16 v[220:235], v[88:91], a[68:71], v[220:235]
  v_mfma_f32_32x32x16_bf16 v[236:251], v[88:91], a[180:183], v[236:251]
  s_add_u32 s23, s26, 26624
  buffer_load_dwordx4 v[84:87], v1, s[8:11], s23 offen sc1
  s_add_u32 s23, s26, 141312
  buffer_load_dwordx4 v[88:91], v1, s[8:11], s23 offen sc1
  s_waitcnt vmcnt(16)
  v_mfma_f32_32x32x16_bf16 v[188:203], v[20:23], a[72:75], v[188:203]
  v_mfma_f32_32x32x16_bf16 v[204:219], v[20:23], a[184:187], v[204:219]
  v_mfma_f32_32x32x16_bf16 v[220:235], v[24:27], a[72:75], v[220:235]
  v_mfma_f32_32x32x16_bf16 v[236:251], v[24:27], a[184:187], v[236:251]
  s_add_u32 s23, s26, 27648
  buffer_load_dwordx4 v[20:23], v1, s[8:11], s23 offen sc1
  s_add_u32 s23, s26, 142336
  buffer_load_dwordx4 v[24:27], v1, s[8:11], s23 offen sc1
  s_waitcnt vmcnt(16)
  v_mfma_f32_32x32x16_bf16 v[188:203], v[28:31], a[76:79], v[188:203]
  v_mfma_f32_32x32x16_bf16 v[204:219], v[28:31], a[188:191], v[204:219]
  v_mfma_f32_32x32x16_bf16 v[220:235], v[32:35], a[76:79], v[220:235]
  v_mfma_f32_32x32x16_bf16 v[236:251], v[32:35], a[188:191], v[236:251]
  s_waitcnt vmcnt(14)
  v_mfma_f32_32x32x16_bf16 v[188:203], v[36:39], a[80:83], v[188:203]
  v_mfma_f32_32x32x16_bf16 v[204:219], v[36:39], a[192:195], v[204:219]
  v_mfma_f32_32x32x16_bf16 v[220:235], v[40:43], a[80:83], v[220:235]
  v_mfma_f32_32x32x16_bf16 v[236:251], v[40:43], a[192:195], v[236:251]
  s_waitcnt vmcnt(12)
  v_mfma_f32_32x32x16_bf16 v[188:203], v[44:47], a[84:87], v[188:203]
  v_mfma_f32_32x32x16_bf16 v[204:219], v[44:47], a[196:199], v[204:219]
  v_mfma_f32_32x32x16_bf16 v[220:235], v[48:51], a[84:87], v[220:235]
  v_mfma_f32_32x32x16_bf16 v[236:251], v[48:51], a[196:199], v[236:251]
  s_waitcnt vmcnt(10)
  v_mfma_f32_32x32x16_bf16 v[188:203], v[52:55], a[88:91], v[188:203]
  v_mfma_f32_32x32x16_bf16 v[204:219], v[52:55], a[200:203], v[204:219]
  v_mfma_f32_32x32x16_bf16 v[220:235], v[56:59], a[88:91], v[220:235]
  v_mfma_f32_32x32x16_bf16 v[236:251], v[56:59], a[200:203], v[236:251]
  s_waitcnt vmcnt(8)
  v_mfma_f32_32x32x16_bf16 v[188:203], v[60:63], a[92:95], v[188:203]
  v_mfma_f32_32x32x16_bf16 v[204:219], v[60:63], a[204:207], v[204:219]
  v_mfma_f32_32x32x16_bf16 v[220:235], v[64:67], a[92:95], v[220:235]
  v_mfma_f32_32x32x16_bf16 v[236:251], v[64:67], a[204:207], v[236:251]
  s_waitcnt vmcnt(6)
  v_mfma_f32_32x32x16_bf16 v[188:203], v[68:71], a[96:99], v[188:203]
  v_mfma_f32_32x32x16_bf16 v[204:219], v[68:71], a[208:211], v[204:219]
  v_mfma_f32_32x32x16_bf16 v[220:235], v[72:75], a[96:99], v[220:235]
  v_mfma_f32_32x32x16_bf16 v[236:251], v[72:75], a[208:211], v[236:251]
  s_waitcnt vmcnt(4)
  v_mfma_f32_32x32x16_bf16 v[188:203], v[76:79], a[100:103], v[188:203]
  v_mfma_f32_32x32x16_bf16 v[204:219], v[76:79], a[212:215], v[204:219]
  v_mfma_f32_32x32x16_bf16 v[220:235], v[80:83], a[100:103], v[220:235]
  v_mfma_f32_32x32x16_bf16 v[236:251], v[80:83], a[212:215], v[236:251]
  s_waitcnt vmcnt(2)
  v_mfma_f32_32x32x16_bf16 v[188:203], v[84:87], a[104:107], v[188:203]
  v_mfma_f32_32x32x16_bf16 v[204:219], v[84:87], a[216:219], v[204:219]
  v_mfma_f32_32x32x16_bf16 v[220:235], v[88:91], a[104:107], v[220:235]
  v_mfma_f32_32x32x16_bf16 v[236:251], v[88:91], a[216:219], v[236:251]
  s_waitcnt vmcnt(0)
  v_mfma_f32_32x32x16_bf16 v[188:203], v[20:23], a[108:111], v[188:203]
  v_mfma_f32_32x32x16_bf16 v[204:219], v[20:23], a[220:223], v[204:219]
  v_mfma_f32_32x32x16_bf16 v[220:235], v[24:27], a[108:111], v[220:235]
  v_mfma_f32_32x32x16_bf16 v[236:251], v[24:27], a[220:223], v[236:251]
  s_nop 7
  s_nop 7
  s_lshl_b32 s22, s3, 12
  v_add_u32 v7, s22, v1
  s_cmp_eq_u32 s3, 0
  s_cbranch_scc1 L_g2_sk0
  ds_write_b128 v7, v[188:191] offset:0
  ds_write_b128 v7, v[192:195] offset:1024
  ds_write_b128 v7, v[196:199] offset:2048
  ds_write_b128 v7, v[200:203] offset:3072
L_g2_sk0:
  s_cmp_eq_u32 s3, 1
  s_cbranch_scc1 L_g2_sk1
  ds_write_b128 v7, v[204:207] offset:16384
  ds_write_b128 v7, v[208:211] offset:17408
  ds_write_b128 v7, v[212:215] offset:18432
  ds_write_b128 v7, v[216:219] offset:19456
L_g2_sk1:
  s_cmp_eq_u32 s3, 2
  s_cbranch_scc1 L_g2_sk2
  ds_write_b128 v7, v[220:223] offset:32768
  ds_write_b128 v7, v[224:227] offset:33792
  ds_write_b128 v7, v[228:231] offset:34816
  ds_write_b128 v7, v[232:235] offset:35840
L_g2_sk2:
  s_cmp_eq_u32 s3, 3
  s_cbranch_scc1 L_g2_sk3
  ds_write_b128 v7, v[236:239] offset:49152
  ds_write_b128 v7, v[240:243] offset:50176
  ds_write_b128 v7, v[244:247] offset:51200
  ds_write_b128 v7, v[248:251] offset:52224
L_g2_sk3:
  s_cmp_eq_u32 s3, 1
  s_cbranch_scc0 L_g2_mv1
  v_mov_b32 v188, v204
  v_mov_b32 v189, v205
  v_mov_b32 v190, v206
  v_mov_b32 v191, v207
  v_mov_b32 v192, v208
  v_mov_b32 v193, v209
  v_mov_b32 v194, v210
  v_mov_b32 v195, v211
  v_mov_b32 v196, v212
  v_mov_b32 v197, v213
  v_mov_b32 v198, v214
  v_mov_b32 v199, v215
  v_mov_b32 v200, v216
  v_mov_b32 v201, v217
  v_mov_b32 v202, v218
  v_mov_b32 v203, v219
L_g2_mv1:
  s_cmp_eq_u32 s3, 2
  s_cbranch_scc0 L_g2_mv2
  v_mov_b32 v188, v220
  v_mov_b32 v189, v221
  v_mov_b32 v190, v222
  v_mov_b32 v191, v223
  v_mov_b32 v192, v224
  v_mov_b32 v193, v225
  v_mov_b32 v194, v226
  v_mov_b32 v195, v227
  v_mov_b32 v196, v228
  v_mov_b32 v197, v229
  v_mov_b32 v198, v230
  v_mov_b32 v199, v231
  v_mov_b32 v200, v232
  v_mov_b32 v201, v233
  v_mov_b32 v202, v234
  v_mov_b32 v203, v235
L_g2_mv2:
  s_cmp_eq_u32 s3, 3
  s_cbranch_scc0 L_g2_mv3
  v_mov_b32 v188, v236
  v_mov_b32 v189, v237
  v_mov_b32 v190, v238
  v_mov_b32 v191, v239
  v_mov_b32 v192, v240
  v_mov_b32 v193, v241
  v_mov_b32 v194, v242
  v_mov_b32 v195, v243
  v_mov_b32 v196, v244
  v_mov_b32 v197, v245
  v_mov_b32 v198, v246
  v_mov_b32 v199, v247
  v_mov_b32 v200, v248
  v_mov_b32 v201, v249
  v_mov_b32 v202, v250
  v_mov_b32 v203, v251
L_g2_mv3:
  s_waitcnt lgkmcnt(0)
  s_barrier
  s_lshl_b32 s22, s3, 14
  v_add_u32 v7, s22, v1
  s_add_u32 s23, s3, 1
  s_and_b32 s23, s23, 3
  s_lshl_b32 s23, s23, 12
  v_add_u32 v8, s23, v7
  s_add_u32 s23, s3, 2
  s_and_b32 s23, s23, 3
  s_lshl_b32 s23, s23, 12
  v_add_u32 v9, s23, v7
  s_add_u32 s23, s3, 3
  s_and_b32 s23, s23, 3
  s_lshl_b32 s23, s23, 12
  v_add_u32 v10, s23, v7
  ds_read_b128 v[20:23], v8 offset:0
  ds_read_b128 v[24:27], v8 offset:1024
  ds_read_b128 v[28:31], v8 offset:2048
  ds_read_b128 v[32:35], v8 offset:3072
  ds_read_b128 v[36:39], v9 offset:0
  ds_read_b128 v[40:43], v9 offset:1024
  ds_read_b128 v[44:47], v9 offset:2048
  ds_read_b128 v[48:51], v9 offset:3072
  ds_read_b128 v[52:55], v10 offset:0
  ds_read_b128 v[56:59], v10 offset:1024
  ds_read_b128 v[60:63], v10 offset:2048
  ds_read_b128 v[64:67], v10 offset:3072
  s_waitcnt lgkmcnt(8)
  v_add_f32 v188, v188, v20
  v_add_f32 v189, v189, v21
  v_add_f32 v190, v190, v22
  v_add_f32 v191, v191, v23
  v_add_f32 v192, v192, v24
  v_add_f32 v193, v193, v25
  v_add_f32 v194, v194, v26
  v_add_f32 v195, v195, v27
  v_add_f32 v196, v196, v28
  v_add_f32 v197, v197, v29
  v_add_f32 v198, v198, v30
  v_add_f32 v199, v199, v31
  v_add_f32 v200, v200, v32
  v_add_f32 v201, v201, v33
  v_add_f32 v202, v202, v34
  v_add_f32 v203, v203, v35
  s_waitcnt lgkmcnt(4)
  v_add_f32 v188, v188, v36
  v_add_f32 v189, v189, v37
  v_add_f32 v190, v190, v38
  v_add_f32 v191, v191, v39
  v_add_f32 v192, v192, v40
  v_add_f32 v193, v193, v41
  v_add_f32 v194, v194, v42
  v_add_f32 v195, v195, v43
  v_add_f32 v196, v196, v44
  v_add_f32 v197, v197, v45
  v_add_f32 v198, v198, v46
  v_add_f32 v199, v199, v47
  v_add_f32 v200, v200, v48
  v_add_f32 v201, v201, v49
  v_add_f32 v202, v202, v50
  v_add_f32 v203, v203, v51
  s_waitcnt lgkmcnt(0)
  v_add_f32 v188, v188, v52
  v_add_f32 v189, v189, v53
  v_add_f32 v190, v190, v54
  v_add_f32 v191, v191, v55
  v_add_f32 v192, v192, v56
  v_add_f32 v193, v193, v57
  v_add_f32 v194, v194, v58
  v_add_f32 v195, v195, v59
  v_add_f32 v196, v196, v60
  v_add_f32 v197, v197, v61
  v_add_f32 v198, v198, v62
  v_add_f32 v199, v199, v63
  v_add_f32 v200, v200, v64
  v_add_f32 v201, v201, v65
  v_add_f32 v202, v202, v66
  v_add_f32 v203, v203, v67
  v_permlane32_swap_b32 v188, v192
  v_permlane32_swap_b32 v196, v200
  v_permlane32_swap_b32 v189, v193
  v_permlane32_swap_b32 v197, v201
  v_permlane32_swap_b32 v190, v194
  v_permlane32_swap_b32 v198, v202
  v_permlane32_swap_b32 v191, v195
  v_permlane32_swap_b32 v199, v203
  v_lshlrev_b32 v6, 16, v6
  v_lshlrev_b32 v40, 16, v12
  v_and_b32 v41, 0xffff0000, v12
  v_add_f32 v188, v188, v6
  v_add_f32 v189, v189, v6
  v_add_f32 v188, v188, v40
  v_add_f32 v189, v189, v41
  v_cvt_pk_bf16_f32 v44, v188, v189
  v_lshlrev_b32 v40, 16, v13
  v_and_b32 v41, 0xffff0000, v13
  v_add_f32 v190, v190, v6
  v_add_f32 v191, v191, v6
  v_add_f32 v190, v190, v40
  v_add_f32 v191, v191, v41
  v_cvt_pk_bf16_f32 v45, v190, v191
  v_lshlrev_b32 v40, 16, v14
  v_and_b32 v41, 0xffff0000, v14
  v_add_f32 v192, v192, v6
  v_add_f32 v193, v193, v6
  v_add_f32 v192, v192, v40
  v_add_f32 v193, v193, v41
  v_cvt_pk_bf16_f32 v46, v192, v193
  v_lshlrev_b32 v40, 16, v15
  v_and_b32 v41, 0xffff0000, v15
  v_add_f32 v194, v194, v6
  v_add_f32 v195, v195, v6
  v_add_f32 v194, v194, v40
  v_add_f32 v195, v195, v41
  v_cvt_pk_bf16_f32 v47, v194, v195
  v_lshlrev_b32 v40, 16, v16
  v_and_b32 v41, 0xffff0000, v16
  v_add_f32 v196, v196, v6
  v_add_f32 v197, v197, v6
  v_add_f32 v196, v196, v40
  v_add_f32 v197, v197, v41
  v_cvt_pk_bf16_f32 v48, v196, v197
  v_lshlrev_b32 v40, 16, v17
  v_and_b32 v41, 0xffff0000, v17
  v_add_f32 v198, v198, v6
  v_add_f32 v199, v199, v6
  v_add_f32 v198, v198, v40
  v_add_f32 v199, v199, v41
  v_cvt_pk_bf16_f32 v49, v198, v199
  v_lshlrev_b32 v40, 16, v18
  v_and_b32 v41, 0xffff0000, v18
  v_add_f32 v200, v200, v6
  v_add_f32 v201, v201, v6
  v_add_f32 v200, v200, v40
  v_add_f32 v201, v201, v41
  v_cvt_pk_bf16_f32 v50, v200, v201
  v_lshlrev_b32 v40, 16, v19
  v_and_b32 v41, 0xffff0000, v19
  v_add_f32 v202, v202, v6
  v_add_f32 v203, v203, v6
  v_add_f32 v202, v202, v40
  v_add_f32 v203, v203, v41
  v_cvt_pk_bf16_f32 v51, v202, v203
  s_lshl_b32 s22, s27, 1
  buffer_store_dwordx4 v[44:47], v4, s[16:19], s22 offen
  buffer_store_dwordx4 v[48:51], v4, s[16:19], s22 offen offset:32
  s_branch L_w_end
L_w_fail:
  s_mov_b64 exec, 1
  v_mov_b32 v1, 76
  v_mov_b32 v2, 1
  global_atomic_add v1, v2, s[6:7]
L_w_end:
  s_waitcnt vmcnt(0)
  s_endpgm

.section .rodata,"a"
.p2align 6
.amdhsa_kernel main_kernel
  .amdhsa_next_free_vgpr 512
  .amdhsa_next_free_sgpr 100
  .amdhsa_accum_offset 256
  .amdhsa_group_segment_fixed_size 0
  .amdhsa_kernarg_size 120
  .amdhsa_user_sgpr_count 2
  .amdhsa_user_sgpr_kernarg_segment_ptr 1
  .amdhsa_system_sgpr_workgroup_id_x 1
.end_amdhsa_kernel
.text
```
